```python
import torch

def _softmax(x, axis=-1):
    return torch.softmax(x, dim=axis)
def _gelu(x):
    return torch.nn.functional.gelu(x, approximate="tanh")
def _silu(x):
    return torch.nn.functional.silu(x)
def _sigmoid(x):
    return torch.sigmoid(x)
def _layernorm(x, axis=-1, eps=1e-5):
    m = x.mean(dim=axis, keepdim=True)
    v = x.var(dim=axis, keepdim=True, unbiased=False)
    return (x - m) / torch.sqrt(v + eps)
def _scatter_add(tgt, idx, src, axis=0):
    return tgt.clone().index_add_(axis, idx, src)
def _segment_sum(src, seg, n):
    out = torch.zeros((n,) + src.shape[1:], dtype=src.dtype)
    return out.index_add_(0, seg, src)
def _pad(x, pw):
    flat = tuple(v for pair in reversed(pw) for v in pair)
    return torch.nn.functional.pad(x, flat)

kernel_name = 'standalone__adm_resblock__diffusion'

def setup_inputs():

    _w = (lambda a: (lambda t: t.to(torch.bfloat16) if t.is_floating_point() else t)(torch.as_tensor(a)))
    B, C, HW, E = 2, 320, 64, 384
    sc = (9.0 * C) ** -0.5
    return {
        "x": _w((lambda *s: torch.randn(*s, dtype=torch.bfloat16) * 0.05)(B, C, HW, HW)),
        "t_emb": _w((lambda *s: torch.randn(*s, dtype=torch.bfloat16) * 0.4)(B, E)),
        "g1": _w(1.0 + 0.1 * (lambda *s: torch.randn(*s, dtype=torch.bfloat16) * 0.4)(C)),
        "be1": _w(0.1 * (lambda *s: torch.randn(*s, dtype=torch.bfloat16) * 0.4)(C)),
        "w1": _w((lambda *s: torch.randn(*s, dtype=torch.bfloat16) * 0.4)(C, C, 3, 3) * sc),
        "w_emb": _w((lambda *s: torch.randn(*s, dtype=torch.bfloat16) * 0.4)(E, C) * (E ** -0.5)),
        "g2": _w(1.0 + 0.1 * (lambda *s: torch.randn(*s, dtype=torch.bfloat16) * 0.4)(C)),
        "be2": _w(0.1 * (lambda *s: torch.randn(*s, dtype=torch.bfloat16) * 0.4)(C)),
        "w2": _w((lambda *s: torch.randn(*s, dtype=torch.bfloat16) * 0.4)(C, C, 3, 3) * sc),
    }

def reference(x, t_emb, g1, be1, w1, w_emb, g2, be2, w2):
    B, C, H, W = x.shape
    G, eps = 4, 1e-5
    def gn(z, gamma, beta):
        zr = z.reshape(B, G, (C // G) * H * W)
        mu = zr.mean(-1).reshape(B, G, 1)
        var = ((zr - mu) ** 2).mean(-1).reshape(B, G, 1)
        zn = ((zr - mu) / torch.sqrt(var + eps)).reshape(B, C, H, W)
        return zn * gamma.reshape(1, C, 1, 1) + beta.reshape(1, C, 1, 1)
    def conv3(z, w):
        zp = _pad(z, ((0, 0), (0, 0), (1, 1), (1, 1)))
        taps = [torch.einsum("bchw,oc->bohw", zp[:, :, i:i+H, j:j+W], w[:, :, i, j]) for i in range(3) for j in range(3)]
        out = taps[0]
        for t in taps[1:]:
            out = out + t
        return out
    h = conv3(_silu(gn(x, g1, be1)), w1)
    emb = _silu(t_emb) @ w_emb
    h = h + emb.reshape(B, C, 1, 1)
    h = conv3(_silu(gn(h, g2, be2)), w2)
    return x + h
```

```asm
; @launch grid=(256,1,1) block=(256,1,1) lds=135040
.amdgcn_target "amdgcn-amd-amdhsa--gfx950"
.text
.globl standalone__adm_resblock__diffusion_kernel
.p2align 8
.type standalone__adm_resblock__diffusion_kernel,@function
standalone__adm_resblock__diffusion_kernel:
    s_cmp_ge_u32 s2, 256
    s_cbranch_scc1 L_done
    s_load_dwordx16 s[4:19], s[0:1], 0
    s_load_dwordx8 s[20:27], s[0:1], 64
    v_lshrrev_b32 v24, 6, v0
    v_and_b32 v1, 63, v0
    v_readfirstlane_b32 s3, v24
    s_getpc_b64 s[74:75]
L_pc:
    s_lshr_b32 s71, s2, 3
    s_lshl_b32 s71, s71, 11
    v_and_b32 v25, 7, v0
    v_lshl_add_u32 v25, v24, 3, v25
    v_lshl_add_u32 v253, v25, 6, s71
    v_min_u32 v25, L_done-L_pc, v253
    s_mov_b64 exec, 255
    global_load_dword v31, v25, s[74:75]
    s_mov_b64 exec, -1
    s_and_b32 s70, s2, 7
    s_lshr_b32 s71, s2, 3
    s_lshr_b32 s48, s70, 2
    s_and_b32 s72, s70, 2
    s_lshl_b32 s72, s72, 3
    s_lshr_b32 s49, s71, 1
    s_add_u32 s49, s49, s72
    s_and_b32 s70, s70, 1
    s_lshl_b32 s70, s70, 1
    s_and_b32 s50, s71, 1
    s_add_u32 s50, s50, s70
    s_lshl_b32 s51, s48, 5
    s_add_u32 s51, s51, s49
    s_lshl_b32 s70, s48, 2
    s_add_u32 s70, s70, s50
    s_mul_i32 s69, s70, 4608
    s_add_u32 s69, s69, 4096
    s_mul_i32 s54, s70, 655360
    s_lshl_b32 s71, s49, 2
    s_add_u32 s71, s71, s3
    s_lshl_b32 s72, s71, 10
    s_add_u32 s63, s54, s72
    s_add_u32 s63, s63, 4096
    s_lshl_b32 s72, s71, 6
    s_add_u32 s54, s54, s72
    v_lshlrev_b32 v2, 4, v1
    v_lshlrev_b32 v17, 3, v1
    v_lshrrev_b32 v30, 4, v1
    v_and_b32 v28, 0xf0, v2
    v_lshl_add_u32 v30, v30, 13, v28
    s_mov_b32 s30, 5242880
    s_mov_b32 s31, 0x20000
    s_mul_i32 s72, s50, 160
    v_min_u32 v19, 39, v1
    v_lshlrev_b32 v19, 2, v19
    v_add_u32 v29, s72, v19
    s_mul_i32 s74, s3, 32704
    s_add_u32 s74, s74, s54
    s_cmp_lt_u32 s3, 2
    s_waitcnt lgkmcnt(0)
    s_cselect_b64 s[70:71], s[8:9], s[16:17]
    s_cselect_b64 s[72:73], s[10:11], s[18:19]
    s_bitcmp0_b32 s3, 0
    s_cselect_b64 s[70:71], s[70:71], s[72:73]
    s_mov_b64 s[28:29], s[4:5]
    global_load_dword v18, v29, s[70:71]
    buffer_load_dwordx4 v[136:139], v30, s[28:31], s74 offen
    s_add_u32 s74, s74, 131072
    buffer_load_dwordx4 v[140:143], v30, s[28:31], s74 offen
    s_add_u32 s74, s74, 131072
    buffer_load_dwordx4 v[144:147], v30, s[28:31], s74 offen
    s_add_u32 s74, s74, 131072
    buffer_load_dwordx4 v[148:151], v30, s[28:31], s74 offen
    s_add_u32 s74, s74, 131072
    buffer_load_dwordx4 v[152:155], v30, s[28:31], s74 offen
    s_load_dwordx2 s[52:53], s[26:27], 0
    s_cmp_eq_u32 s3, 1
    s_cselect_b64 s[28:29], s[12:13], s[20:21]
    s_cselect_b32 s70, 3, 0
    s_cmp_lt_u32 s51, 62
    s_cselect_b32 s70, s70, 0
    s_cmp_eq_u32 s3, 3
    s_cselect_b32 s71, 0, s3
    s_cmp_lt_u32 s51, 50
    s_cselect_b32 s68, s71, s70
    s_cselect_b64 s[28:29], s[28:29], s[14:15]
    s_mov_b32 s70, 245760
    s_cselect_b32 s30, 1843200, s70
    s_cmp_lg_u32 s68, 3
    s_cbranch_scc1 L_noemb
    s_sub_u32 s70, s51, 50
    s_mul_i32 s71, s70, 20480
    s_mul_i32 s72, s50, 160
    s_add_u32 s71, s71, s72
    s_lshl_b32 s70, s70, 6
    s_movk_i32 s72, 480
    v_add_u32 v25, s71, v2
    v_mul_u32_u24 v24, 6554, v1
    s_mov_b32 m0, 116608
    v_lshrrev_b32 v26, 16, v24
    v_mad_u32_u24 v26, v26, s72, v25
    buffer_load_dwordx4 v26, s[28:31], 0 offen offset:0 lds
    v_add_u32 v24, 419456, v24
    v_lshrrev_b32 v26, 16, v24
    v_mad_u32_u24 v26, v26, s72, v25
    buffer_load_dwordx4 v26, s[28:31], 0 offen offset:1024 lds
    v_add_u32 v24, 419456, v24
    v_lshrrev_b32 v26, 16, v24
    v_mad_u32_u24 v26, v26, s72, v25
    buffer_load_dwordx4 v26, s[28:31], 0 offen offset:2048 lds
    v_add_u32 v24, 419456, v24
    v_lshrrev_b32 v26, 16, v24
    v_mad_u32_u24 v26, v26, s72, v25
    buffer_load_dwordx4 v26, s[28:31], 0 offen offset:3072 lds
    v_add_u32 v24, 419456, v24
    v_add_u32 v25, 4096, v25
    s_mov_b32 m0, 120704
    v_lshrrev_b32 v26, 16, v24
    v_mad_u32_u24 v26, v26, s72, v25
    buffer_load_dwordx4 v26, s[28:31], 0 offen offset:0 lds
    v_and_b32 v24, 15, v1
    v_min_u32 v24, 1, v24
    v_mul_u32_u24 v24, 768, v24
    v_and_b32 v25, 0x30, v1
    v_add3_u32 v24, v24, v25, s70
    global_load_dwordx4 v[216:219], v24, s[6:7]
    s_branch L_nostage1
L_noemb:
    s_cmp_lg_u32 s68, 1
    s_cbranch_scc1 L_nostage1
    s_mul_i32 s70, s51, 205
    s_lshr_b32 s70, s70, 11
    s_mul_i32 s71, s70, 10
    s_sub_u32 s71, s51, s71
    s_lshl_b32 s72, s71, 1
    s_mov_b32 s58, 3885033360
    s_mov_b32 s59, 57
    s_lshl_b32 s73, s72, 1
    s_lshr_b64 s[58:59], s[58:59], s73
    s_add_u32 s73, s58, s50
    s_and_b32 s73, s73, 3
    s_mul_i32 s73, s73, 5
    s_mov_b32 s58, 2586083336
    s_mov_b32 s59, 153382308
    s_mul_i32 vcc_lo, s72, 3
    s_lshr_b64 s[58:59], s[58:59], vcc_lo
    s_and_b32 s58, s58, 7
    s_add_u32 s73, s73, s58
    s_add_u32 s72, s72, 1
    s_mov_b32 s58, 3885033360
    s_mov_b32 s59, 57
    s_lshl_b32 s74, s72, 1
    s_lshr_b64 s[58:59], s[58:59], s74
    s_add_u32 s74, s58, s50
    s_and_b32 s74, s74, 3
    s_mul_i32 s74, s74, 5
    s_mov_b32 s58, 2586083336
    s_mov_b32 s59, 153382308
    s_mul_i32 vcc_lo, s72, 3
    s_lshr_b64 s[58:59], s[58:59], vcc_lo
    s_and_b32 s58, s58, 7
    s_add_u32 s74, s74, s58
    s_mul_i32 s75, s50, 5
    s_add_u32 s72, s75, s70
    s_mul_i32 s72, s72, 92160
    s_sub_u32 s74, s74, s73
    s_mul_i32 s73, s73, 288
    s_mul_i32 s74, s74, 288
    s_add_u32 s73, s73, s72
    s_sub_u32 s74, s74, 88064
    v_add_u32 v25, s73, v2
    v_add_u32 v26, s74, v25
    v_add_u32 v27, 4096, v25
    s_mov_b32 exec_lo, 0
    v_mov_b32 v27, v26
    s_mov_b32 exec_lo, -1
    v_add_u32 v28, 4096, v26
    s_mov_b32 s76, 5472
    v_mul_u32_u24 v24, 3641, v1
    v_lshrrev_b32 v204, 16, v24
    v_mad_u32_u24 v204, v204, s76, v25
    v_add_u32 v24, 233024, v24
    v_lshrrev_b32 v205, 16, v24
    v_mad_u32_u24 v205, v205, s76, v25
    v_add_u32 v24, 233024, v24
    v_lshrrev_b32 v206, 16, v24
    v_mad_u32_u24 v206, v206, s76, v25
    v_add_u32 v24, 233024, v24
    v_lshrrev_b32 v207, 16, v24
    v_mad_u32_u24 v207, v207, s76, v25
    v_add_u32 v24, 233024, v24
    v_lshrrev_b32 v208, 16, v24
    v_mad_u32_u24 v208, v208, s76, v27
    v_add_u32 v24, 233024, v24
    v_lshrrev_b32 v209, 16, v24
    v_mad_u32_u24 v209, v209, s76, v26
    v_add_u32 v24, 233024, v24
    v_lshrrev_b32 v210, 16, v24
    v_mad_u32_u24 v210, v210, s76, v26
    v_add_u32 v24, 233024, v24
    v_lshrrev_b32 v211, 16, v24
    v_mad_u32_u24 v211, v211, s76, v26
    v_add_u32 v24, 233024, v24
    v_lshrrev_b32 v212, 16, v24
    v_mad_u32_u24 v212, v212, s76, v28
    s_mov_b32 m0, 116608
    s_nop 0
    buffer_load_dwordx4 v204, s[28:31], 0 offen offset:0 lds
    buffer_load_dwordx4 v205, s[28:31], 0 offen offset:1024 lds
    buffer_load_dwordx4 v206, s[28:31], 0 offen offset:2048 lds
    buffer_load_dwordx4 v207, s[28:31], 0 offen offset:3072 lds
    s_mov_b32 m0, 120704
    s_nop 0
    buffer_load_dwordx4 v208, s[28:31], 0 offen offset:0 lds
    buffer_load_dwordx4 v209, s[28:31], 0 offen offset:1024 lds
    buffer_load_dwordx4 v210, s[28:31], 0 offen offset:2048 lds
    buffer_load_dwordx4 v211, s[28:31], 0 offen offset:3072 lds
    s_mov_b32 m0, 124800
    s_nop 0
    buffer_load_dwordx4 v212, s[28:31], 0 offen offset:0 lds
L_nostage1:
    s_mul_i32 s70, s3, 320
    s_add_u32 s70, s70, 115328
    v_lshl_add_u32 v19, v19, 1, s70
    s_mov_b64 s[32:33], s[22:23]
    s_mov_b32 s34, 5242880
    s_mov_b32 s35, 0x20000
    s_mov_b64 s[36:37], s[26:27]
    s_mov_b32 s38, 17825792
    s_mov_b32 s39, 0x20000
    s_mov_b32 s64, 0xbfb8aa3b
    s_mul_i32 s70, s48, 34
    s_add_u32 s70, s70, s49
    s_lshl_b32 s70, s70, 8
    s_add_u32 s61, s70, 262144
    v_and_b32 v15, 0x30, v1
    v_add_u32 v15, 115328, v15
    s_add_u32 s20, s26, 6287360
    s_addc_u32 s21, s27, 0
    s_mov_b32 s22, 5246976
    s_mov_b32 s23, 0x20000
    s_lshl_b32 s70, s50, 2
    s_add_u32 s70, s70, s3
    s_mul_i32 s55, s70, 307200
    s_add_u32 s55, s55, 1048576
    s_mov_b32 s24, s55
    s_lshl_b32 s65, s50, 13
    s_add_u32 s65, s65, 131072
    v_min_u32 v254, 61, v1
    v_lshlrev_b32 v254, 6, v254
    s_cmp_eq_u32 s3, 1
    s_cselect_b32 s72, 0, 0x40000000
    v_or_b32 v254, s72, v254
    v_mov_b32 v20, 0
    v_mov_b32 v21, 0
    v_and_b32 v24, 15, v1
    v_bfe_u32 v25, v1, 4, 1
    v_lshrrev_b32 v26, 5, v1
    v_lshlrev_b32 v27, 5, v25
    v_lshl_add_u32 v27, v26, 4, v27
    v_lshl_add_u32 v3, v24, 13, v27
    s_lshl_b32 s73, s3, 6
    s_add_u32 s73, s73, 33344
    v_mul_u32_u24 v28, 288, v24
    v_add3_u32 v250, v28, v27, s73
    v_lshlrev_b32 v27, 5, v24
    v_lshl_add_u32 v4, v25, 9, v27
    v_lshl_add_u32 v4, v26, 4, v4
    v_lshl_add_u32 v25, v24, 1, v25
    v_lshl_add_u32 v25, v26, 5, v25
    v_mul_u32_u24 v25, 144, v25
    v_add_u32 v252, 116608, v25
    v_lshrrev_b32 v25, 2, v1
    v_mul_u32_u24 v25, 288, v25
    v_and_b32 v26, 24, v17
    v_add3_u32 v249, v25, v26, s73
    s_mul_i32 s73, s3, 1152
    s_add_u32 s73, s73, 33344
    v_lshrrev_b32 v25, 4, v1
    v_mul_u32_u24 v25, 288, v25
    v_lshlrev_b32 v24, 4, v24
    v_add3_u32 v248, v25, v24, s73
    s_lshl_b32 s70, s3, 10
    s_add_u32 s70, s70, 33344
    v_add_u32 v13, s70, v4
    s_lshl_b32 s70, s51, 6
    s_cmp_eq_u32 s3, 1
    s_cselect_b32 s70, s70, 0x40000000
    v_mov_b32 v247, 0x40000000
    s_mov_b64 exec, 0xff
    v_add_u32 v247, s70, v17
    s_mov_b64 exec, -1
    s_lshl_b32 s70, s50, 6
    s_cmp_eq_u32 s3, 0
    s_cselect_b32 s70, s70, 0x40000000
    v_mov_b32 v16, 0x40000000
    v_writelane_b32 v16, s70, 0
    s_bitcmp1_b32 s3, 0
    s_cselect_b32 s70, s64, 1.0
    v_mov_b32 v204, 0
    v_mov_b32 v205, 0
    v_mov_b32 v206, 0
    v_mov_b32 v207, 0
    v_mov_b32 v208, 0
    v_mov_b32 v209, 0
    v_mov_b32 v210, 0
    v_mov_b32 v211, 0
    v_mov_b32 v212, 0
    s_mov_b32 s77, s70
    s_cmp_lg_u32 s68, 2
    s_cbranch_scc1 L_noaddr2
    s_mul_i32 s70, s51, 205
    s_lshr_b32 s70, s70, 11
    s_mul_i32 s71, s70, 10
    s_sub_u32 s71, s51, s71
    s_lshl_b32 s72, s71, 1
    s_mov_b32 s58, 3885033360
    s_mov_b32 s59, 57
    s_lshl_b32 s73, s72, 1
    s_lshr_b64 s[58:59], s[58:59], s73
    s_add_u32 s73, s58, s50
    s_and_b32 s73, s73, 3
    s_mul_i32 s73, s73, 5
    s_mov_b32 s58, 2586083336
    s_mov_b32 s59, 153382308
    s_mul_i32 vcc_lo, s72, 3
    s_lshr_b64 s[58:59], s[58:59], vcc_lo
    s_and_b32 s58, s58, 7
    s_add_u32 s73, s73, s58
    s_add_u32 s72, s72, 1
    s_mov_b32 s58, 3885033360
    s_mov_b32 s59, 57
    s_lshl_b32 s74, s72, 1
    s_lshr_b64 s[58:59], s[58:59], s74
    s_add_u32 s74, s58, s50
    s_and_b32 s74, s74, 3
    s_mul_i32 s74, s74, 5
    s_mov_b32 s58, 2586083336
    s_mov_b32 s59, 153382308
    s_mul_i32 vcc_lo, s72, 3
    s_lshr_b64 s[58:59], s[58:59], vcc_lo
    s_and_b32 s58, s58, 7
    s_add_u32 s74, s74, s58
    s_mul_i32 s75, s50, 5
    s_add_u32 s72, s75, s70
    s_mul_i32 s72, s72, 92160
    s_sub_u32 s74, s74, s73
    s_mul_i32 s73, s73, 288
    s_mul_i32 s74, s74, 288
    s_add_u32 s73, s73, s72
    s_sub_u32 s74, s74, 88064
    v_add_u32 v25, s73, v2
    v_add_u32 v26, s74, v25
    v_add_u32 v27, 4096, v25
    s_mov_b32 exec_lo, 0
    v_mov_b32 v27, v26
    s_mov_b32 exec_lo, -1
    v_add_u32 v28, 4096, v26
    s_mov_b32 s76, 5472
    v_mul_u32_u24 v24, 3641, v1
    v_lshrrev_b32 v204, 16, v24
    v_mad_u32_u24 v204, v204, s76, v25
    v_add_u32 v24, 233024, v24
    v_lshrrev_b32 v205, 16, v24
    v_mad_u32_u24 v205, v205, s76, v25
    v_add_u32 v24, 233024, v24
    v_lshrrev_b32 v206, 16, v24
    v_mad_u32_u24 v206, v206, s76, v25
    v_add_u32 v24, 233024, v24
    v_lshrrev_b32 v207, 16, v24
    v_mad_u32_u24 v207, v207, s76, v25
    v_add_u32 v24, 233024, v24
    v_lshrrev_b32 v208, 16, v24
    v_mad_u32_u24 v208, v208, s76, v27
    v_add_u32 v24, 233024, v24
    v_lshrrev_b32 v209, 16, v24
    v_mad_u32_u24 v209, v209, s76, v26
    v_add_u32 v24, 233024, v24
    v_lshrrev_b32 v210, 16, v24
    v_mad_u32_u24 v210, v210, s76, v26
    v_add_u32 v24, 233024, v24
    v_lshrrev_b32 v211, 16, v24
    v_mad_u32_u24 v211, v211, s76, v26
    v_add_u32 v24, 233024, v24
    v_lshrrev_b32 v212, 16, v24
    v_mad_u32_u24 v212, v212, s76, v28
    s_mov_b32 m0, 125824
    s_nop 0
    buffer_load_dwordx4 v204, s[28:31], 0 offen offset:0 lds
    buffer_load_dwordx4 v205, s[28:31], 0 offen offset:1024 lds
    buffer_load_dwordx4 v206, s[28:31], 0 offen offset:2048 lds
    buffer_load_dwordx4 v207, s[28:31], 0 offen offset:3072 lds
    s_mov_b32 m0, 129920
    s_nop 0
    buffer_load_dwordx4 v208, s[28:31], 0 offen offset:0 lds
    buffer_load_dwordx4 v209, s[28:31], 0 offen offset:1024 lds
    buffer_load_dwordx4 v210, s[28:31], 0 offen offset:2048 lds
    buffer_load_dwordx4 v211, s[28:31], 0 offen offset:3072 lds
    s_mov_b32 m0, 134016
    s_nop 0
    buffer_load_dwordx4 v212, s[28:31], 0 offen offset:0 lds
L_noaddr2:
    s_mov_b32 s70, s77
    s_cmp_lg_u32 s3, 3
    s_cbranch_scc1 L_nohop0
    s_mov_b64 exec, 0
    s_branch L_chain0
L_back0:
    s_mov_b64 exec, -1
L_nohop0:
    s_cmp_lg_u32 s3, 0
    s_cbranch_scc1 L_nohop1
    s_mov_b64 exec, 0
    s_branch L_chain1
L_back1:
    s_mov_b64 exec, -1
L_nohop1:
    s_waitcnt vmcnt(14)
    s_cmp_eq_u32 s68, 2
    s_cbranch_scc1 L_waitp_done
    s_cmp_eq_u32 s68, 1
    s_cbranch_scc1 L_waitp_done
    s_waitcnt vmcnt(11)
    s_cmp_eq_u32 s68, 3
    s_cbranch_scc1 L_waitp_done
    s_waitcnt vmcnt(5)
L_waitp_done:
    v_lshlrev_b32 v26, 16, v18
    v_and_b32 v27, 0xffff0000, v18
    v_mul_f32 v26, s70, v26
    v_mul_f32 v27, s70, v27
    v_mov_b32 v25, 0x3f803f80
    ds_write_b64 v19, v[26:27]
    s_waitcnt lgkmcnt(0)
    s_add_u32 s52, s52, 1
    s_addc_u32 s53, s53, 0
    v_mov_b32 v22, s52
    v_mov_b32 v23, s53
    s_branch L_cut
.p2align 12
L_chain0:
L_page0:
    s_cbranch_execz L_page1
L_cut:
    s_waitcnt vmcnt(9)
    s_cmp_eq_u32 s68, 2
    s_cbranch_scc1 L_waitx_done
    s_cmp_eq_u32 s68, 1
    s_cbranch_scc1 L_waitx_done
    s_waitcnt vmcnt(6)
    s_cmp_eq_u32 s68, 3
    s_cbranch_scc1 L_waitx_done
    s_waitcnt vmcnt(0)
L_waitx_done:
    v_dot2c_f32_bf16 v20, v136, v25
    v_dot2c_f32_bf16 v21, v136, v136
    v_dot2c_f32_bf16 v20, v137, v25
    v_dot2c_f32_bf16 v21, v137, v137
    v_dot2c_f32_bf16 v20, v138, v25
    v_dot2c_f32_bf16 v21, v138, v138
    v_dot2c_f32_bf16 v20, v139, v25
    v_dot2c_f32_bf16 v21, v139, v139
    v_dot2c_f32_bf16 v20, v140, v25
    v_dot2c_f32_bf16 v21, v140, v140
    v_dot2c_f32_bf16 v20, v141, v25
    v_dot2c_f32_bf16 v21, v141, v141
    v_dot2c_f32_bf16 v20, v142, v25
    v_dot2c_f32_bf16 v21, v142, v142
    v_dot2c_f32_bf16 v20, v143, v25
    v_dot2c_f32_bf16 v21, v143, v143
    v_dot2c_f32_bf16 v20, v144, v25
    v_dot2c_f32_bf16 v21, v144, v144
    v_dot2c_f32_bf16 v20, v145, v25
    v_dot2c_f32_bf16 v21, v145, v145
    v_dot2c_f32_bf16 v20, v146, v25
    v_dot2c_f32_bf16 v21, v146, v146
    v_dot2c_f32_bf16 v20, v147, v25
    v_dot2c_f32_bf16 v21, v147, v147
    v_dot2c_f32_bf16 v20, v148, v25
    v_dot2c_f32_bf16 v21, v148, v148
    v_dot2c_f32_bf16 v20, v149, v25
    v_dot2c_f32_bf16 v21, v149, v149
    v_dot2c_f32_bf16 v20, v150, v25
    v_dot2c_f32_bf16 v21, v150, v150
    v_dot2c_f32_bf16 v20, v151, v25
    v_dot2c_f32_bf16 v21, v151, v151
    v_dot2c_f32_bf16 v20, v152, v25
    v_dot2c_f32_bf16 v21, v152, v152
    v_dot2c_f32_bf16 v20, v153, v25
    v_dot2c_f32_bf16 v21, v153, v153
    v_dot2c_f32_bf16 v20, v154, v25
    v_dot2c_f32_bf16 v21, v154, v154
    v_dot2c_f32_bf16 v20, v155, v25
    v_dot2c_f32_bf16 v21, v155, v155
    s_nop 1
    s_lshl_b32 s70, s3, 3
    v_add_f32_dpp v20, v20, v20 row_shr:1 row_mask:0xf bank_mask:0xf bound_ctrl:0
    v_add_f32_dpp v21, v21, v21 row_shr:1 row_mask:0xf bank_mask:0xf bound_ctrl:0
    s_add_u32 s70, s70, 115264
    v_add_f32_dpp v20, v20, v20 row_shr:2 row_mask:0xf bank_mask:0xf bound_ctrl:0
    v_add_f32_dpp v21, v21, v21 row_shr:2 row_mask:0xf bank_mask:0xf bound_ctrl:0
    v_mov_b32 v29, s70
    v_add_f32_dpp v20, v20, v20 row_shr:4 row_mask:0xf bank_mask:0xf bound_ctrl:0
    v_add_f32_dpp v21, v21, v21 row_shr:4 row_mask:0xf bank_mask:0xf bound_ctrl:0
    s_lshl_b32 s70, s49, 4
    v_add_f32_dpp v20, v20, v20 row_shr:8 row_mask:0xf bank_mask:0xf bound_ctrl:0
    v_add_f32_dpp v21, v21, v21 row_shr:8 row_mask:0xf bank_mask:0xf bound_ctrl:0
    s_add_u32 s70, s70, s69
    v_add_f32_dpp v20, v20, v20 row_bcast:15 row_mask:0xa bank_mask:0xf
    v_add_f32_dpp v21, v21, v21 row_bcast:15 row_mask:0xa bank_mask:0xf
    s_nop 0
    v_add_f32_dpp v20, v20, v20 row_bcast:31 row_mask:0xc bank_mask:0xf
    v_add_f32_dpp v21, v21, v21 row_bcast:31 row_mask:0xc bank_mask:0xf
    s_mov_b32 exec_lo, 0
    s_mov_b32 exec_hi, 0x80000000
    ds_write_b64 v29, v[20:21]
    s_mov_b64 exec, -1
    s_cmp_lg_u32 s3, 0
    s_waitcnt lgkmcnt(0)
    s_barrier
    s_cbranch_scc1 L_nopub0
    ds_read_b128 v[24:27], v29 offset:16
    ds_read_b128 v[28:31], v29
    s_add_u32 s70, s70, 0
    s_mov_b64 exec, 1
    s_waitcnt lgkmcnt(0)
    v_pk_add_f32 v[24:25], v[24:25], v[26:27]
    v_pk_add_f32 v[28:29], v[28:29], v[30:31]
    v_pk_add_f32 v[20:21], v[24:25], v[28:29]
    buffer_store_dwordx4 v[20:23], v2, s[36:39], s70 offen sc1
    s_mov_b64 exec, -1
L_nopub0:
    ds_write_b128 v248, v[136:139] offset:0
    ds_write_b128 v248, v[140:143] offset:4608
    ds_write_b128 v248, v[144:147] offset:9216
    ds_write_b128 v248, v[148:151] offset:13824
    ds_write_b128 v248, v[152:155] offset:18432
    s_mul_i32 s70, s51, 205
    s_lshr_b32 s70, s70, 11
    s_mul_i32 s71, s70, 10
    s_sub_u32 s71, s51, s71
    s_mul_i32 s72, s71, 5
    s_add_u32 s72, s72, s70
    s_lshl_b32 s70, s70, 1
    s_add_u32 s70, s70, s71
    s_add_u32 s70, s70, 32
    s_cmp_ge_u32 s71, 8
    s_cselect_b32 s70, s70, s72
    s_mul_i32 s70, s70, 3072
    s_mul_i32 s71, s50, 1228800
    s_add_u32 s70, s70, s71
    s_add_u32 s70, s70, 1048576
    s_add_u32 s71, s70, 307200
    s_add_u32 s72, s70, 614400
    s_add_u32 s73, s70, 921600
    s_mov_b32 s74, 0x07060100
    s_mov_b32 s75, 0x05040302
    s_cmp_lt_u32 s51, 50
    s_cselect_b32 s77, s3, 0
    s_cmp_lg_u32 s68, 1
    s_cbranch_scc1 L_nowaitw
    s_waitcnt vmcnt(0)
L_nowaitw:
    s_waitcnt lgkmcnt(0)
    s_barrier
    s_cmp_lg_u32 s77, 0
    s_cbranch_scc1 L_role1_w1
    s_cmp_eq_u32 s68, 3
    s_cbranch_scc1 L_role1_e
    s_cmp_lg_u32 s3, 0
    s_cbranch_scc1 L_wdone0
    v_not_b32 v18, v22
    v_mov_b32 v19, v23
    s_lshl_b32 s70, s50, 6
    s_add_u32 s70, s70, s61
    v_lshrrev_b32 v24, 3, v1
    v_mul_u32_u24 v24, 32704, v24
    v_add_u32 v24, v24, v17
    s_mov_b32 exec_hi, 0
    buffer_store_dwordx2 v[18:19], v24, s[36:39], s70 offen offset:256 sc1
    s_mov_b64 exec, -1
    s_branch L_wdone0
L_role1_e:
    s_waitcnt vmcnt(0)
    v_lshrrev_b32 v24, 4, v1
    v_bfe_u32 v25, v1, 2, 2
    v_lshl_add_u32 v24, v24, 3, v25
    v_mul_u32_u24 v24, 160, v24
    v_and_b32 v25, 3, v1
    v_lshlrev_b32 v25, 3, v25
    v_add_u32 v24, v24, v25
    v_add_u32 v24, 116608, v24
    ds_read_b64_tr_b16 v[220:221], v24 offset:0
    ds_read_b64_tr_b16 v[222:223], v24 offset:640
    ds_read_b64_tr_b16 v[224:225], v24 offset:32
    ds_read_b64_tr_b16 v[226:227], v24 offset:672
    ds_read_b64_tr_b16 v[228:229], v24 offset:64
    ds_read_b64_tr_b16 v[230:231], v24 offset:704
    ds_read_b64_tr_b16 v[232:233], v24 offset:96
    ds_read_b64_tr_b16 v[234:235], v24 offset:736
    ds_read_b64_tr_b16 v[236:237], v24 offset:128
    ds_read_b64_tr_b16 v[238:239], v24 offset:768
    v_lshlrev_b32 v92, 16, v216
    v_and_b32 v93, 0xffff0000, v216
    v_lshlrev_b32 v94, 16, v217
    v_and_b32 v95, 0xffff0000, v217
    v_lshlrev_b32 v96, 16, v218
    v_and_b32 v97, 0xffff0000, v218
    v_lshlrev_b32 v98, 16, v219
    v_and_b32 v99, 0xffff0000, v219
    v_mul_f32 v92, s64, v92
    v_mul_f32 v93, s64, v93
    v_mul_f32 v94, s64, v94
    v_mul_f32 v95, s64, v95
    v_mul_f32 v96, s64, v96
    v_mul_f32 v97, s64, v97
    v_mul_f32 v98, s64, v98
    v_mul_f32 v99, s64, v99
    v_exp_f32 v100, v92
    v_exp_f32 v101, v93
    v_exp_f32 v102, v94
    v_exp_f32 v103, v95
    v_exp_f32 v104, v96
    v_exp_f32 v105, v97
    v_exp_f32 v106, v98
    v_exp_f32 v107, v99
    v_fma_f32 v100, v100, s64, s64
    v_fma_f32 v101, v101, s64, s64
    v_fma_f32 v102, v102, s64, s64
    v_fma_f32 v103, v103, s64, s64
    v_fma_f32 v104, v104, s64, s64
    v_fma_f32 v105, v105, s64, s64
    v_fma_f32 v106, v106, s64, s64
    v_fma_f32 v107, v107, s64, s64
    v_rcp_f32 v100, v100
    v_rcp_f32 v101, v101
    v_rcp_f32 v102, v102
    v_rcp_f32 v103, v103
    v_rcp_f32 v104, v104
    v_rcp_f32 v105, v105
    v_rcp_f32 v106, v106
    v_rcp_f32 v107, v107
    v_mul_f32 v92, v92, v100
    v_mul_f32 v93, v93, v101
    v_mul_f32 v94, v94, v102
    v_mul_f32 v95, v95, v103
    v_mul_f32 v96, v96, v104
    v_mul_f32 v97, v97, v105
    v_mul_f32 v98, v98, v106
    v_mul_f32 v99, v99, v107
    v_cvt_pk_bf16_f32 v100, v92, v93
    v_cvt_pk_bf16_f32 v101, v94, v95
    v_cvt_pk_bf16_f32 v102, v96, v97
    v_cvt_pk_bf16_f32 v103, v98, v99
    s_sub_u32 s70, s51, 50
    s_mul_i32 s70, s70, 2560
    s_waitcnt lgkmcnt(0)
    v_mfma_f32_16x16x32_bf16 v[108:111], v[100:103], v[220:223], 0
    v_mfma_f32_16x16x32_bf16 v[112:115], v[100:103], v[224:227], 0
    v_mfma_f32_16x16x32_bf16 v[116:119], v[100:103], v[228:231], 0
    v_mfma_f32_16x16x32_bf16 v[120:123], v[100:103], v[232:235], 0
    v_mfma_f32_16x16x32_bf16 v[124:127], v[100:103], v[236:239], 0
    s_mul_i32 s71, s50, 320
    s_add_u32 s70, s70, s71
    s_add_u32 s70, s70, 196608
    v_lshlrev_b32 v24, 2, v1
    s_nop 1
    v_mov_b32 v92, v108
    v_mov_b32 v96, v109
    v_mov_b32 v93, v112
    v_mov_b32 v97, v113
    v_mov_b32 v94, v116
    v_mov_b32 v98, v117
    v_mov_b32 v95, v120
    v_mov_b32 v99, v121
    s_mov_b64 exec, 0xffff
    buffer_store_dwordx4 v[92:95], v2, s[36:39], s70 offen offset:0 sc1
    buffer_store_dword v124, v24, s[36:39], s70 offen offset:256 sc1
    buffer_store_dwordx4 v[96:99], v2, s[36:39], s70 offen offset:1280 sc1
    buffer_store_dword v125, v24, s[36:39], s70 offen offset:1536 sc1
    s_mov_b64 exec, -1
    s_branch L_wdone0
L_role1_w1:
    ds_read_b128 v[204:207], v252 offset:0
    ds_read_b128 v[208:211], v252 offset:16
    ds_read_b128 v[212:215], v252 offset:32
    ds_read_b128 v[216:219], v252 offset:48
    ds_read_b128 v[220:223], v252 offset:64
    ds_read_b128 v[224:227], v252 offset:80
    ds_read_b128 v[228:231], v252 offset:96
    ds_read_b128 v[232:235], v252 offset:112
    ds_read_b128 v[236:239], v252 offset:128
    s_waitcnt lgkmcnt(0)
    s_cmp_eq_u32 s77, 0
    s_cbranch_scc1 L_w1_done
    s_cmp_lg_u32 s77, 1
    s_cbranch_scc1 L_w1_1
    v_lshlrev_b32 v108, 16, v204
    v_and_b32 v109, 0xffff0000, v208
    v_and_b32 v110, 0xffff0000, v205
    v_lshlrev_b32 v111, 16, v210
    v_lshlrev_b32 v112, 16, v207
    v_and_b32 v113, 0xffff0000, v211
    v_perm_b32 v92, v208, v204, s74
    v_perm_b32 v104, v211, v207, s74
    v_pk_add_f32 v[108:109], v[108:109], v[112:113]
    v_pk_add_f32 v[114:115], v[108:109], v[110:111]
    v_pk_add_f32 v[116:117], v[108:109], v[110:111] neg_lo:[0,1] neg_hi:[0,1]
    v_cvt_pk_bf16_f32 v96, v114, v115
    v_cvt_pk_bf16_f32 v100, v116, v117
    v_lshlrev_b32 v108, 16, v213
    v_and_b32 v109, 0xffff0000, v217
    v_and_b32 v110, 0xffff0000, v214
    v_lshlrev_b32 v111, 16, v219
    v_lshlrev_b32 v112, 16, v216
    v_and_b32 v113, 0xffff0000, v220
    v_perm_b32 v93, v217, v213, s74
    v_perm_b32 v105, v220, v216, s74
    v_pk_add_f32 v[108:109], v[108:109], v[112:113]
    v_pk_add_f32 v[114:115], v[108:109], v[110:111]
    v_pk_add_f32 v[116:117], v[108:109], v[110:111] neg_lo:[0,1] neg_hi:[0,1]
    v_cvt_pk_bf16_f32 v97, v114, v115
    v_cvt_pk_bf16_f32 v101, v116, v117
    v_lshlrev_b32 v108, 16, v222
    v_and_b32 v109, 0xffff0000, v226
    v_and_b32 v110, 0xffff0000, v223
    v_lshlrev_b32 v111, 16, v228
    v_lshlrev_b32 v112, 16, v225
    v_and_b32 v113, 0xffff0000, v229
    v_perm_b32 v94, v226, v222, s74
    v_perm_b32 v106, v229, v225, s74
    v_pk_add_f32 v[108:109], v[108:109], v[112:113]
    v_pk_add_f32 v[114:115], v[108:109], v[110:111]
    v_pk_add_f32 v[116:117], v[108:109], v[110:111] neg_lo:[0,1] neg_hi:[0,1]
    v_cvt_pk_bf16_f32 v98, v114, v115
    v_cvt_pk_bf16_f32 v102, v116, v117
    v_lshlrev_b32 v108, 16, v231
    v_and_b32 v109, 0xffff0000, v235
    v_and_b32 v110, 0xffff0000, v232
    v_lshlrev_b32 v111, 16, v237
    v_lshlrev_b32 v112, 16, v234
    v_and_b32 v113, 0xffff0000, v238
    v_perm_b32 v95, v235, v231, s74
    v_perm_b32 v107, v238, v234, s74
    v_pk_add_f32 v[108:109], v[108:109], v[112:113]
    v_pk_add_f32 v[114:115], v[108:109], v[110:111]
    v_pk_add_f32 v[116:117], v[108:109], v[110:111] neg_lo:[0,1] neg_hi:[0,1]
    v_cvt_pk_bf16_f32 v99, v114, v115
    v_cvt_pk_bf16_f32 v103, v116, v117
    buffer_store_dwordx4 v[92:95], v2, s[36:39], s70 offen offset:0 sc1
    buffer_store_dwordx4 v[96:99], v2, s[36:39], s71 offen offset:0 sc1
    buffer_store_dwordx4 v[100:103], v2, s[36:39], s72 offen offset:0 sc1
    buffer_store_dwordx4 v[104:107], v2, s[36:39], s73 offen offset:0 sc1
    s_branch L_w1_done
L_w1_1:
    s_cmp_lg_u32 s77, 2
    s_cbranch_scc1 L_w1_2
    v_and_b32 v108, 0xffff0000, v204
    v_lshlrev_b32 v109, 16, v209
    v_lshlrev_b32 v110, 16, v206
    v_and_b32 v111, 0xffff0000, v210
    v_and_b32 v112, 0xffff0000, v207
    v_lshlrev_b32 v113, 16, v212
    v_perm_b32 v92, v209, v204, s75
    v_perm_b32 v104, v212, v207, s75
    v_pk_add_f32 v[108:109], v[108:109], v[112:113]
    v_pk_add_f32 v[114:115], v[108:109], v[110:111]
    v_pk_add_f32 v[116:117], v[108:109], v[110:111] neg_lo:[0,1] neg_hi:[0,1]
    v_cvt_pk_bf16_f32 v96, v114, v115
    v_cvt_pk_bf16_f32 v100, v116, v117
    v_and_b32 v108, 0xffff0000, v213
    v_lshlrev_b32 v109, 16, v218
    v_lshlrev_b32 v110, 16, v215
    v_and_b32 v111, 0xffff0000, v219
    v_and_b32 v112, 0xffff0000, v216
    v_lshlrev_b32 v113, 16, v221
    v_perm_b32 v93, v218, v213, s75
    v_perm_b32 v105, v221, v216, s75
    v_pk_add_f32 v[108:109], v[108:109], v[112:113]
    v_pk_add_f32 v[114:115], v[108:109], v[110:111]
    v_pk_add_f32 v[116:117], v[108:109], v[110:111] neg_lo:[0,1] neg_hi:[0,1]
    v_cvt_pk_bf16_f32 v97, v114, v115
    v_cvt_pk_bf16_f32 v101, v116, v117
    v_and_b32 v108, 0xffff0000, v222
    v_lshlrev_b32 v109, 16, v227
    v_lshlrev_b32 v110, 16, v224
    v_and_b32 v111, 0xffff0000, v228
    v_and_b32 v112, 0xffff0000, v225
    v_lshlrev_b32 v113, 16, v230
    v_perm_b32 v94, v227, v222, s75
    v_perm_b32 v106, v230, v225, s75
    v_pk_add_f32 v[108:109], v[108:109], v[112:113]
    v_pk_add_f32 v[114:115], v[108:109], v[110:111]
    v_pk_add_f32 v[116:117], v[108:109], v[110:111] neg_lo:[0,1] neg_hi:[0,1]
    v_cvt_pk_bf16_f32 v98, v114, v115
    v_cvt_pk_bf16_f32 v102, v116, v117
    v_and_b32 v108, 0xffff0000, v231
    v_lshlrev_b32 v109, 16, v236
    v_lshlrev_b32 v110, 16, v233
    v_and_b32 v111, 0xffff0000, v237
    v_and_b32 v112, 0xffff0000, v234
    v_lshlrev_b32 v113, 16, v239
    v_perm_b32 v95, v236, v231, s75
    v_perm_b32 v107, v239, v234, s75
    v_pk_add_f32 v[108:109], v[108:109], v[112:113]
    v_pk_add_f32 v[114:115], v[108:109], v[110:111]
    v_pk_add_f32 v[116:117], v[108:109], v[110:111] neg_lo:[0,1] neg_hi:[0,1]
    v_cvt_pk_bf16_f32 v99, v114, v115
    v_cvt_pk_bf16_f32 v103, v116, v117
    buffer_store_dwordx4 v[92:95], v2, s[36:39], s70 offen offset:1024 sc1
    buffer_store_dwordx4 v[96:99], v2, s[36:39], s71 offen offset:1024 sc1
    buffer_store_dwordx4 v[100:103], v2, s[36:39], s72 offen offset:1024 sc1
    buffer_store_dwordx4 v[104:107], v2, s[36:39], s73 offen offset:1024 sc1
    s_branch L_w1_done
L_w1_2:
    v_lshlrev_b32 v108, 16, v205
    v_and_b32 v109, 0xffff0000, v209
    v_and_b32 v110, 0xffff0000, v206
    v_lshlrev_b32 v111, 16, v211
    v_lshlrev_b32 v112, 16, v208
    v_and_b32 v113, 0xffff0000, v212
    v_perm_b32 v92, v209, v205, s74
    v_perm_b32 v104, v212, v208, s74
    v_pk_add_f32 v[108:109], v[108:109], v[112:113]
    v_pk_add_f32 v[114:115], v[108:109], v[110:111]
    v_pk_add_f32 v[116:117], v[108:109], v[110:111] neg_lo:[0,1] neg_hi:[0,1]
    v_cvt_pk_bf16_f32 v96, v114, v115
    v_cvt_pk_bf16_f32 v100, v116, v117
    v_lshlrev_b32 v108, 16, v214
    v_and_b32 v109, 0xffff0000, v218
    v_and_b32 v110, 0xffff0000, v215
    v_lshlrev_b32 v111, 16, v220
    v_lshlrev_b32 v112, 16, v217
    v_and_b32 v113, 0xffff0000, v221
    v_perm_b32 v93, v218, v214, s74
    v_perm_b32 v105, v221, v217, s74
    v_pk_add_f32 v[108:109], v[108:109], v[112:113]
    v_pk_add_f32 v[114:115], v[108:109], v[110:111]
    v_pk_add_f32 v[116:117], v[108:109], v[110:111] neg_lo:[0,1] neg_hi:[0,1]
    v_cvt_pk_bf16_f32 v97, v114, v115
    v_cvt_pk_bf16_f32 v101, v116, v117
    v_lshlrev_b32 v108, 16, v223
    v_and_b32 v109, 0xffff0000, v227
    v_and_b32 v110, 0xffff0000, v224
    v_lshlrev_b32 v111, 16, v229
    v_lshlrev_b32 v112, 16, v226
    v_and_b32 v113, 0xffff0000, v230
    v_perm_b32 v94, v227, v223, s74
    v_perm_b32 v106, v230, v226, s74
    v_pk_add_f32 v[108:109], v[108:109], v[112:113]
    v_pk_add_f32 v[114:115], v[108:109], v[110:111]
    v_pk_add_f32 v[116:117], v[108:109], v[110:111] neg_lo:[0,1] neg_hi:[0,1]
    v_cvt_pk_bf16_f32 v98, v114, v115
    v_cvt_pk_bf16_f32 v102, v116, v117
    v_lshlrev_b32 v108, 16, v232
    v_and_b32 v109, 0xffff0000, v236
    v_and_b32 v110, 0xffff0000, v233
    v_lshlrev_b32 v111, 16, v238
    v_lshlrev_b32 v112, 16, v235
    v_and_b32 v113, 0xffff0000, v239
    v_perm_b32 v95, v236, v232, s74
    v_perm_b32 v107, v239, v235, s74
    v_pk_add_f32 v[108:109], v[108:109], v[112:113]
    v_pk_add_f32 v[114:115], v[108:109], v[110:111]
    v_pk_add_f32 v[116:117], v[108:109], v[110:111] neg_lo:[0,1] neg_hi:[0,1]
    v_cvt_pk_bf16_f32 v99, v114, v115
    v_cvt_pk_bf16_f32 v103, v116, v117
    buffer_store_dwordx4 v[92:95], v2, s[36:39], s70 offen offset:2048 sc1
    buffer_store_dwordx4 v[96:99], v2, s[36:39], s71 offen offset:2048 sc1
    buffer_store_dwordx4 v[100:103], v2, s[36:39], s72 offen offset:2048 sc1
    buffer_store_dwordx4 v[104:107], v2, s[36:39], s73 offen offset:2048 sc1
L_w1_done:
L_wdone0:
    ds_read_b64_tr_b16 v[132:133], v249 offset:0
    ds_read_b64_tr_b16 v[134:135], v249 offset:4608
    ds_read_b64_tr_b16 v[136:137], v249 offset:9216
    ds_read_b64_tr_b16 v[138:139], v249 offset:13824
    ds_read_b64_tr_b16 v[140:141], v249 offset:18432
    ds_read_b64_tr_b16 v[142:143], v249 offset:32
    ds_read_b64_tr_b16 v[144:145], v249 offset:4640
    ds_read_b64_tr_b16 v[146:147], v249 offset:9248
    ds_read_b64_tr_b16 v[148:149], v249 offset:13856
    ds_read_b64_tr_b16 v[150:151], v249 offset:18464
    ds_read_b128 v[156:159], v15 offset:0
    ds_read_b128 v[160:163], v15 offset:64
    ds_read_b128 v[164:167], v15 offset:128
    ds_read_b128 v[168:171], v15 offset:192
    ds_read_b128 v[172:175], v15 offset:256
    ds_read_b128 v[176:179], v15 offset:320
    ds_read_b128 v[180:183], v15 offset:384
    ds_read_b128 v[184:187], v15 offset:448
    ds_read_b128 v[188:191], v15 offset:512
    ds_read_b128 v[192:195], v15 offset:576
    s_waitcnt lgkmcnt(14)
    v_lshlrev_b32 v32, 16, v132
    v_and_b32 v33, 0xffff0000, v132
    v_lshlrev_b32 v34, 16, v133
    v_and_b32 v35, 0xffff0000, v133
    v_lshlrev_b32 v36, 16, v134
    v_and_b32 v37, 0xffff0000, v134
    v_lshlrev_b32 v38, 16, v135
    v_and_b32 v39, 0xffff0000, v135
    v_lshlrev_b32 v40, 16, v136
    v_and_b32 v41, 0xffff0000, v136
    v_lshlrev_b32 v42, 16, v137
    v_and_b32 v43, 0xffff0000, v137
    v_lshlrev_b32 v44, 16, v138
    v_and_b32 v45, 0xffff0000, v138
    v_lshlrev_b32 v46, 16, v139
    v_and_b32 v47, 0xffff0000, v139
    v_lshlrev_b32 v48, 16, v140
    v_and_b32 v49, 0xffff0000, v140
    v_lshlrev_b32 v50, 16, v141
    v_and_b32 v51, 0xffff0000, v141
    s_waitcnt lgkmcnt(10)
    ds_read_b128 v[72:75], v250 offset:0
    ds_read_b128 v[76:79], v250 offset:4608
    ds_read_b128 v[80:83], v250 offset:9216
    ds_read_b128 v[84:87], v250 offset:13824
    ds_read_b128 v[88:91], v250 offset:18432
    v_lshlrev_b32 v52, 16, v142
    v_and_b32 v53, 0xffff0000, v142
    v_lshlrev_b32 v54, 16, v143
    v_and_b32 v55, 0xffff0000, v143
    v_lshlrev_b32 v56, 16, v144
    v_and_b32 v57, 0xffff0000, v144
    v_lshlrev_b32 v58, 16, v145
    v_and_b32 v59, 0xffff0000, v145
    v_lshlrev_b32 v60, 16, v146
    v_and_b32 v61, 0xffff0000, v146
    v_lshlrev_b32 v62, 16, v147
    v_and_b32 v63, 0xffff0000, v147
    v_lshlrev_b32 v64, 16, v148
    v_and_b32 v65, 0xffff0000, v148
    v_lshlrev_b32 v66, 16, v149
    v_and_b32 v67, 0xffff0000, v149
    v_lshlrev_b32 v68, 16, v150
    v_and_b32 v69, 0xffff0000, v150
    v_lshlrev_b32 v70, 16, v151
    v_and_b32 v71, 0xffff0000, v151
    s_waitcnt lgkmcnt(10)
    v_pk_mul_f32 v[32:33], v[32:33], v[156:157]
    v_pk_mul_f32 v[34:35], v[34:35], v[158:159]
    v_pk_mul_f32 v[36:37], v[36:37], v[160:161]
    v_pk_mul_f32 v[38:39], v[38:39], v[162:163]
    v_pk_mul_f32 v[40:41], v[40:41], v[164:165]
    v_pk_mul_f32 v[42:43], v[42:43], v[166:167]
    v_pk_mul_f32 v[44:45], v[44:45], v[168:169]
    v_pk_mul_f32 v[46:47], v[46:47], v[170:171]
    v_pk_mul_f32 v[48:49], v[48:49], v[172:173]
    v_pk_mul_f32 v[50:51], v[50:51], v[174:175]
    v_pk_mul_f32 v[52:53], v[52:53], v[156:157]
    v_pk_mul_f32 v[54:55], v[54:55], v[158:159]
    v_pk_mul_f32 v[56:57], v[56:57], v[160:161]
    v_pk_mul_f32 v[58:59], v[58:59], v[162:163]
    v_pk_mul_f32 v[60:61], v[60:61], v[164:165]
    v_pk_mul_f32 v[62:63], v[62:63], v[166:167]
    v_pk_mul_f32 v[64:65], v[64:65], v[168:169]
    v_pk_mul_f32 v[66:67], v[66:67], v[170:171]
    v_pk_mul_f32 v[68:69], v[68:69], v[172:173]
    v_pk_mul_f32 v[70:71], v[70:71], v[174:175]
    s_cmp_lg_u32 s3, 0
    s_cbranch_scc1 L_nohop2
    s_mov_b64 exec, 0
    s_branch L_chain2
L_back2:
    s_mov_b64 exec, -1
L_nohop2:
    s_cmp_lg_u32 s3, 0
    s_cbranch_scc1 L_role2_x
    s_add_u32 s70, s69, 0
    s_mov_b32 s71, 0x364ccccd
    v_mov_b32 v19, 0x3727c5ac
    v_mov_b32 v18, 115296
    s_mov_b32 exec_hi, 0
    s_mov_b32 s76, 0
L_pstat0:
    buffer_load_dwordx4 v[24:27], v2, s[36:39], s70 offen sc1
    s_add_u32 s76, s76, 1
    s_cmp_gt_u32 s76, 0x20000
    s_cbranch_scc1 L_pstat0_out
    s_waitcnt vmcnt(0)
    v_cmp_ne_u64 vcc, s[52:53], v[26:27]
    s_cbranch_vccnz L_pstat0
L_pstat0_out:
    s_waitcnt vmcnt(0)
    s_nop 0
    v_add_f32_dpp v24, v24, v24 row_shr:1 row_mask:0xf bank_mask:0xf bound_ctrl:0
    v_add_f32_dpp v25, v25, v25 row_shr:1 row_mask:0xf bank_mask:0xf bound_ctrl:0
    s_nop 0
    v_add_f32_dpp v24, v24, v24 row_shr:2 row_mask:0xf bank_mask:0xf bound_ctrl:0
    v_add_f32_dpp v25, v25, v25 row_shr:2 row_mask:0xf bank_mask:0xf bound_ctrl:0
    s_nop 0
    v_add_f32_dpp v24, v24, v24 row_shr:4 row_mask:0xf bank_mask:0xf bound_ctrl:0
    v_add_f32_dpp v25, v25, v25 row_shr:4 row_mask:0xf bank_mask:0xf bound_ctrl:0
    s_nop 0
    v_add_f32_dpp v24, v24, v24 row_shr:8 row_mask:0xf bank_mask:0xf bound_ctrl:0
    v_add_f32_dpp v25, v25, v25 row_shr:8 row_mask:0xf bank_mask:0xf bound_ctrl:0
    s_nop 0
    v_add_f32_dpp v24, v24, v24 row_bcast:15 row_mask:0xa bank_mask:0xf
    v_add_f32_dpp v25, v25, v25 row_bcast:15 row_mask:0xa bank_mask:0xf
    v_mul_f32 v24, s71, v24
    v_fma_f32 v25, v25, s71, v19
    v_fma_f32 v25, -v24, v24, v25
    v_max_f32 v25, v19, v25
    v_rsq_f32 v25, v25
    s_mov_b32 exec_lo, 0x80000000
    v_mul_f32 v26, s64, v25
    v_mul_f32 v27, -v24, v26
    ds_write_b64 v18, v[26:27]
    s_mov_b64 exec, -1
L_role2_x:
    v_mov_b32 v24, 115296
    s_waitcnt vmcnt(0) lgkmcnt(0)
    s_barrier
    ds_read_b64 v[18:19], v24
    buffer_store_dwordx2 v[22:23], v247, s[36:39], s65 offen sc1
    s_mov_b32 s70, s63
    s_waitcnt lgkmcnt(0)
    v_pk_fma_f32 v[176:177], v[156:157], v[18:19], v[176:177] op_sel:[0,1,0] op_sel_hi:[1,1,1]
    v_pk_fma_f32 v[178:179], v[158:159], v[18:19], v[178:179] op_sel:[0,1,0] op_sel_hi:[1,1,1]
    v_pk_fma_f32 v[32:33], v[32:33], v[18:19], v[176:177] op_sel_hi:[1,0,1]
    v_pk_fma_f32 v[34:35], v[34:35], v[18:19], v[178:179] op_sel_hi:[1,0,1]
    v_pk_fma_f32 v[52:53], v[52:53], v[18:19], v[176:177] op_sel_hi:[1,0,1]
    v_pk_fma_f32 v[54:55], v[54:55], v[18:19], v[178:179] op_sel_hi:[1,0,1]
    v_exp_f32 v92, v32
    v_exp_f32 v93, v33
    v_exp_f32 v94, v34
    v_exp_f32 v95, v35
    v_exp_f32 v96, v52
    v_exp_f32 v97, v53
    v_exp_f32 v98, v54
    v_exp_f32 v99, v55
    v_pk_fma_f32 v[180:181], v[160:161], v[18:19], v[180:181] op_sel:[0,1,0] op_sel_hi:[1,1,1]
    v_pk_fma_f32 v[182:183], v[162:163], v[18:19], v[182:183] op_sel:[0,1,0] op_sel_hi:[1,1,1]
    v_pk_fma_f32 v[92:93], v[92:93], s[64:65], s[64:65] op_sel_hi:[1,0,0]
    v_pk_fma_f32 v[94:95], v[94:95], s[64:65], s[64:65] op_sel_hi:[1,0,0]
    v_pk_fma_f32 v[36:37], v[36:37], v[18:19], v[180:181] op_sel_hi:[1,0,1]
    v_pk_fma_f32 v[38:39], v[38:39], v[18:19], v[182:183] op_sel_hi:[1,0,1]
    v_pk_fma_f32 v[96:97], v[96:97], s[64:65], s[64:65] op_sel_hi:[1,0,0]
    v_pk_fma_f32 v[98:99], v[98:99], s[64:65], s[64:65] op_sel_hi:[1,0,0]
    v_rcp_f32 v92, v92
    v_rcp_f32 v93, v93
    v_rcp_f32 v94, v94
    v_rcp_f32 v95, v95
    v_pk_fma_f32 v[56:57], v[56:57], v[18:19], v[180:181] op_sel_hi:[1,0,1]
    v_pk_fma_f32 v[58:59], v[58:59], v[18:19], v[182:183] op_sel_hi:[1,0,1]
    v_rcp_f32 v96, v96
    v_rcp_f32 v97, v97
    v_rcp_f32 v98, v98
    v_rcp_f32 v99, v99
    v_exp_f32 v100, v36
    v_pk_mul_f32 v[92:93], v[32:33], v[92:93]
    v_pk_mul_f32 v[96:97], v[52:53], v[96:97]
    v_exp_f32 v101, v37
    v_pk_mul_f32 v[94:95], v[34:35], v[94:95]
    v_pk_mul_f32 v[98:99], v[54:55], v[98:99]
    v_exp_f32 v102, v38
    v_cvt_pk_bf16_f32 v108, v92, v93
    v_cvt_pk_bf16_f32 v110, v96, v97
    v_exp_f32 v103, v39
    v_cvt_pk_bf16_f32 v109, v94, v95
    v_cvt_pk_bf16_f32 v111, v98, v99
    v_exp_f32 v104, v56
    v_permlane16_swap_b32 v108, v110
    s_nop 0
    v_permlane16_swap_b32 v109, v111
    v_exp_f32 v105, v57
    buffer_store_dwordx4 v[108:111], v4, s[20:23], s70 offen sc1
    v_exp_f32 v106, v58
    ds_write_b128 v13, v[108:111] offset:0
    v_exp_f32 v107, v59
    v_pk_fma_f32 v[184:185], v[164:165], v[18:19], v[184:185] op_sel:[0,1,0] op_sel_hi:[1,1,1]
    v_pk_fma_f32 v[186:187], v[166:167], v[18:19], v[186:187] op_sel:[0,1,0] op_sel_hi:[1,1,1]
    v_pk_fma_f32 v[100:101], v[100:101], s[64:65], s[64:65] op_sel_hi:[1,0,0]
    v_pk_fma_f32 v[102:103], v[102:103], s[64:65], s[64:65] op_sel_hi:[1,0,0]
    v_pk_fma_f32 v[40:41], v[40:41], v[18:19], v[184:185] op_sel_hi:[1,0,1]
    v_pk_fma_f32 v[42:43], v[42:43], v[18:19], v[186:187] op_sel_hi:[1,0,1]
    v_pk_fma_f32 v[104:105], v[104:105], s[64:65], s[64:65] op_sel_hi:[1,0,0]
    v_pk_fma_f32 v[106:107], v[106:107], s[64:65], s[64:65] op_sel_hi:[1,0,0]
    v_rcp_f32 v100, v100
    v_rcp_f32 v101, v101
    v_rcp_f32 v102, v102
    v_rcp_f32 v103, v103
    v_pk_fma_f32 v[60:61], v[60:61], v[18:19], v[184:185] op_sel_hi:[1,0,1]
    v_pk_fma_f32 v[62:63], v[62:63], v[18:19], v[186:187] op_sel_hi:[1,0,1]
    v_rcp_f32 v104, v104
    v_rcp_f32 v105, v105
    v_rcp_f32 v106, v106
    v_rcp_f32 v107, v107
    v_exp_f32 v92, v40
    v_pk_mul_f32 v[100:101], v[36:37], v[100:101]
    v_pk_mul_f32 v[104:105], v[56:57], v[104:105]
    v_exp_f32 v93, v41
    v_pk_mul_f32 v[102:103], v[38:39], v[102:103]
    v_pk_mul_f32 v[106:107], v[58:59], v[106:107]
    v_exp_f32 v94, v42
    v_cvt_pk_bf16_f32 v112, v100, v101
    v_cvt_pk_bf16_f32 v114, v104, v105
    v_exp_f32 v95, v43
    v_cvt_pk_bf16_f32 v113, v102, v103
    v_cvt_pk_bf16_f32 v115, v106, v107
    v_exp_f32 v96, v60
    v_permlane16_swap_b32 v112, v114
    s_add_u32 s70, s70, 131072
    v_permlane16_swap_b32 v113, v115
    v_exp_f32 v97, v61
    buffer_store_dwordx4 v[112:115], v4, s[20:23], s70 offen sc1
    v_exp_f32 v98, v62
    ds_write_b128 v13, v[112:115] offset:4096
    v_exp_f32 v99, v63
    v_pk_fma_f32 v[188:189], v[168:169], v[18:19], v[188:189] op_sel:[0,1,0] op_sel_hi:[1,1,1]
    v_pk_fma_f32 v[190:191], v[170:171], v[18:19], v[190:191] op_sel:[0,1,0] op_sel_hi:[1,1,1]
    v_pk_fma_f32 v[92:93], v[92:93], s[64:65], s[64:65] op_sel_hi:[1,0,0]
    v_pk_fma_f32 v[94:95], v[94:95], s[64:65], s[64:65] op_sel_hi:[1,0,0]
    v_pk_fma_f32 v[44:45], v[44:45], v[18:19], v[188:189] op_sel_hi:[1,0,1]
    v_pk_fma_f32 v[46:47], v[46:47], v[18:19], v[190:191] op_sel_hi:[1,0,1]
    v_pk_fma_f32 v[96:97], v[96:97], s[64:65], s[64:65] op_sel_hi:[1,0,0]
L_page1:
    s_cbranch_execz L_page2
    v_pk_fma_f32 v[98:99], v[98:99], s[64:65], s[64:65] op_sel_hi:[1,0,0]
    v_rcp_f32 v92, v92
    v_rcp_f32 v93, v93
    v_rcp_f32 v94, v94
    v_rcp_f32 v95, v95
    v_pk_fma_f32 v[64:65], v[64:65], v[18:19], v[188:189] op_sel_hi:[1,0,1]
    v_pk_fma_f32 v[66:67], v[66:67], v[18:19], v[190:191] op_sel_hi:[1,0,1]
    v_rcp_f32 v96, v96
    v_rcp_f32 v97, v97
    v_rcp_f32 v98, v98
    v_rcp_f32 v99, v99
    v_exp_f32 v100, v44
    v_pk_mul_f32 v[92:93], v[40:41], v[92:93]
    v_pk_mul_f32 v[96:97], v[60:61], v[96:97]
    v_exp_f32 v101, v45
    v_pk_mul_f32 v[94:95], v[42:43], v[94:95]
    v_pk_mul_f32 v[98:99], v[62:63], v[98:99]
    v_exp_f32 v102, v46
    v_cvt_pk_bf16_f32 v116, v92, v93
    v_cvt_pk_bf16_f32 v118, v96, v97
    v_exp_f32 v103, v47
    v_cvt_pk_bf16_f32 v117, v94, v95
    v_cvt_pk_bf16_f32 v119, v98, v99
    v_exp_f32 v104, v64
    v_permlane16_swap_b32 v116, v118
    s_add_u32 s70, s70, 131072
    v_permlane16_swap_b32 v117, v119
    v_exp_f32 v105, v65
    buffer_store_dwordx4 v[116:119], v4, s[20:23], s70 offen sc1
    v_exp_f32 v106, v66
    ds_write_b128 v13, v[116:119] offset:8192
    v_exp_f32 v107, v67
    v_pk_fma_f32 v[192:193], v[172:173], v[18:19], v[192:193] op_sel:[0,1,0] op_sel_hi:[1,1,1]
    v_pk_fma_f32 v[194:195], v[174:175], v[18:19], v[194:195] op_sel:[0,1,0] op_sel_hi:[1,1,1]
    v_pk_fma_f32 v[100:101], v[100:101], s[64:65], s[64:65] op_sel_hi:[1,0,0]
    v_pk_fma_f32 v[102:103], v[102:103], s[64:65], s[64:65] op_sel_hi:[1,0,0]
    v_pk_fma_f32 v[48:49], v[48:49], v[18:19], v[192:193] op_sel_hi:[1,0,1]
    v_pk_fma_f32 v[50:51], v[50:51], v[18:19], v[194:195] op_sel_hi:[1,0,1]
    v_pk_fma_f32 v[104:105], v[104:105], s[64:65], s[64:65] op_sel_hi:[1,0,0]
    v_pk_fma_f32 v[106:107], v[106:107], s[64:65], s[64:65] op_sel_hi:[1,0,0]
    v_rcp_f32 v100, v100
    v_rcp_f32 v101, v101
    v_rcp_f32 v102, v102
    v_rcp_f32 v103, v103
    v_pk_fma_f32 v[68:69], v[68:69], v[18:19], v[192:193] op_sel_hi:[1,0,1]
    v_pk_fma_f32 v[70:71], v[70:71], v[18:19], v[194:195] op_sel_hi:[1,0,1]
    v_rcp_f32 v104, v104
    v_rcp_f32 v105, v105
    v_rcp_f32 v106, v106
    v_rcp_f32 v107, v107
    v_exp_f32 v92, v48
    v_pk_mul_f32 v[100:101], v[44:45], v[100:101]
    v_pk_mul_f32 v[104:105], v[64:65], v[104:105]
    v_exp_f32 v93, v49
    v_pk_mul_f32 v[102:103], v[46:47], v[102:103]
    v_pk_mul_f32 v[106:107], v[66:67], v[106:107]
    v_exp_f32 v94, v50
    v_cvt_pk_bf16_f32 v120, v100, v101
    v_cvt_pk_bf16_f32 v122, v104, v105
    v_exp_f32 v95, v51
    v_cvt_pk_bf16_f32 v121, v102, v103
    v_cvt_pk_bf16_f32 v123, v106, v107
    v_exp_f32 v96, v68
    v_permlane16_swap_b32 v120, v122
    s_add_u32 s70, s70, 131072
    v_permlane16_swap_b32 v121, v123
    v_exp_f32 v97, v69
    buffer_store_dwordx4 v[120:123], v4, s[20:23], s70 offen sc1
    v_exp_f32 v98, v70
    ds_write_b128 v13, v[120:123] offset:12288
    v_exp_f32 v99, v71
    v_pk_fma_f32 v[92:93], v[92:93], s[64:65], s[64:65] op_sel_hi:[1,0,0]
    v_pk_fma_f32 v[94:95], v[94:95], s[64:65], s[64:65] op_sel_hi:[1,0,0]
    v_pk_fma_f32 v[96:97], v[96:97], s[64:65], s[64:65] op_sel_hi:[1,0,0]
    v_pk_fma_f32 v[98:99], v[98:99], s[64:65], s[64:65] op_sel_hi:[1,0,0]
    v_rcp_f32 v92, v92
    v_rcp_f32 v93, v93
    v_rcp_f32 v94, v94
    v_rcp_f32 v95, v95
    v_rcp_f32 v96, v96
    v_rcp_f32 v97, v97
    v_rcp_f32 v98, v98
    v_rcp_f32 v99, v99
    v_pk_mul_f32 v[92:93], v[48:49], v[92:93]
    v_pk_mul_f32 v[96:97], v[68:69], v[96:97]
    v_pk_mul_f32 v[94:95], v[50:51], v[94:95]
    v_pk_mul_f32 v[98:99], v[70:71], v[98:99]
    v_cvt_pk_bf16_f32 v124, v92, v93
    v_cvt_pk_bf16_f32 v126, v96, v97
    v_cvt_pk_bf16_f32 v125, v94, v95
    v_cvt_pk_bf16_f32 v127, v98, v99
    v_permlane16_swap_b32 v124, v126
    s_add_u32 s70, s70, 131072
    v_permlane16_swap_b32 v125, v127
    buffer_store_dwordx4 v[124:127], v4, s[20:23], s70 offen sc1
    s_waitcnt vmcnt(3) lgkmcnt(0)
    s_barrier
    buffer_store_dwordx2 v[22:23], v16, s[36:39], s61 offen offset:256 sc1
    ds_read_b128 v[188:191], v252 offset:9216
    ds_read_b128 v[192:195], v252 offset:9232
    ds_read_b128 v[196:199], v252 offset:9248
    ds_read_b128 v[200:203], v252 offset:9264
    ds_read_b128 v[204:207], v252 offset:9280
    ds_read_b128 v[208:211], v252 offset:9296
    ds_read_b128 v[212:215], v252 offset:9312
    ds_read_b128 v[216:219], v252 offset:9328
    ds_read_b128 v[220:223], v252 offset:9344
    v_lshrrev_b32 v24, 1, v1
    v_min_u32 v24, 16, v24
    v_mul_u32_u24 v24, 2080, v24
    v_and_b32 v25, 16, v2
    v_add_u32 v24, v24, v25
    v_mov_b32 v92, 0
    v_mov_b32 v93, 0
    v_mov_b32 v94, 0
    v_mov_b32 v95, 0
    ds_write_b128 v24, v[92:95]
    s_mov_b64 s[40:41], s[20:21]
    s_mov_b32 s43, 0x20000
    s_mov_b64 s[44:45], s[20:21]
    s_mov_b32 s47, 0x20000
    s_cmp_eq_u32 s49, 0
    s_cselect_b32 s42, 0, s22
    s_mov_b32 s66, 0xfff
    s_cselect_b32 s66, 0xff0, s66
    s_cmp_eq_u32 s49, 31
    s_cselect_b32 s46, 0, s22
    s_cselect_b32 s66, 0xff, s66
    s_mov_b32 s67, 0
    s_and_b32 s74, s3, 1
    s_lshl_b32 s74, s74, 10
    s_lshl_b32 s70, s49, 12
    s_add_u32 s70, s70, s74
    s_mul_i32 s71, s48, 2621440
    s_add_u32 s70, s70, s71
    s_add_u32 s70, s70, 2048
    s_lshr_b32 s75, s3, 1
    s_add_u32 s71, s50, 0
    s_and_b32 s71, s71, 3
    s_mul_i32 s71, s71, 655360
    s_add_u32 s14, s71, s70
    s_add_u32 s71, s50, 1
    s_and_b32 s71, s71, 3
    s_mul_i32 s71, s71, 655360
    s_add_u32 s15, s71, s70
    s_add_u32 s71, s50, 2
    s_and_b32 s71, s71, 3
    s_mul_i32 s71, s71, 655360
    s_add_u32 s16, s71, s70
    s_add_u32 s71, s50, 3
    s_and_b32 s71, s71, 3
    s_mul_i32 s71, s71, 655360
    s_add_u32 s17, s71, s70
    s_lshl_b32 s71, s75, 17
    s_cselect_b32 s4, s14, s14
    s_cselect_b32 s5, s16, s15
    s_cselect_b32 s6, s15, s17
    s_cselect_b32 s7, s17, s16
    s_cselect_b32 s8, s14, s14
    s_cselect_b32 s9, s16, s15
    s_cselect_b32 s10, s15, s17
    s_cselect_b32 s11, s17, s16
    s_cselect_b32 s12, s16, s15
    s_cselect_b32 s13, s14, s17
    s_add_u32 s4, s4, s71
    s_add_u32 s6, s6, s71
    s_add_u32 s7, s7, 131072
    s_add_u32 s8, s8, 262144
    s_add_u32 s8, s8, s71
    s_add_u32 s9, s9, 262144
    s_add_u32 s10, s10, 262144
    s_add_u32 s10, s10, s71
    s_add_u32 s11, s11, 393216
    s_add_u32 s12, s12, 524288
    s_add_u32 s13, s13, 524288
    s_lshl_b32 s71, s75, 12
    s_add_u32 s71, s71, s74
    s_add_u32 s71, s71, 33344
    v_add_u32 v14, s71, v2
    s_cmp_eq_u32 s3, 0
    s_cselect_b32 s14, -1.0, 0.5
    s_cmp_eq_u32 s3, 2
    s_cselect_b32 s14, -0.5, s14
    s_cselect_b32 s18, -1.0, 0.5
    s_cselect_b32 s72, 3, 2
    s_cmp_eq_u32 s3, 3
    s_cselect_b32 s14, -1.0, s14
    s_cselect_b32 s18, -0.5, s18
    s_cmp_eq_u32 s3, 1
    s_cselect_b32 s16, -1.0, 0.5
    s_cselect_b32 s71, 0, 1
    s_xor_b32 s73, s71, s3
    s_and_b32 s73, s73, 1
    s_lshl_b32 s76, s71, 1
    s_add_u32 s73, s73, s76
    s_mul_i32 s73, s73, 10240
    s_add_u32 s73, s73, 33344
    v_add_u32 v10, s73, v2
    s_xor_b32 s73, s72, s3
    s_and_b32 s73, s73, 1
    s_lshl_b32 s76, s72, 1
    s_add_u32 s73, s73, s76
    s_mul_i32 s73, s73, 10240
    s_add_u32 s73, s73, 33344
    v_add_u32 v11, s73, v2
    s_mul_i32 s73, s3, 20480
    s_add_u32 s73, s73, 33344
    v_add_u32 v9, s73, v2
    s_mul_i32 s73, s75, 2080
    s_add_u32 s73, s73, s74
    v_add3_u32 v7, v2, 32, s73
    v_add_u32 v244, 4096, v2
    s_add_u32 s62, s61, 0x8000
    s_mov_b32 s25, s66
    v_mov_b32 v246, 0x40000000
    v_min_u32 v255, 11, v1
    v_lshlrev_b32 v255, 6, v255
    s_cmp_eq_u32 s3, 0
    s_cselect_b32 s66, s66, 0
    s_mov_b64 vcc, s[66:67]
    v_cndmask_b32 v246, v246, v255, vcc
    v_and_b32 v24, 15, v1
    v_bfe_u32 v25, v1, 4, 1
    v_lshrrev_b32 v26, 5, v1
    v_lshlrev_b32 v27, 5, v24
    v_lshl_add_u32 v27, v25, 4, v27
    v_mul_u32_u24 v28, 2080, v26
    s_mul_i32 s70, s3, 4160
    s_add_u32 s72, s70, s74
    s_xor_b32 s74, s74, 1024
    s_add_u32 s73, s70, s74
    v_add3_u32 v5, v27, v28, s72
    v_add3_u32 v6, v27, v28, s73
    v_lshrrev_b32 v28, 4, v1
    v_mul_u32_u24 v28, 320, v28
    v_add_u32 v28, 116608, v28
    v_lshl_add_u32 v30, v24, 4, v28
    v_lshl_add_u32 v29, v24, 2, v28
    s_lshl_b32 s70, s3, 6
    v_add_u32 v24, s70, v1
    v_min_u32 v24, 239, v24
    v_mul_u32_u24 v25, 3277, v24
    v_lshrrev_b32 v25, 16, v25
    v_mul_u32_u24 v25, 2240, v25
    v_lshl_add_u32 v28, v24, 4, v25
    s_lshl_b32 s70, s3, 10
    s_add_u32 m0, s70, 116608
    s_lshr_b32 s77, s54, 13
    s_lshl_b32 s77, s77, 2
    s_add_u32 s77, s77, 196608
    buffer_load_dwordx2 v[250:251], v254, s[36:39], s65 offen sc1
    s_mov_b32 s60, s77
    s_lshl_b32 s76, s51, 3
    s_add_u32 s76, s76, 4096
    s_cmp_eq_u32 s68, 2
    s_cselect_b32 s76, s76, 0x40000000
    v_mov_b32 v247, 0x40000000
    s_mov_b64 exec, 1
    v_add_u32 v247, s76, v17
    s_mov_b64 exec, -1
    s_lshl_b32 s76, s3, 10
    s_max_u32 s76, s76, 1024
    s_sub_u32 s76, s76, 1024
    v_add_u32 v31, s76, v2
    s_cmp_eq_u32 s3, 1
    s_cselect_b64 s[58:59], -1, 0
    s_cmp_lt_u32 s51, 50
    s_cselect_b32 s77, s3, 0
    s_mul_i32 s70, s51, 205
    s_lshr_b32 s70, s70, 11
    s_mul_i32 s71, s70, 10
    s_sub_u32 s71, s51, s71
    s_mul_i32 s72, s71, 5
    s_add_u32 s72, s72, s70
    s_lshl_b32 s70, s70, 1
    s_add_u32 s70, s70, s71
    s_add_u32 s70, s70, 32
    s_cmp_ge_u32 s71, 8
    s_cselect_b32 s70, s70, s72
    s_mul_i32 s70, s70, 3072
    s_mul_i32 s71, s50, 1228800
    s_add_u32 s70, s70, s71
    s_add_u32 s70, s70, 1202176
    s_add_u32 s71, s70, 307200
    s_add_u32 s72, s70, 614400
    s_add_u32 s73, s70, 921600
    s_mov_b32 s74, 0x07060100
    s_mov_b32 s75, 0x05040302
    buffer_load_dwordx2 v[248:249], v246, s[36:39], s61 offen sc1
    s_waitcnt lgkmcnt(0)
    s_cmp_eq_u32 s77, 0
    s_cbranch_scc1 L_w2_done
    s_cmp_lg_u32 s77, 1
    s_cbranch_scc1 L_w2_1
    v_lshlrev_b32 v172, 16, v188
    v_and_b32 v173, 0xffff0000, v192
    v_and_b32 v174, 0xffff0000, v189
    v_lshlrev_b32 v175, 16, v194
    v_lshlrev_b32 v176, 16, v191
    v_and_b32 v177, 0xffff0000, v195
    v_perm_b32 v156, v192, v188, s74
    v_perm_b32 v168, v195, v191, s74
    v_pk_add_f32 v[172:173], v[172:173], v[176:177]
    v_pk_add_f32 v[178:179], v[172:173], v[174:175]
    v_pk_add_f32 v[180:181], v[172:173], v[174:175] neg_lo:[0,1] neg_hi:[0,1]
    v_cvt_pk_bf16_f32 v160, v178, v179
    v_cvt_pk_bf16_f32 v164, v180, v181
    v_lshlrev_b32 v172, 16, v197
    v_and_b32 v173, 0xffff0000, v201
    v_and_b32 v174, 0xffff0000, v198
    v_lshlrev_b32 v175, 16, v203
    v_lshlrev_b32 v176, 16, v200
    v_and_b32 v177, 0xffff0000, v204
    v_perm_b32 v157, v201, v197, s74
    v_perm_b32 v169, v204, v200, s74
    v_pk_add_f32 v[172:173], v[172:173], v[176:177]
    v_pk_add_f32 v[178:179], v[172:173], v[174:175]
    v_pk_add_f32 v[180:181], v[172:173], v[174:175] neg_lo:[0,1] neg_hi:[0,1]
    v_cvt_pk_bf16_f32 v161, v178, v179
    v_cvt_pk_bf16_f32 v165, v180, v181
    v_lshlrev_b32 v172, 16, v206
    v_and_b32 v173, 0xffff0000, v210
    v_and_b32 v174, 0xffff0000, v207
    v_lshlrev_b32 v175, 16, v212
    v_lshlrev_b32 v176, 16, v209
    v_and_b32 v177, 0xffff0000, v213
    v_perm_b32 v158, v210, v206, s74
    v_perm_b32 v170, v213, v209, s74
    v_pk_add_f32 v[172:173], v[172:173], v[176:177]
    v_pk_add_f32 v[178:179], v[172:173], v[174:175]
    v_pk_add_f32 v[180:181], v[172:173], v[174:175] neg_lo:[0,1] neg_hi:[0,1]
    v_cvt_pk_bf16_f32 v162, v178, v179
    v_cvt_pk_bf16_f32 v166, v180, v181
    v_lshlrev_b32 v172, 16, v215
    v_and_b32 v173, 0xffff0000, v219
    v_and_b32 v174, 0xffff0000, v216
    v_lshlrev_b32 v175, 16, v221
    v_lshlrev_b32 v176, 16, v218
    v_and_b32 v177, 0xffff0000, v222
    v_perm_b32 v159, v219, v215, s74
    v_perm_b32 v171, v222, v218, s74
    v_pk_add_f32 v[172:173], v[172:173], v[176:177]
    v_pk_add_f32 v[178:179], v[172:173], v[174:175]
    v_pk_add_f32 v[180:181], v[172:173], v[174:175] neg_lo:[0,1] neg_hi:[0,1]
    v_cvt_pk_bf16_f32 v163, v178, v179
    v_cvt_pk_bf16_f32 v167, v180, v181
    s_branch L_w2_done
L_w2_1:
    s_cmp_lg_u32 s77, 2
    s_cbranch_scc1 L_w2_2
    v_and_b32 v172, 0xffff0000, v188
    v_lshlrev_b32 v173, 16, v193
    v_lshlrev_b32 v174, 16, v190
    v_and_b32 v175, 0xffff0000, v194
    v_and_b32 v176, 0xffff0000, v191
    v_lshlrev_b32 v177, 16, v196
    v_perm_b32 v156, v193, v188, s75
    v_perm_b32 v168, v196, v191, s75
    v_pk_add_f32 v[172:173], v[172:173], v[176:177]
    v_pk_add_f32 v[178:179], v[172:173], v[174:175]
    v_pk_add_f32 v[180:181], v[172:173], v[174:175] neg_lo:[0,1] neg_hi:[0,1]
    v_cvt_pk_bf16_f32 v160, v178, v179
    v_cvt_pk_bf16_f32 v164, v180, v181
    v_and_b32 v172, 0xffff0000, v197
    v_lshlrev_b32 v173, 16, v202
    v_lshlrev_b32 v174, 16, v199
    v_and_b32 v175, 0xffff0000, v203
    v_and_b32 v176, 0xffff0000, v200
    v_lshlrev_b32 v177, 16, v205
    v_perm_b32 v157, v202, v197, s75
    v_perm_b32 v169, v205, v200, s75
    v_pk_add_f32 v[172:173], v[172:173], v[176:177]
    v_pk_add_f32 v[178:179], v[172:173], v[174:175]
    v_pk_add_f32 v[180:181], v[172:173], v[174:175] neg_lo:[0,1] neg_hi:[0,1]
    v_cvt_pk_bf16_f32 v161, v178, v179
    v_cvt_pk_bf16_f32 v165, v180, v181
    v_and_b32 v172, 0xffff0000, v206
    v_lshlrev_b32 v173, 16, v211
    v_lshlrev_b32 v174, 16, v208
    v_and_b32 v175, 0xffff0000, v212
    v_and_b32 v176, 0xffff0000, v209
    v_lshlrev_b32 v177, 16, v214
    v_perm_b32 v158, v211, v206, s75
    v_perm_b32 v170, v214, v209, s75
    v_pk_add_f32 v[172:173], v[172:173], v[176:177]
    v_pk_add_f32 v[178:179], v[172:173], v[174:175]
    v_pk_add_f32 v[180:181], v[172:173], v[174:175] neg_lo:[0,1] neg_hi:[0,1]
    v_cvt_pk_bf16_f32 v162, v178, v179
    v_cvt_pk_bf16_f32 v166, v180, v181
    v_and_b32 v172, 0xffff0000, v215
    v_lshlrev_b32 v173, 16, v220
    v_lshlrev_b32 v174, 16, v217
    v_and_b32 v175, 0xffff0000, v221
    v_and_b32 v176, 0xffff0000, v218
    v_lshlrev_b32 v177, 16, v223
    v_perm_b32 v159, v220, v215, s75
    v_perm_b32 v171, v223, v218, s75
    v_pk_add_f32 v[172:173], v[172:173], v[176:177]
    v_pk_add_f32 v[178:179], v[172:173], v[174:175]
    v_pk_add_f32 v[180:181], v[172:173], v[174:175] neg_lo:[0,1] neg_hi:[0,1]
    v_cvt_pk_bf16_f32 v163, v178, v179
    v_cvt_pk_bf16_f32 v167, v180, v181
    s_branch L_w2_done
L_w2_2:
    v_lshlrev_b32 v172, 16, v189
    v_and_b32 v173, 0xffff0000, v193
    v_and_b32 v174, 0xffff0000, v190
    v_lshlrev_b32 v175, 16, v195
    v_lshlrev_b32 v176, 16, v192
    v_and_b32 v177, 0xffff0000, v196
    v_perm_b32 v156, v193, v189, s74
    v_perm_b32 v168, v196, v192, s74
    v_pk_add_f32 v[172:173], v[172:173], v[176:177]
    v_pk_add_f32 v[178:179], v[172:173], v[174:175]
    v_pk_add_f32 v[180:181], v[172:173], v[174:175] neg_lo:[0,1] neg_hi:[0,1]
    v_cvt_pk_bf16_f32 v160, v178, v179
    v_cvt_pk_bf16_f32 v164, v180, v181
    v_lshlrev_b32 v172, 16, v198
    v_and_b32 v173, 0xffff0000, v202
    v_and_b32 v174, 0xffff0000, v199
    v_lshlrev_b32 v175, 16, v204
    v_lshlrev_b32 v176, 16, v201
    v_and_b32 v177, 0xffff0000, v205
    v_perm_b32 v157, v202, v198, s74
    v_perm_b32 v169, v205, v201, s74
    v_pk_add_f32 v[172:173], v[172:173], v[176:177]
    v_pk_add_f32 v[178:179], v[172:173], v[174:175]
    v_pk_add_f32 v[180:181], v[172:173], v[174:175] neg_lo:[0,1] neg_hi:[0,1]
    v_cvt_pk_bf16_f32 v161, v178, v179
    v_cvt_pk_bf16_f32 v165, v180, v181
    v_lshlrev_b32 v172, 16, v207
    v_and_b32 v173, 0xffff0000, v211
    v_and_b32 v174, 0xffff0000, v208
    v_lshlrev_b32 v175, 16, v213
    v_lshlrev_b32 v176, 16, v210
    v_and_b32 v177, 0xffff0000, v214
    v_perm_b32 v158, v211, v207, s74
    v_perm_b32 v170, v214, v210, s74
    v_pk_add_f32 v[172:173], v[172:173], v[176:177]
    v_pk_add_f32 v[178:179], v[172:173], v[174:175]
    v_pk_add_f32 v[180:181], v[172:173], v[174:175] neg_lo:[0,1] neg_hi:[0,1]
    v_cvt_pk_bf16_f32 v162, v178, v179
    v_cvt_pk_bf16_f32 v166, v180, v181
    v_lshlrev_b32 v172, 16, v216
    v_and_b32 v173, 0xffff0000, v220
    v_and_b32 v174, 0xffff0000, v217
    v_lshlrev_b32 v175, 16, v222
    v_lshlrev_b32 v176, 16, v219
    v_and_b32 v177, 0xffff0000, v223
    v_perm_b32 v159, v220, v216, s74
    v_perm_b32 v171, v223, v219, s74
    v_pk_add_f32 v[172:173], v[172:173], v[176:177]
    v_pk_add_f32 v[178:179], v[172:173], v[174:175]
    v_pk_add_f32 v[180:181], v[172:173], v[174:175] neg_lo:[0,1] neg_hi:[0,1]
    v_cvt_pk_bf16_f32 v163, v178, v179
    v_cvt_pk_bf16_f32 v167, v180, v181
L_w2_done:
    s_mov_b32 s76, 0
    s_waitcnt vmcnt(1)
L_pwt:
    v_cmp_ne_u64 vcc, s[52:53], v[250:251]
    s_and_b64 vcc, vcc, s[58:59]
    s_cbranch_scc0 L_pwt_out
    s_add_u32 s76, s76, 1
    s_cmp_gt_u32 s76, 0x20000
    s_cbranch_scc1 L_pwt_out
    buffer_load_dwordx2 v[250:251], v254, s[36:39], s65 offen sc1
    s_waitcnt vmcnt(0)
    s_branch L_pwt
L_pwt_out:
    s_waitcnt vmcnt(1)
    v_min_u32 v254, 49, v1
    v_lshlrev_b32 v254, 3, v254
    v_add_u32 v254, 4096, v254
    s_mov_b32 s76, 0
    s_waitcnt vmcnt(0)
L_pact0:
    v_cmp_ne_u64 vcc, s[52:53], v[248:249]
    s_and_b64 vcc, vcc, s[66:67]
    s_cbranch_scc0 L_pact0_out
    s_add_u32 s76, s76, 1
    s_cmp_gt_u32 s76, 0x20000
    s_cbranch_scc1 L_pact0_out
    buffer_load_dwordx2 v[248:249], v246, s[36:39], s61 offen sc1
    s_waitcnt vmcnt(0)
    s_branch L_pact0
L_pact0_out:
    s_barrier
    buffer_load_dwordx4 v[92:95], v2, s[40:43], s4 offen offset:0
    buffer_load_dwordx4 v[104:107], v244, s[44:47], s4 offen offset:2048
    buffer_load_dwordx4 v[112:115], v2, s[20:23], s5 offen offset:2048
    buffer_load_dwordx4 v[116:119], v244, s[20:23], s5 offen offset:0
    buffer_load_dwordx4 v[108:111], v2, s[40:43], s5 offen offset:0
    buffer_load_dwordx4 v[120:123], v244, s[44:47], s5 offen offset:2048
    ds_read_b128 v[96:99], v14 offset:0
    ds_read_b128 v[100:103], v14 offset:2048
    buffer_store_dwordx2 v[22:23], v16, s[36:39], s62 offen offset:256 sc1
    buffer_load_dwordx4 a[136:139], v2, s[36:39], s55 offen offset:0
    buffer_load_dwordx4 a[140:143], v2, s[36:39], s55 offen offset:1024
    buffer_load_dwordx4 a[144:147], v2, s[36:39], s55 offen offset:2048
    buffer_load_dwordx4 a[148:151], v2, s[36:39], s55 offen offset:3072
    s_add_u32 s55, s24, 4096
    buffer_load_dwordx4 a[152:155], v2, s[36:39], s55 offen offset:0
    buffer_load_dwordx4 a[156:159], v2, s[36:39], s55 offen offset:1024
    s_waitcnt lgkmcnt(0)
    v_lshlrev_b32 v188, 16, v96
    v_and_b32 v189, 0xffff0000, v96
    v_lshlrev_b32 v190, 16, v97
    v_and_b32 v191, 0xffff0000, v97
    v_lshlrev_b32 v192, 16, v98
    v_and_b32 v193, 0xffff0000, v98
    v_lshlrev_b32 v194, 16, v99
    v_and_b32 v195, 0xffff0000, v99
    v_lshlrev_b32 v196, 16, v100
    v_and_b32 v197, 0xffff0000, v100
    v_lshlrev_b32 v198, 16, v101
    v_and_b32 v199, 0xffff0000, v101
    v_lshlrev_b32 v200, 16, v102
    v_and_b32 v201, 0xffff0000, v102
    v_lshlrev_b32 v202, 16, v103
    v_and_b32 v203, 0xffff0000, v103
    v_pk_add_f32 v[124:125], v[188:189], v[196:197]
    v_pk_add_f32 v[126:127], v[190:191], v[198:199]
    v_pk_add_f32 v[128:129], v[192:193], v[200:201]
    v_pk_add_f32 v[130:131], v[194:195], v[202:203]
    v_cvt_pk_bf16_f32 v144, v124, v125
    v_cvt_pk_bf16_f32 v145, v126, v127
    v_cvt_pk_bf16_f32 v146, v128, v129
    v_cvt_pk_bf16_f32 v147, v130, v131
    ds_write_b128 v7, v[144:147] offset:4160
    v_pk_add_f32 v[124:125], v[196:197], v[188:189] neg_lo:[0,1] neg_hi:[0,1]
    v_pk_add_f32 v[126:127], v[198:199], v[190:191] neg_lo:[0,1] neg_hi:[0,1]
    v_pk_add_f32 v[128:129], v[200:201], v[192:193] neg_lo:[0,1] neg_hi:[0,1]
    v_pk_add_f32 v[130:131], v[202:203], v[194:195] neg_lo:[0,1] neg_hi:[0,1]
    v_cvt_pk_bf16_f32 v148, v124, v125
    v_cvt_pk_bf16_f32 v149, v126, v127
    v_cvt_pk_bf16_f32 v150, v128, v129
    v_cvt_pk_bf16_f32 v151, v130, v131
    ds_write_b128 v7, v[148:151] offset:8320
    s_waitcnt vmcnt(12)
    v_lshlrev_b32 v132, 16, v92
    v_and_b32 v133, 0xffff0000, v92
    v_lshlrev_b32 v134, 16, v93
    v_and_b32 v135, 0xffff0000, v93
    v_lshlrev_b32 v136, 16, v94
    v_and_b32 v137, 0xffff0000, v94
    v_lshlrev_b32 v138, 16, v95
    v_and_b32 v139, 0xffff0000, v95
    v_pk_add_f32 v[124:125], v[196:197], v[132:133] neg_lo:[0,1] neg_hi:[0,1]
    v_pk_add_f32 v[126:127], v[198:199], v[134:135] neg_lo:[0,1] neg_hi:[0,1]
    v_pk_add_f32 v[128:129], v[200:201], v[136:137] neg_lo:[0,1] neg_hi:[0,1]
    v_pk_add_f32 v[130:131], v[202:203], v[138:139] neg_lo:[0,1] neg_hi:[0,1]
    v_cvt_pk_bf16_f32 v140, v124, v125
    v_cvt_pk_bf16_f32 v141, v126, v127
    v_cvt_pk_bf16_f32 v142, v128, v129
    v_cvt_pk_bf16_f32 v143, v130, v131
    ds_write_b128 v7, v[140:143] offset:0
    s_waitcnt vmcnt(11)
    v_lshlrev_b32 v132, 16, v104
    v_and_b32 v133, 0xffff0000, v104
    v_lshlrev_b32 v134, 16, v105
    v_and_b32 v135, 0xffff0000, v105
    v_lshlrev_b32 v136, 16, v106
    v_and_b32 v137, 0xffff0000, v106
    v_lshlrev_b32 v138, 16, v107
    v_and_b32 v139, 0xffff0000, v107
    v_pk_add_f32 v[124:125], v[188:189], v[132:133] neg_lo:[0,1] neg_hi:[0,1]
    v_pk_add_f32 v[126:127], v[190:191], v[134:135] neg_lo:[0,1] neg_hi:[0,1]
    v_pk_add_f32 v[128:129], v[192:193], v[136:137] neg_lo:[0,1] neg_hi:[0,1]
    v_pk_add_f32 v[130:131], v[194:195], v[138:139] neg_lo:[0,1] neg_hi:[0,1]
    v_cvt_pk_bf16_f32 v152, v124, v125
    v_cvt_pk_bf16_f32 v153, v126, v127
    v_cvt_pk_bf16_f32 v154, v128, v129
    v_cvt_pk_bf16_f32 v155, v130, v131
    ds_write_b128 v7, v[152:155] offset:12480
    buffer_load_dwordx4 a[160:163], v2, s[36:39], s55 offen offset:2048
    buffer_load_dwordx4 a[164:167], v2, s[36:39], s55 offen offset:3072
    s_add_u32 s55, s24, 8192
    buffer_load_dwordx4 a[168:171], v2, s[36:39], s55 offen offset:0
    buffer_load_dwordx4 a[172:175], v2, s[36:39], s55 offen offset:1024
    buffer_load_dwordx4 a[176:179], v2, s[36:39], s55 offen offset:2048
    buffer_load_dwordx4 a[180:183], v2, s[36:39], s55 offen offset:3072
    s_add_u32 s55, s24, 12288
    buffer_load_dwordx4 a[184:187], v2, s[36:39], s55 offen offset:0
    buffer_load_dwordx4 a[188:191], v2, s[36:39], s55 offen offset:1024
    buffer_load_dwordx4 a[192:195], v2, s[36:39], s55 offen offset:2048
    buffer_load_dwordx4 a[196:199], v2, s[36:39], s55 offen offset:3072
    buffer_load_dwordx4 v[96:99], v2, s[20:23], s6 offen offset:2048
    buffer_load_dwordx4 v[100:103], v244, s[20:23], s6 offen offset:0
    s_waitcnt lgkmcnt(0)
    s_barrier
    ds_read_b128 a[40:43], v5 offset:0
    ds_read_b128 a[56:59], v5 offset:32
    ds_read_b128 a[72:75], v5 offset:64
    ds_read_b128 a[44:47], v5 offset:512
    ds_read_b128 a[60:63], v5 offset:544
    ds_read_b128 a[76:79], v5 offset:576
    buffer_load_dwordx4 v[92:95], v2, s[40:43], s6 offen offset:0
    buffer_load_dwordx4 v[104:107], v244, s[44:47], s6 offen offset:2048
    s_waitcnt vmcnt(21)
    v_lshlrev_b32 v188, 16, v112
    v_and_b32 v189, 0xffff0000, v112
    v_lshlrev_b32 v190, 16, v113
    v_and_b32 v191, 0xffff0000, v113
    v_lshlrev_b32 v192, 16, v114
    v_and_b32 v193, 0xffff0000, v114
    v_lshlrev_b32 v194, 16, v115
    v_and_b32 v195, 0xffff0000, v115
    v_lshlrev_b32 v196, 16, v116
    v_and_b32 v197, 0xffff0000, v116
    v_lshlrev_b32 v198, 16, v117
    v_and_b32 v199, 0xffff0000, v117
    v_lshlrev_b32 v200, 16, v118
    v_and_b32 v201, 0xffff0000, v118
    v_lshlrev_b32 v202, 16, v119
    v_and_b32 v203, 0xffff0000, v119
    s_waitcnt vmcnt(17) lgkmcnt(3)
    v_mfma_f32_16x16x32_bf16 v[32:35], a[136:139], a[40:43], 0
    ds_read_b128 a[48:51], v6 offset:0
    s_add_u32 s55, s24, 16384
    v_mfma_f32_16x16x32_bf16 v[32:35], a[140:143], a[56:59], v[32:35]
    ds_read_b128 a[64:67], v6 offset:32
    buffer_load_dwordx4 a[200:203], v2, s[36:39], s55 offen offset:0
    v_add_f32 v124, v188, v196
    v_mfma_f32_16x16x32_bf16 v[32:35], a[144:147], a[72:75], v[32:35]
    ds_read_b128 a[80:83], v6 offset:64
    s_waitcnt lgkmcnt(3)
    v_mfma_f32_16x16x32_bf16 v[52:55], a[144:147], a[76:79], 0
    ds_read_b128 a[52:55], v6 offset:512
    v_add_f32 v125, v189, v197
    v_add_f32 v126, v190, v198
    v_mfma_f32_16x16x32_bf16 v[52:55], a[140:143], a[60:63], v[52:55]
    ds_read_b128 a[68:71], v6 offset:544
    buffer_load_dwordx4 a[204:207], v2, s[36:39], s55 offen offset:1024
    v_add_f32 v127, v191, v199
    v_mfma_f32_16x16x32_bf16 v[52:55], a[136:139], a[44:47], v[52:55]
    ds_read_b128 a[84:87], v6 offset:576
    s_waitcnt lgkmcnt(3)
    v_mfma_f32_16x16x32_bf16 a[0:3], a[136:139], a[48:51], 0
    v_add_f32 v128, v192, v200
    v_add_f32 v129, v193, v201
    v_add_f32 v130, v194, v202
    v_mfma_f32_16x16x32_bf16 a[0:3], a[140:143], a[64:67], a[0:3]
    buffer_load_dwordx4 a[208:211], v2, s[36:39], s55 offen offset:2048
    v_add_f32 v131, v195, v203
    v_mfma_f32_16x16x32_bf16 a[0:3], a[144:147], a[80:83], a[0:3]
    v_cvt_pk_bf16_f32 v144, v124, v125
    v_cvt_pk_bf16_f32 v145, v126, v127
    s_waitcnt lgkmcnt(0)
    v_mfma_f32_16x16x32_bf16 a[20:23], a[144:147], a[84:87], 0
    v_cvt_pk_bf16_f32 v146, v128, v129
    v_cvt_pk_bf16_f32 v147, v130, v131
    v_sub_f32 v124, v196, v188
    v_mfma_f32_16x16x32_bf16 a[20:23], a[140:143], a[68:71], a[20:23]
    ds_write_b128 v7, v[144:147] offset:20800
    buffer_load_dwordx4 a[212:215], v2, s[36:39], s55 offen offset:3072
    v_mfma_f32_16x16x32_bf16 a[20:23], a[136:139], a[52:55], a[20:23]
    s_add_u32 s55, s24, 20480
L_page2:
    s_cbranch_execz L_back0
    v_sub_f32 v125, v197, v189
    s_waitcnt vmcnt(18)
    v_mfma_f32_16x16x32_bf16 v[36:39], a[148:151], a[40:43], 0
    v_sub_f32 v126, v198, v190
    v_sub_f32 v127, v199, v191
    v_sub_f32 v128, v200, v192
    v_mfma_f32_16x16x32_bf16 v[36:39], a[152:155], a[56:59], v[36:39]
    buffer_load_dwordx4 a[216:219], v2, s[36:39], s55 offen offset:0
    v_sub_f32 v129, v201, v193
    v_mfma_f32_16x16x32_bf16 v[36:39], a[156:159], a[72:75], v[36:39]
    v_sub_f32 v130, v202, v194
    v_sub_f32 v131, v203, v195
    v_cvt_pk_bf16_f32 v148, v124, v125
    v_mfma_f32_16x16x32_bf16 v[56:59], a[156:159], a[76:79], 0
    buffer_load_dwordx2 v[248:249], v255, s[36:39], s62 offen sc1
    v_cvt_pk_bf16_f32 v149, v126, v127
    v_mfma_f32_16x16x32_bf16 v[56:59], a[152:155], a[60:63], v[56:59]
    buffer_load_dwordx4 a[220:223], v2, s[36:39], s55 offen offset:1024
    v_cvt_pk_bf16_f32 v150, v128, v129
    v_cvt_pk_bf16_f32 v151, v130, v131
    v_mfma_f32_16x16x32_bf16 v[56:59], a[148:151], a[44:47], v[56:59]
    v_lshlrev_b32 v132, 16, v108
    v_and_b32 v133, 0xffff0000, v108
    v_lshlrev_b32 v134, 16, v109
    v_mfma_f32_16x16x32_bf16 a[4:7], a[148:151], a[48:51], 0
    ds_write_b128 v7, v[148:151] offset:24960
    v_and_b32 v135, 0xffff0000, v109
    v_mfma_f32_16x16x32_bf16 a[4:7], a[152:155], a[64:67], a[4:7]
    v_lshlrev_b32 v136, 16, v110
    v_and_b32 v137, 0xffff0000, v110
    v_lshlrev_b32 v138, 16, v111
    v_mfma_f32_16x16x32_bf16 a[4:7], a[156:159], a[80:83], a[4:7]
    buffer_load_dwordx4 a[224:227], v2, s[36:39], s55 offen offset:2048
    v_and_b32 v139, 0xffff0000, v111
    v_sub_f32 v124, v196, v132
    v_mfma_f32_16x16x32_bf16 a[24:27], a[156:159], a[84:87], 0
    v_sub_f32 v125, v197, v133
    v_sub_f32 v126, v198, v134
    v_mfma_f32_16x16x32_bf16 a[24:27], a[152:155], a[68:71], a[24:27]
    v_sub_f32 v127, v199, v135
    v_sub_f32 v128, v200, v136
    v_sub_f32 v129, v201, v137
    v_mfma_f32_16x16x32_bf16 a[24:27], a[148:151], a[52:55], a[24:27]
    buffer_load_dwordx4 a[228:231], v2, s[36:39], s55 offen offset:3072
    s_waitcnt vmcnt(20)
    v_mfma_f32_16x16x32_bf16 v[40:43], a[160:163], a[40:43], 0
    s_add_u32 s55, s24, 24576
    v_sub_f32 v130, v202, v138
    v_sub_f32 v131, v203, v139
    v_mfma_f32_16x16x32_bf16 v[40:43], a[164:167], a[56:59], v[40:43]
    v_cvt_pk_bf16_f32 v140, v124, v125
    v_cvt_pk_bf16_f32 v141, v126, v127
    v_cvt_pk_bf16_f32 v142, v128, v129
    v_mfma_f32_16x16x32_bf16 v[40:43], a[168:171], a[72:75], v[40:43]
    buffer_load_dwordx4 a[232:235], v2, s[36:39], s55 offen offset:0
    v_cvt_pk_bf16_f32 v143, v130, v131
    v_mfma_f32_16x16x32_bf16 v[60:63], a[168:171], a[76:79], 0
    v_lshlrev_b32 v132, 16, v120
    v_and_b32 v133, 0xffff0000, v120
    v_lshlrev_b32 v134, 16, v121
    v_mfma_f32_16x16x32_bf16 v[60:63], a[164:167], a[60:63], v[60:63]
    ds_write_b128 v7, v[140:143] offset:16640
    v_and_b32 v135, 0xffff0000, v121
    v_mfma_f32_16x16x32_bf16 v[60:63], a[160:163], a[44:47], v[60:63]
    buffer_load_dwordx4 a[236:239], v2, s[36:39], s55 offen offset:1024
    v_lshlrev_b32 v136, 16, v122
    v_and_b32 v137, 0xffff0000, v122
    v_mfma_f32_16x16x32_bf16 a[8:11], a[160:163], a[48:51], 0
    v_lshlrev_b32 v138, 16, v123
    v_and_b32 v139, 0xffff0000, v123
    v_sub_f32 v124, v188, v132
    v_mfma_f32_16x16x32_bf16 a[8:11], a[164:167], a[64:67], a[8:11]
    v_sub_f32 v125, v189, v133
    v_sub_f32 v126, v190, v134
    v_mfma_f32_16x16x32_bf16 a[8:11], a[168:171], a[80:83], a[8:11]
    buffer_load_dwordx4 a[240:243], v2, s[36:39], s55 offen offset:2048
    v_sub_f32 v127, v191, v135
    v_sub_f32 v128, v192, v136
    v_mfma_f32_16x16x32_bf16 a[28:31], a[168:171], a[84:87], 0
    v_sub_f32 v129, v193, v137
    v_sub_f32 v130, v194, v138
    v_sub_f32 v131, v195, v139
    v_mfma_f32_16x16x32_bf16 a[28:31], a[164:167], a[68:71], a[28:31]
    v_cvt_pk_bf16_f32 v152, v124, v125
    v_cvt_pk_bf16_f32 v153, v126, v127
    v_mfma_f32_16x16x32_bf16 a[28:31], a[160:163], a[52:55], a[28:31]
    buffer_load_dwordx4 a[244:247], v2, s[36:39], s55 offen offset:3072
    s_add_u32 s55, s24, 28672
    s_waitcnt vmcnt(21)
    v_mfma_f32_16x16x32_bf16 v[44:47], a[172:175], a[40:43], 0
    v_cvt_pk_bf16_f32 v154, v128, v129
    v_cvt_pk_bf16_f32 v155, v130, v131
    v_mfma_f32_16x16x32_bf16 v[44:47], a[176:179], a[56:59], v[44:47]
    s_waitcnt vmcnt(13)
    v_lshlrev_b32 v188, 16, v96
    v_and_b32 v189, 0xffff0000, v96
    v_mfma_f32_16x16x32_bf16 v[44:47], a[180:183], a[72:75], v[44:47]
    ds_write_b128 v7, v[152:155] offset:29120
    v_lshlrev_b32 v190, 16, v97
    v_and_b32 v191, 0xffff0000, v97
    v_mfma_f32_16x16x32_bf16 v[64:67], a[180:183], a[76:79], 0
    buffer_load_dwordx4 v[112:115], v2, s[20:23], s7 offen offset:2048
    v_lshlrev_b32 v192, 16, v98
    v_mfma_f32_16x16x32_bf16 v[64:67], a[176:179], a[60:63], v[64:67]
    v_and_b32 v193, 0xffff0000, v98
    v_lshlrev_b32 v194, 16, v99
    v_and_b32 v195, 0xffff0000, v99
    v_mfma_f32_16x16x32_bf16 v[64:67], a[172:175], a[44:47], v[64:67]
    v_lshlrev_b32 v196, 16, v100
    v_and_b32 v197, 0xffff0000, v100
    v_lshlrev_b32 v198, 16, v101
    v_mfma_f32_16x16x32_bf16 a[12:15], a[172:175], a[48:51], 0
    s_waitcnt lgkmcnt(0)
    s_barrier
    v_mfma_f32_16x16x32_bf16 a[12:15], a[176:179], a[64:67], a[12:15]
    ds_read_b128 a[88:91], v5 offset:16640
    buffer_load_dwordx4 v[116:119], v244, s[20:23], s7 offen offset:0
    v_and_b32 v199, 0xffff0000, v101
    v_mfma_f32_16x16x32_bf16 a[12:15], a[180:183], a[80:83], a[12:15]
    ds_read_b128 a[104:107], v5 offset:16672
    v_lshlrev_b32 v200, 16, v102
    v_mfma_f32_16x16x32_bf16 a[32:35], a[180:183], a[84:87], 0
    ds_read_b128 a[120:123], v5 offset:16704
    v_and_b32 v201, 0xffff0000, v102
    v_lshlrev_b32 v202, 16, v103
    v_mfma_f32_16x16x32_bf16 a[32:35], a[176:179], a[68:71], a[32:35]
    ds_read_b128 a[92:95], v5 offset:17152
    buffer_load_dwordx4 v[108:111], v2, s[40:43], s7 offen offset:0
    v_and_b32 v203, 0xffff0000, v103
    v_mfma_f32_16x16x32_bf16 a[32:35], a[172:175], a[52:55], a[32:35]
    ds_read_b128 a[108:111], v5 offset:17184
    v_add_f32 v124, v188, v196
    v_mfma_f32_16x16x32_bf16 v[48:51], a[184:187], a[40:43], 0
    ds_read_b128 a[124:127], v5 offset:17216
    v_add_f32 v125, v189, v197
    v_add_f32 v126, v190, v198
    v_mfma_f32_16x16x32_bf16 v[48:51], a[188:191], a[56:59], v[48:51]
    ds_read_b128 a[96:99], v6 offset:16640
    buffer_load_dwordx4 v[120:123], v244, s[44:47], s7 offen offset:2048
    s_cmp_eq_u32 s77, 0
    s_cbranch_scc1 L_now2
    buffer_store_dwordx4 v[156:159], v31, s[36:39], s70 offen sc1
    buffer_store_dwordx4 v[160:163], v31, s[36:39], s71 offen sc1
    buffer_store_dwordx4 v[164:167], v31, s[36:39], s72 offen sc1
    buffer_store_dwordx4 v[168:171], v31, s[36:39], s73 offen sc1
L_now2:
    v_mfma_f32_16x16x32_bf16 v[48:51], a[192:195], a[72:75], v[48:51]
    ds_read_b128 a[112:115], v6 offset:16672
    v_add_f32 v127, v191, v199
    v_mfma_f32_16x16x32_bf16 v[68:71], a[192:195], a[76:79], 0
    ds_read_b128 a[128:131], v6 offset:16704
    v_add_f32 v128, v192, v200
    v_add_f32 v129, v193, v201
    v_mfma_f32_16x16x32_bf16 v[68:71], a[188:191], a[60:63], v[68:71]
    ds_read_b128 a[100:103], v6 offset:17152
    buffer_load_dwordx4 a[248:251], v2, s[36:39], s55 offen offset:0
    v_mfma_f32_16x16x32_bf16 v[68:71], a[184:187], a[44:47], v[68:71]
    ds_read_b128 a[116:119], v6 offset:17184
    v_add_f32 v130, v194, v202
    v_add_f32 v131, v195, v203
    v_mfma_f32_16x16x32_bf16 a[16:19], a[184:187], a[48:51], 0
    ds_read_b128 a[132:135], v6 offset:17216
    v_cvt_pk_bf16_f32 v144, v124, v125
    v_cvt_pk_bf16_f32 v145, v126, v127
    v_mfma_f32_16x16x32_bf16 a[16:19], a[188:191], a[64:67], a[16:19]
    buffer_load_dwordx4 a[252:255], v2, s[36:39], s55 offen offset:1024
    v_cvt_pk_bf16_f32 v146, v128, v129
    v_mfma_f32_16x16x32_bf16 a[16:19], a[192:195], a[80:83], a[16:19]
    v_cvt_pk_bf16_f32 v147, v130, v131
    v_sub_f32 v124, v196, v188
    v_sub_f32 v125, v197, v189
    v_mfma_f32_16x16x32_bf16 a[36:39], a[192:195], a[84:87], 0
    ds_write_b128 v7, v[144:147] offset:4160
    v_sub_f32 v126, v198, v190
    v_mfma_f32_16x16x32_bf16 a[36:39], a[188:191], a[68:71], a[36:39]
    buffer_load_dwordx4 a[136:139], v2, s[36:39], s55 offen offset:2048
    v_sub_f32 v127, v199, v191
    v_sub_f32 v128, v200, v192
    v_mfma_f32_16x16x32_bf16 a[36:39], a[184:187], a[52:55], a[36:39]
    s_mov_b32 s58, s25
    s_mov_b32 s59, 0
    s_waitcnt vmcnt(18) lgkmcnt(10)
    v_mfma_f32_16x16x32_bf16 v[32:35], a[196:199], a[88:91], v[32:35]
    s_waitcnt vmcnt(14)
    v_cmp_ne_u64 vcc, s[52:53], v[248:249]
    v_mfma_f32_16x16x32_bf16 v[32:35], a[200:203], a[104:107], v[32:35]
    s_and_b64 vcc, vcc, s[58:59]
    s_cbranch_scc1 L_actb0_slow
L_actb0_ok:
    v_sub_f32 v129, v201, v193
    v_sub_f32 v130, v202, v194
    v_mfma_f32_16x16x32_bf16 v[32:35], a[204:207], a[120:123], v[32:35]
    buffer_load_dwordx4 a[140:143], v2, s[36:39], s55 offen offset:3072
    s_add_u32 s55, s24, 32768
    s_waitcnt lgkmcnt(7)
    v_mfma_f32_16x16x32_bf16 v[52:55], a[204:207], a[124:127], v[52:55]
    v_sub_f32 v131, v203, v195
    v_cvt_pk_bf16_f32 v148, v124, v125
    v_mfma_f32_16x16x32_bf16 v[52:55], a[200:203], a[108:111], v[52:55]
    v_cvt_pk_bf16_f32 v149, v126, v127
    v_cvt_pk_bf16_f32 v150, v128, v129
    v_cvt_pk_bf16_f32 v151, v130, v131
    v_mfma_f32_16x16x32_bf16 v[52:55], a[196:199], a[92:95], v[52:55]
    buffer_load_dwordx4 a[144:147], v2, s[36:39], s55 offen offset:0
    s_waitcnt lgkmcnt(4)
    v_mfma_f32_16x16x32_bf16 a[0:3], a[196:199], a[96:99], a[0:3]
    v_lshlrev_b32 v132, 16, v92
    v_and_b32 v133, 0xffff0000, v92
    v_lshlrev_b32 v134, 16, v93
    v_mfma_f32_16x16x32_bf16 a[0:3], a[200:203], a[112:115], a[0:3]
    ds_write_b128 v7, v[148:151] offset:8320
    v_and_b32 v135, 0xffff0000, v93
    v_lshlrev_b32 v136, 16, v94
    v_mfma_f32_16x16x32_bf16 a[0:3], a[204:207], a[128:131], a[0:3]
    buffer_load_dwordx4 a[148:151], v2, s[36:39], s55 offen offset:1024
    s_waitcnt lgkmcnt(2)
    v_mfma_f32_16x16x32_bf16 a[20:23], a[204:207], a[132:135], a[20:23]
    v_and_b32 v137, 0xffff0000, v94
    v_lshlrev_b32 v138, 16, v95
    v_and_b32 v139, 0xffff0000, v95
    v_mfma_f32_16x16x32_bf16 a[20:23], a[200:203], a[116:119], a[20:23]
    v_sub_f32 v124, v196, v132
    v_sub_f32 v125, v197, v133
    v_sub_f32 v126, v198, v134
    v_mfma_f32_16x16x32_bf16 a[20:23], a[196:199], a[100:103], a[20:23]
    buffer_load_dwordx4 a[152:155], v2, s[36:39], s55 offen offset:2048
    v_sub_f32 v127, v199, v135
    v_mfma_f32_16x16x32_bf16 v[36:39], a[208:211], a[88:91], v[36:39]
    v_sub_f32 v128, v200, v136
    v_sub_f32 v129, v201, v137
    v_sub_f32 v130, v202, v138
    v_mfma_f32_16x16x32_bf16 v[36:39], a[212:215], a[104:107], v[36:39]
    v_sub_f32 v131, v203, v139
    v_cvt_pk_bf16_f32 v140, v124, v125
    v_mfma_f32_16x16x32_bf16 v[36:39], a[216:219], a[120:123], v[36:39]
    buffer_load_dwordx4 a[156:159], v2, s[36:39], s55 offen offset:3072
    s_add_u32 s55, s24, 36864
    v_cvt_pk_bf16_f32 v141, v126, v127
    v_mfma_f32_16x16x32_bf16 v[56:59], a[216:219], a[124:127], v[56:59]
    v_cvt_pk_bf16_f32 v142, v128, v129
    v_cvt_pk_bf16_f32 v143, v130, v131
    v_lshlrev_b32 v132, 16, v104
    v_mfma_f32_16x16x32_bf16 v[56:59], a[212:215], a[108:111], v[56:59]
    ds_write_b128 v7, v[140:143] offset:0
    v_and_b32 v133, 0xffff0000, v104
    v_mfma_f32_16x16x32_bf16 v[56:59], a[208:211], a[92:95], v[56:59]
    buffer_load_dwordx4 a[160:163], v2, s[36:39], s55 offen offset:0
    v_lshlrev_b32 v134, 16, v105
    v_and_b32 v135, 0xffff0000, v105
    v_mfma_f32_16x16x32_bf16 a[4:7], a[208:211], a[96:99], a[4:7]
    v_lshlrev_b32 v136, 16, v106
    v_and_b32 v137, 0xffff0000, v106
    v_mfma_f32_16x16x32_bf16 a[4:7], a[212:215], a[112:115], a[4:7]
    v_lshlrev_b32 v138, 16, v107
    v_and_b32 v139, 0xffff0000, v107
    v_sub_f32 v124, v188, v132
    v_mfma_f32_16x16x32_bf16 a[4:7], a[216:219], a[128:131], a[4:7]
    v_sub_f32 v125, v189, v133
    v_sub_f32 v126, v190, v134
    v_sub_f32 v127, v191, v135
    v_mfma_f32_16x16x32_bf16 a[24:27], a[216:219], a[132:135], a[24:27]
    buffer_load_dwordx4 a[164:167], v2, s[36:39], s55 offen offset:1024
    v_sub_f32 v128, v192, v136
    v_mfma_f32_16x16x32_bf16 a[24:27], a[212:215], a[116:119], a[24:27]
    v_sub_f32 v129, v193, v137
    v_sub_f32 v130, v194, v138
    v_sub_f32 v131, v195, v139
    v_mfma_f32_16x16x32_bf16 a[24:27], a[208:211], a[100:103], a[24:27]
    v_cvt_pk_bf16_f32 v152, v124, v125
    v_cvt_pk_bf16_f32 v153, v126, v127
    s_waitcnt vmcnt(18)
    v_mfma_f32_16x16x32_bf16 v[40:43], a[220:223], a[88:91], v[40:43]
    buffer_load_dwordx4 a[168:171], v2, s[36:39], s55 offen offset:2048
    v_cvt_pk_bf16_f32 v154, v128, v129
    v_mfma_f32_16x16x32_bf16 v[40:43], a[224:227], a[104:107], v[40:43]
    v_cvt_pk_bf16_f32 v155, v130, v131
    s_waitcnt vmcnt(11)
    v_lshlrev_b32 v188, 16, v112
    v_mfma_f32_16x16x32_bf16 v[40:43], a[228:231], a[120:123], v[40:43]
    ds_write_b128 v7, v[152:155] offset:12480
    ds_read_b128 v[96:99], v14 offset:8192
    v_mfma_f32_16x16x32_bf16 v[60:63], a[228:231], a[124:127], v[60:63]
    ds_read_b128 v[100:103], v14 offset:10240
    v_and_b32 v189, 0xffff0000, v112
    v_lshlrev_b32 v190, 16, v113
    v_mfma_f32_16x16x32_bf16 v[60:63], a[224:227], a[108:111], v[60:63]
    buffer_load_dwordx4 v[92:95], v2, s[40:43], s8 offen offset:0
    v_and_b32 v191, 0xffff0000, v113
    v_lshlrev_b32 v192, 16, v114
    v_mfma_f32_16x16x32_bf16 v[60:63], a[220:223], a[92:95], v[60:63]
    v_and_b32 v193, 0xffff0000, v114
    v_lshlrev_b32 v194, 16, v115
    v_mfma_f32_16x16x32_bf16 a[8:11], a[220:223], a[96:99], a[8:11]
    s_waitcnt lgkmcnt(2)
    s_barrier
    ds_read_b128 a[40:43], v5 offset:0
    v_mfma_f32_16x16x32_bf16 a[8:11], a[224:227], a[112:115], a[8:11]
    ds_read_b128 a[56:59], v5 offset:32
    buffer_load_dwordx4 v[104:107], v244, s[44:47], s8 offen offset:2048
    v_and_b32 v195, 0xffff0000, v115
    v_mfma_f32_16x16x32_bf16 a[8:11], a[228:231], a[128:131], a[8:11]
    ds_read_b128 a[72:75], v5 offset:64
    v_lshlrev_b32 v196, 16, v116
    v_mfma_f32_16x16x32_bf16 a[28:31], a[228:231], a[132:135], a[28:31]
    ds_read_b128 a[44:47], v5 offset:512
    v_and_b32 v197, 0xffff0000, v116
    v_lshlrev_b32 v198, 16, v117
    v_mfma_f32_16x16x32_bf16 a[28:31], a[224:227], a[116:119], a[28:31]
    ds_read_b128 a[60:63], v5 offset:544
    buffer_load_dwordx4 a[172:175], v2, s[36:39], s55 offen offset:3072
    v_mfma_f32_16x16x32_bf16 a[28:31], a[220:223], a[100:103], a[28:31]
    ds_read_b128 a[76:79], v5 offset:576
    s_add_u32 s55, s24, 40960
    v_and_b32 v199, 0xffff0000, v117
    v_mfma_f32_16x16x32_bf16 v[44:47], a[232:235], a[88:91], v[44:47]
    ds_read_b128 a[48:51], v6 offset:0
    v_lshlrev_b32 v200, 16, v118
    v_and_b32 v201, 0xffff0000, v118
    v_mfma_f32_16x16x32_bf16 v[44:47], a[236:239], a[104:107], v[44:47]
    ds_read_b128 a[64:67], v6 offset:32
    buffer_load_dwordx4 a[176:179], v2, s[36:39], s55 offen offset:0
    v_mfma_f32_16x16x32_bf16 v[44:47], a[240:243], a[120:123], v[44:47]
    ds_read_b128 a[80:83], v6 offset:64
    v_lshlrev_b32 v202, 16, v119
    v_and_b32 v203, 0xffff0000, v119
    v_mfma_f32_16x16x32_bf16 v[64:67], a[240:243], a[124:127], v[64:67]
    ds_read_b128 a[52:55], v6 offset:512
    v_add_f32 v124, v188, v196
    v_add_f32 v125, v189, v197
    v_mfma_f32_16x16x32_bf16 v[64:67], a[236:239], a[108:111], v[64:67]
    ds_read_b128 a[68:71], v6 offset:544
    buffer_load_dwordx4 a[180:183], v2, s[36:39], s55 offen offset:1024
    v_mfma_f32_16x16x32_bf16 v[64:67], a[232:235], a[92:95], v[64:67]
    ds_read_b128 a[84:87], v6 offset:576
    v_add_f32 v126, v190, v198
    v_add_f32 v127, v191, v199
    v_mfma_f32_16x16x32_bf16 a[12:15], a[232:235], a[96:99], a[12:15]
    v_add_f32 v128, v192, v200
    v_add_f32 v129, v193, v201
    v_mfma_f32_16x16x32_bf16 a[12:15], a[236:239], a[112:115], a[12:15]
    buffer_load_dwordx4 a[184:187], v2, s[36:39], s55 offen offset:2048
    v_add_f32 v130, v194, v202
    v_add_f32 v131, v195, v203
    v_mfma_f32_16x16x32_bf16 a[12:15], a[240:243], a[128:131], a[12:15]
    v_cvt_pk_bf16_f32 v144, v124, v125
    v_cvt_pk_bf16_f32 v145, v126, v127
    v_cvt_pk_bf16_f32 v146, v128, v129
    v_mfma_f32_16x16x32_bf16 a[32:35], a[240:243], a[132:135], a[32:35]
    v_cvt_pk_bf16_f32 v147, v130, v131
    v_sub_f32 v124, v196, v188
    v_mfma_f32_16x16x32_bf16 a[32:35], a[236:239], a[116:119], a[32:35]
    ds_write_b128 v7, v[144:147] offset:20800
    v_sub_f32 v125, v197, v189
    v_sub_f32 v126, v198, v190
    v_mfma_f32_16x16x32_bf16 a[32:35], a[232:235], a[100:103], a[32:35]
    buffer_load_dwordx4 a[188:191], v2, s[36:39], s55 offen offset:3072
    s_waitcnt vmcnt(16)
    v_mfma_f32_16x16x32_bf16 v[48:51], a[244:247], a[88:91], v[48:51]
    s_add_u32 s55, s24, 45056
    v_sub_f32 v127, v199, v191
    v_sub_f32 v128, v200, v192
    v_mfma_f32_16x16x32_bf16 v[48:51], a[248:251], a[104:107], v[48:51]
    v_sub_f32 v129, v201, v193
    v_sub_f32 v130, v202, v194
    v_sub_f32 v131, v203, v195
    v_mfma_f32_16x16x32_bf16 v[48:51], a[252:255], a[120:123], v[48:51]
    buffer_load_dwordx4 a[192:195], v2, s[36:39], s55 offen offset:0
    v_cvt_pk_bf16_f32 v148, v124, v125
    v_mfma_f32_16x16x32_bf16 v[68:71], a[252:255], a[124:127], v[68:71]
    v_cvt_pk_bf16_f32 v149, v126, v127
    v_cvt_pk_bf16_f32 v150, v128, v129
    v_cvt_pk_bf16_f32 v151, v130, v131
    v_mfma_f32_16x16x32_bf16 v[68:71], a[248:251], a[108:111], v[68:71]
    v_lshlrev_b32 v132, 16, v108
    v_and_b32 v133, 0xffff0000, v108
    v_lshlrev_b32 v134, 16, v109
    v_mfma_f32_16x16x32_bf16 v[68:71], a[244:247], a[92:95], v[68:71]
    ds_write_b128 v7, v[148:151] offset:24960
    buffer_load_dwordx4 a[196:199], v2, s[36:39], s55 offen offset:1024
    v_mfma_f32_16x16x32_bf16 a[16:19], a[244:247], a[96:99], a[16:19]
    v_and_b32 v135, 0xffff0000, v109
    v_lshlrev_b32 v136, 16, v110
    v_and_b32 v137, 0xffff0000, v110
    v_mfma_f32_16x16x32_bf16 a[16:19], a[248:251], a[112:115], a[16:19]
    v_lshlrev_b32 v138, 16, v111
    v_and_b32 v139, 0xffff0000, v111
    v_mfma_f32_16x16x32_bf16 a[16:19], a[252:255], a[128:131], a[16:19]
    buffer_load_dwordx4 a[200:203], v2, s[36:39], s55 offen offset:2048
    v_sub_f32 v124, v196, v132
    v_sub_f32 v125, v197, v133
    v_mfma_f32_16x16x32_bf16 a[36:39], a[252:255], a[132:135], a[36:39]
    v_sub_f32 v126, v198, v134
    v_sub_f32 v127, v199, v135
    v_sub_f32 v128, v200, v136
    v_mfma_f32_16x16x32_bf16 a[36:39], a[248:251], a[116:119], a[36:39]
    v_sub_f32 v129, v201, v137
    v_sub_f32 v130, v202, v138
    v_mfma_f32_16x16x32_bf16 a[36:39], a[244:247], a[100:103], a[36:39]
    buffer_load_dwordx4 a[204:207], v2, s[36:39], s55 offen offset:3072
    s_add_u32 s55, s24, 49152
    s_waitcnt vmcnt(17) lgkmcnt(2)
    v_mfma_f32_16x16x32_bf16 v[32:35], a[136:139], a[40:43], v[32:35]
    v_sub_f32 v131, v203, v139
    v_cvt_pk_bf16_f32 v140, v124, v125
    v_mfma_f32_16x16x32_bf16 v[32:35], a[140:143], a[56:59], v[32:35]
    v_cvt_pk_bf16_f32 v141, v126, v127
    v_cvt_pk_bf16_f32 v142, v128, v129
    v_mfma_f32_16x16x32_bf16 v[32:35], a[144:147], a[72:75], v[32:35]
    buffer_load_dwordx4 a[208:211], v2, s[36:39], s55 offen offset:0
    v_cvt_pk_bf16_f32 v143, v130, v131
    v_lshlrev_b32 v132, 16, v120
    v_mfma_f32_16x16x32_bf16 v[52:55], a[144:147], a[76:79], v[52:55]
    ds_write_b128 v7, v[140:143] offset:16640
    v_and_b32 v133, 0xffff0000, v120
    v_mfma_f32_16x16x32_bf16 v[52:55], a[140:143], a[60:63], v[52:55]
    v_lshlrev_b32 v134, 16, v121
    v_and_b32 v135, 0xffff0000, v121
    v_mfma_f32_16x16x32_bf16 v[52:55], a[136:139], a[44:47], v[52:55]
    v_lshlrev_b32 v136, 16, v122
    v_and_b32 v137, 0xffff0000, v122
    v_mfma_f32_16x16x32_bf16 a[0:3], a[136:139], a[48:51], a[0:3]
    buffer_load_dwordx4 a[212:215], v2, s[36:39], s55 offen offset:1024
    v_lshlrev_b32 v138, 16, v123
    v_mfma_f32_16x16x32_bf16 a[0:3], a[140:143], a[64:67], a[0:3]
    v_and_b32 v139, 0xffff0000, v123
    v_sub_f32 v124, v188, v132
    v_sub_f32 v125, v189, v133
    v_mfma_f32_16x16x32_bf16 a[0:3], a[144:147], a[80:83], a[0:3]
    v_sub_f32 v126, v190, v134
    v_sub_f32 v127, v191, v135
    v_mfma_f32_16x16x32_bf16 a[20:23], a[144:147], a[84:87], a[20:23]
    buffer_load_dwordx4 a[216:219], v2, s[36:39], s55 offen offset:2048
    v_sub_f32 v128, v192, v136
    v_mfma_f32_16x16x32_bf16 a[20:23], a[140:143], a[68:71], a[20:23]
    v_sub_f32 v129, v193, v137
    v_sub_f32 v130, v194, v138
    v_mfma_f32_16x16x32_bf16 a[20:23], a[136:139], a[52:55], a[20:23]
    v_sub_f32 v131, v195, v139
    s_waitcnt vmcnt(17)
    v_mfma_f32_16x16x32_bf16 v[36:39], a[148:151], a[40:43], v[36:39]
    buffer_load_dwordx4 a[220:223], v2, s[36:39], s55 offen offset:3072
    s_add_u32 s55, s24, 53248
    v_cvt_pk_bf16_f32 v152, v124, v125
    v_mfma_f32_16x16x32_bf16 v[36:39], a[152:155], a[56:59], v[36:39]
    v_cvt_pk_bf16_f32 v153, v126, v127
    v_cvt_pk_bf16_f32 v154, v128, v129
    v_mfma_f32_16x16x32_bf16 v[36:39], a[156:159], a[72:75], v[36:39]
    v_cvt_pk_bf16_f32 v155, v130, v131
    v_lshlrev_b32 v188, 16, v96
    v_mfma_f32_16x16x32_bf16 v[56:59], a[156:159], a[76:79], v[56:59]
    ds_write_b128 v7, v[152:155] offset:29120
    buffer_load_dwordx4 v[112:115], v2, s[20:23], s9 offen offset:2048
    v_mfma_f32_16x16x32_bf16 v[56:59], a[152:155], a[60:63], v[56:59]
    v_and_b32 v189, 0xffff0000, v96
    v_lshlrev_b32 v190, 16, v97
    v_mfma_f32_16x16x32_bf16 v[56:59], a[148:151], a[44:47], v[56:59]
    v_and_b32 v191, 0xffff0000, v97
    v_lshlrev_b32 v192, 16, v98
    v_and_b32 v193, 0xffff0000, v98
    v_mfma_f32_16x16x32_bf16 a[4:7], a[148:151], a[48:51], a[4:7]
    buffer_load_dwordx4 v[116:119], v244, s[20:23], s9 offen offset:0
    v_lshlrev_b32 v194, 16, v99
    v_mfma_f32_16x16x32_bf16 a[4:7], a[152:155], a[64:67], a[4:7]
    s_waitcnt lgkmcnt(0)
    s_barrier
    v_mfma_f32_16x16x32_bf16 a[4:7], a[156:159], a[80:83], a[4:7]
    ds_read_b128 a[88:91], v5 offset:16640
    buffer_store_dwordx2 v[22:23], v247, s[36:39], s65 offen sc1
    v_mfma_f32_16x16x32_bf16 a[24:27], a[156:159], a[84:87], a[24:27]
    ds_read_b128 a[104:107], v5 offset:16672
    buffer_load_dwordx4 v[108:111], v2, s[40:43], s9 offen offset:0
    v_mfma_f32_16x16x32_bf16 a[24:27], a[152:155], a[68:71], a[24:27]
    ds_read_b128 a[120:123], v5 offset:16704
    v_and_b32 v195, 0xffff0000, v99
    v_lshlrev_b32 v196, 16, v100
    v_mfma_f32_16x16x32_bf16 a[24:27], a[148:151], a[52:55], a[24:27]
    ds_read_b128 a[92:95], v5 offset:17152
    s_waitcnt vmcnt(19)
    v_mfma_f32_16x16x32_bf16 v[40:43], a[160:163], a[40:43], v[40:43]
    ds_read_b128 a[108:111], v5 offset:17184
    v_and_b32 v197, 0xffff0000, v100
    v_mfma_f32_16x16x32_bf16 v[40:43], a[164:167], a[56:59], v[40:43]
    ds_read_b128 a[124:127], v5 offset:17216
    buffer_load_dwordx4 v[120:123], v244, s[44:47], s9 offen offset:2048
    v_mfma_f32_16x16x32_bf16 v[40:43], a[168:171], a[72:75], v[40:43]
    ds_read_b128 a[96:99], v6 offset:16640
    v_lshlrev_b32 v198, 16, v101
    v_mfma_f32_16x16x32_bf16 v[60:63], a[168:171], a[76:79], v[60:63]
    ds_read_b128 a[112:115], v6 offset:16672
    v_and_b32 v199, 0xffff0000, v101
    v_lshlrev_b32 v200, 16, v102
    v_mfma_f32_16x16x32_bf16 v[60:63], a[164:167], a[60:63], v[60:63]
    ds_read_b128 a[128:131], v6 offset:16704
    buffer_load_dwordx4 a[224:227], v2, s[36:39], s55 offen offset:0
    v_mfma_f32_16x16x32_bf16 v[60:63], a[160:163], a[44:47], v[60:63]
    ds_read_b128 a[100:103], v6 offset:17152
    v_and_b32 v201, 0xffff0000, v102
    v_mfma_f32_16x16x32_bf16 a[8:11], a[160:163], a[48:51], a[8:11]
    ds_read_b128 a[116:119], v6 offset:17184
    v_lshlrev_b32 v202, 16, v103
    v_mfma_f32_16x16x32_bf16 a[8:11], a[164:167], a[64:67], a[8:11]
    ds_read_b128 a[132:135], v6 offset:17216
    buffer_load_dwordx4 a[228:231], v2, s[36:39], s55 offen offset:1024
    v_mfma_f32_16x16x32_bf16 a[8:11], a[168:171], a[80:83], a[8:11]
    v_and_b32 v203, 0xffff0000, v103
    v_add_f32 v124, v188, v196
    v_add_f32 v125, v189, v197
    v_mfma_f32_16x16x32_bf16 a[28:31], a[168:171], a[84:87], a[28:31]
    v_add_f32 v126, v190, v198
    v_add_f32 v127, v191, v199
    v_mfma_f32_16x16x32_bf16 a[28:31], a[164:167], a[68:71], a[28:31]
    buffer_load_dwordx4 a[232:235], v2, s[36:39], s55 offen offset:2048
    v_add_f32 v128, v192, v200
    v_mfma_f32_16x16x32_bf16 a[28:31], a[160:163], a[52:55], a[28:31]
    v_add_f32 v129, v193, v201
    s_waitcnt vmcnt(18)
    v_mfma_f32_16x16x32_bf16 v[44:47], a[172:175], a[40:43], v[44:47]
    v_add_f32 v130, v194, v202
    v_add_f32 v131, v195, v203
    v_mfma_f32_16x16x32_bf16 v[44:47], a[176:179], a[56:59], v[44:47]
    buffer_load_dwordx4 a[236:239], v2, s[36:39], s55 offen offset:3072
    s_add_u32 s55, s24, 57344
    v_cvt_pk_bf16_f32 v144, v124, v125
    v_mfma_f32_16x16x32_bf16 v[44:47], a[180:183], a[72:75], v[44:47]
    v_cvt_pk_bf16_f32 v145, v126, v127
    v_cvt_pk_bf16_f32 v146, v128, v129
    v_mfma_f32_16x16x32_bf16 v[64:67], a[180:183], a[76:79], v[64:67]
    v_cvt_pk_bf16_f32 v147, v130, v131
    v_sub_f32 v124, v196, v188
    v_mfma_f32_16x16x32_bf16 v[64:67], a[176:179], a[60:63], v[64:67]
    ds_write_b128 v7, v[144:147] offset:4160
    v_sub_f32 v125, v197, v189
    v_mfma_f32_16x16x32_bf16 v[64:67], a[172:175], a[44:47], v[64:67]
    buffer_load_dwordx4 a[240:243], v2, s[36:39], s55 offen offset:0
    v_sub_f32 v126, v198, v190
    v_mfma_f32_16x16x32_bf16 a[12:15], a[172:175], a[48:51], a[12:15]
    v_sub_f32 v127, v199, v191
    v_sub_f32 v128, v200, v192
    v_sub_f32 v129, v201, v193
    v_mfma_f32_16x16x32_bf16 a[12:15], a[176:179], a[64:67], a[12:15]
    v_sub_f32 v130, v202, v194
    v_sub_f32 v131, v203, v195
    v_mfma_f32_16x16x32_bf16 a[12:15], a[180:183], a[80:83], a[12:15]
    buffer_load_dwordx4 a[244:247], v2, s[36:39], s55 offen offset:1024
    v_cvt_pk_bf16_f32 v148, v124, v125
    v_mfma_f32_16x16x32_bf16 a[32:35], a[180:183], a[84:87], a[32:35]
    v_cvt_pk_bf16_f32 v149, v126, v127
    v_cvt_pk_bf16_f32 v150, v128, v129
    v_mfma_f32_16x16x32_bf16 a[32:35], a[176:179], a[68:71], a[32:35]
    v_cvt_pk_bf16_f32 v151, v130, v131
    v_lshlrev_b32 v132, 16, v92
    v_mfma_f32_16x16x32_bf16 a[32:35], a[172:175], a[52:55], a[32:35]
    ds_write_b128 v7, v[148:151] offset:8320
    buffer_load_dwordx4 a[248:251], v2, s[36:39], s55 offen offset:2048
    s_waitcnt vmcnt(19)
    v_mfma_f32_16x16x32_bf16 v[48:51], a[184:187], a[40:43], v[48:51]
    v_and_b32 v133, 0xffff0000, v92
    v_lshlrev_b32 v134, 16, v93
    v_mfma_f32_16x16x32_bf16 v[48:51], a[188:191], a[56:59], v[48:51]
    v_and_b32 v135, 0xffff0000, v93
    v_lshlrev_b32 v136, 16, v94
    v_mfma_f32_16x16x32_bf16 v[48:51], a[192:195], a[72:75], v[48:51]
    buffer_load_dwordx4 a[252:255], v2, s[36:39], s55 offen offset:3072
    s_add_u32 s55, s24, 61440
    v_mfma_f32_16x16x32_bf16 v[68:71], a[192:195], a[76:79], v[68:71]
    v_and_b32 v137, 0xffff0000, v94
    v_lshlrev_b32 v138, 16, v95
    v_mfma_f32_16x16x32_bf16 v[68:71], a[188:191], a[60:63], v[68:71]
    v_and_b32 v139, 0xffff0000, v95
    v_sub_f32 v124, v196, v132
    v_sub_f32 v125, v197, v133
    v_mfma_f32_16x16x32_bf16 v[68:71], a[184:187], a[44:47], v[68:71]
    buffer_load_dwordx4 a[136:139], v2, s[36:39], s55 offen offset:0
    v_sub_f32 v126, v198, v134
    v_mfma_f32_16x16x32_bf16 a[16:19], a[184:187], a[48:51], a[16:19]
    v_sub_f32 v127, v199, v135
    v_sub_f32 v128, v200, v136
    v_mfma_f32_16x16x32_bf16 a[16:19], a[188:191], a[64:67], a[16:19]
    v_sub_f32 v129, v201, v137
    v_sub_f32 v130, v202, v138
    v_mfma_f32_16x16x32_bf16 a[16:19], a[192:195], a[80:83], a[16:19]
    buffer_load_dwordx4 a[140:143], v2, s[36:39], s55 offen offset:1024
    v_sub_f32 v131, v203, v139
    v_mfma_f32_16x16x32_bf16 a[36:39], a[192:195], a[84:87], a[36:39]
    v_cvt_pk_bf16_f32 v140, v124, v125
    v_cvt_pk_bf16_f32 v141, v126, v127
    v_cvt_pk_bf16_f32 v142, v128, v129
    v_mfma_f32_16x16x32_bf16 a[36:39], a[188:191], a[68:71], a[36:39]
    v_cvt_pk_bf16_f32 v143, v130, v131
    v_lshlrev_b32 v132, 16, v104
    v_mfma_f32_16x16x32_bf16 a[36:39], a[184:187], a[52:55], a[36:39]
    ds_write_b128 v7, v[140:143] offset:0
    s_waitcnt vmcnt(19) lgkmcnt(3)
    v_mfma_f32_16x16x32_bf16 v[32:35], a[196:199], a[88:91], v[32:35]
    buffer_load_dwordx4 a[144:147], v2, s[36:39], s55 offen offset:2048
    v_and_b32 v133, 0xffff0000, v104
    v_mfma_f32_16x16x32_bf16 v[32:35], a[200:203], a[104:107], v[32:35]
    v_lshlrev_b32 v134, 16, v105
    v_and_b32 v135, 0xffff0000, v105
    v_mfma_f32_16x16x32_bf16 v[32:35], a[204:207], a[120:123], v[32:35]
    v_lshlrev_b32 v136, 16, v106
    v_and_b32 v137, 0xffff0000, v106
    v_lshlrev_b32 v138, 16, v107
    v_mfma_f32_16x16x32_bf16 v[52:55], a[204:207], a[124:127], v[52:55]
    buffer_load_dwordx4 a[148:151], v2, s[36:39], s55 offen offset:3072
    s_add_u32 s55, s24, 65536
    v_mfma_f32_16x16x32_bf16 v[52:55], a[200:203], a[108:111], v[52:55]
    v_and_b32 v139, 0xffff0000, v107
    v_sub_f32 v124, v188, v132
    v_mfma_f32_16x16x32_bf16 v[52:55], a[196:199], a[92:95], v[52:55]
    v_sub_f32 v125, v189, v133
    v_sub_f32 v126, v190, v134
    v_mfma_f32_16x16x32_bf16 a[0:3], a[196:199], a[96:99], a[0:3]
    buffer_load_dwordx4 a[152:155], v2, s[36:39], s55 offen offset:0
L_chain1:
L_page3:
    s_cbranch_execz L_page4
    v_sub_f32 v127, v191, v135
    v_mfma_f32_16x16x32_bf16 a[0:3], a[200:203], a[112:115], a[0:3]
    v_sub_f32 v128, v192, v136
    v_sub_f32 v129, v193, v137
    v_sub_f32 v130, v194, v138
    v_mfma_f32_16x16x32_bf16 a[0:3], a[204:207], a[128:131], a[0:3]
    v_sub_f32 v131, v195, v139
    v_cvt_pk_bf16_f32 v152, v124, v125
    v_mfma_f32_16x16x32_bf16 a[20:23], a[204:207], a[132:135], a[20:23]
    buffer_load_dwordx4 a[156:159], v2, s[36:39], s55 offen offset:1024
    v_cvt_pk_bf16_f32 v153, v126, v127
    v_mfma_f32_16x16x32_bf16 a[20:23], a[200:203], a[116:119], a[20:23]
    v_cvt_pk_bf16_f32 v154, v128, v129
    v_cvt_pk_bf16_f32 v155, v130, v131
    v_mfma_f32_16x16x32_bf16 a[20:23], a[196:199], a[100:103], a[20:23]
    s_waitcnt vmcnt(14)
    v_mfma_f32_16x16x32_bf16 v[36:39], a[208:211], a[88:91], v[36:39]
    ds_write_b128 v7, v[152:155] offset:12480
    buffer_load_dwordx4 v[96:99], v2, s[20:23], s10 offen offset:2048
    v_lshlrev_b32 v188, 16, v112
    v_mfma_f32_16x16x32_bf16 v[36:39], a[212:215], a[104:107], v[36:39]
    v_and_b32 v189, 0xffff0000, v112
    v_lshlrev_b32 v190, 16, v113
    v_mfma_f32_16x16x32_bf16 v[36:39], a[216:219], a[120:123], v[36:39]
    v_and_b32 v191, 0xffff0000, v113
    v_lshlrev_b32 v192, 16, v114
    v_mfma_f32_16x16x32_bf16 v[56:59], a[216:219], a[124:127], v[56:59]
    buffer_load_dwordx4 v[100:103], v244, s[20:23], s10 offen offset:0
    v_and_b32 v193, 0xffff0000, v114
    v_mfma_f32_16x16x32_bf16 v[56:59], a[212:215], a[108:111], v[56:59]
    s_waitcnt lgkmcnt(0)
    s_barrier
    v_mfma_f32_16x16x32_bf16 v[56:59], a[208:211], a[92:95], v[56:59]
    ds_read_b128 a[40:43], v5 offset:0
    v_lshlrev_b32 v194, 16, v115
    v_and_b32 v195, 0xffff0000, v115
    v_mfma_f32_16x16x32_bf16 a[4:7], a[208:211], a[96:99], a[4:7]
    ds_read_b128 a[56:59], v5 offset:32
    v_lshlrev_b32 v196, 16, v116
    v_mfma_f32_16x16x32_bf16 a[4:7], a[212:215], a[112:115], a[4:7]
    ds_read_b128 a[72:75], v5 offset:64
    buffer_load_dwordx4 v[92:95], v2, s[40:43], s10 offen offset:0
    v_mfma_f32_16x16x32_bf16 a[4:7], a[216:219], a[128:131], a[4:7]
    ds_read_b128 a[44:47], v5 offset:512
    v_and_b32 v197, 0xffff0000, v116
    v_mfma_f32_16x16x32_bf16 a[24:27], a[216:219], a[132:135], a[24:27]
    ds_read_b128 a[60:63], v5 offset:544
    v_lshlrev_b32 v198, 16, v117
    v_mfma_f32_16x16x32_bf16 a[24:27], a[212:215], a[116:119], a[24:27]
    ds_read_b128 a[76:79], v5 offset:576
    buffer_load_dwordx4 v[104:107], v244, s[44:47], s10 offen offset:2048
    v_and_b32 v199, 0xffff0000, v117
    v_mfma_f32_16x16x32_bf16 a[24:27], a[208:211], a[100:103], a[24:27]
    ds_read_b128 a[48:51], v6 offset:0
    s_waitcnt vmcnt(16)
    v_mfma_f32_16x16x32_bf16 v[40:43], a[220:223], a[88:91], v[40:43]
    ds_read_b128 a[64:67], v6 offset:32
    v_lshlrev_b32 v200, 16, v118
    v_mfma_f32_16x16x32_bf16 v[40:43], a[224:227], a[104:107], v[40:43]
    ds_read_b128 a[80:83], v6 offset:64
    buffer_load_dwordx4 a[160:163], v2, s[36:39], s55 offen offset:2048
    v_mfma_f32_16x16x32_bf16 v[40:43], a[228:231], a[120:123], v[40:43]
    ds_read_b128 a[52:55], v6 offset:512
    v_and_b32 v201, 0xffff0000, v118
    v_mfma_f32_16x16x32_bf16 v[60:63], a[228:231], a[124:127], v[60:63]
    ds_read_b128 a[68:71], v6 offset:544
    v_lshlrev_b32 v202, 16, v119
    v_and_b32 v203, 0xffff0000, v119
    v_mfma_f32_16x16x32_bf16 v[60:63], a[224:227], a[108:111], v[60:63]
    ds_read_b128 a[84:87], v6 offset:576
    buffer_load_dwordx4 a[164:167], v2, s[36:39], s55 offen offset:3072
    v_mfma_f32_16x16x32_bf16 v[60:63], a[220:223], a[92:95], v[60:63]
    s_add_u32 s55, s24, 69632
    v_add_f32 v124, v188, v196
    v_mfma_f32_16x16x32_bf16 a[8:11], a[220:223], a[96:99], a[8:11]
    v_add_f32 v125, v189, v197
    v_add_f32 v126, v190, v198
    v_mfma_f32_16x16x32_bf16 a[8:11], a[224:227], a[112:115], a[8:11]
    buffer_load_dwordx4 a[168:171], v2, s[36:39], s55 offen offset:0
    v_add_f32 v127, v191, v199
    v_mfma_f32_16x16x32_bf16 a[8:11], a[228:231], a[128:131], a[8:11]
    v_add_f32 v128, v192, v200
    v_add_f32 v129, v193, v201
    v_add_f32 v130, v194, v202
    v_mfma_f32_16x16x32_bf16 a[28:31], a[228:231], a[132:135], a[28:31]
    v_add_f32 v131, v195, v203
    v_cvt_pk_bf16_f32 v144, v124, v125
    v_mfma_f32_16x16x32_bf16 a[28:31], a[224:227], a[116:119], a[28:31]
    buffer_load_dwordx4 a[172:175], v2, s[36:39], s55 offen offset:1024
    v_cvt_pk_bf16_f32 v145, v126, v127
    v_mfma_f32_16x16x32_bf16 a[28:31], a[220:223], a[100:103], a[28:31]
    v_cvt_pk_bf16_f32 v146, v128, v129
    s_waitcnt vmcnt(17)
    v_mfma_f32_16x16x32_bf16 v[44:47], a[232:235], a[88:91], v[44:47]
    v_cvt_pk_bf16_f32 v147, v130, v131
    v_sub_f32 v124, v196, v188
    v_mfma_f32_16x16x32_bf16 v[44:47], a[236:239], a[104:107], v[44:47]
    ds_write_b128 v7, v[144:147] offset:20800
    v_sub_f32 v125, v197, v189
    v_sub_f32 v126, v198, v190
    v_mfma_f32_16x16x32_bf16 v[44:47], a[240:243], a[120:123], v[44:47]
    buffer_load_dwordx4 a[176:179], v2, s[36:39], s55 offen offset:2048
    v_sub_f32 v127, v199, v191
    v_mfma_f32_16x16x32_bf16 v[64:67], a[240:243], a[124:127], v[64:67]
    v_sub_f32 v128, v200, v192
    v_sub_f32 v129, v201, v193
    v_mfma_f32_16x16x32_bf16 v[64:67], a[236:239], a[108:111], v[64:67]
    v_sub_f32 v130, v202, v194
    v_sub_f32 v131, v203, v195
    v_mfma_f32_16x16x32_bf16 v[64:67], a[232:235], a[92:95], v[64:67]
    buffer_load_dwordx4 a[180:183], v2, s[36:39], s55 offen offset:3072
    s_add_u32 s55, s24, 73728
    v_mfma_f32_16x16x32_bf16 a[12:15], a[232:235], a[96:99], a[12:15]
    v_cvt_pk_bf16_f32 v148, v124, v125
    v_cvt_pk_bf16_f32 v149, v126, v127
    v_cvt_pk_bf16_f32 v150, v128, v129
    v_mfma_f32_16x16x32_bf16 a[12:15], a[236:239], a[112:115], a[12:15]
    v_cvt_pk_bf16_f32 v151, v130, v131
    v_lshlrev_b32 v132, 16, v108
    v_mfma_f32_16x16x32_bf16 a[12:15], a[240:243], a[128:131], a[12:15]
    ds_write_b128 v7, v[148:151] offset:24960
    buffer_load_dwordx4 a[184:187], v2, s[36:39], s55 offen offset:0
    v_mfma_f32_16x16x32_bf16 a[32:35], a[240:243], a[132:135], a[32:35]
    v_and_b32 v133, 0xffff0000, v108
    v_lshlrev_b32 v134, 16, v109
    v_mfma_f32_16x16x32_bf16 a[32:35], a[236:239], a[116:119], a[32:35]
    v_and_b32 v135, 0xffff0000, v109
    v_lshlrev_b32 v136, 16, v110
    v_mfma_f32_16x16x32_bf16 a[32:35], a[232:235], a[100:103], a[32:35]
    buffer_load_dwordx4 a[188:191], v2, s[36:39], s55 offen offset:1024
    v_and_b32 v137, 0xffff0000, v110
    s_waitcnt vmcnt(18)
    v_mfma_f32_16x16x32_bf16 v[48:51], a[244:247], a[88:91], v[48:51]
    v_lshlrev_b32 v138, 16, v111
    v_and_b32 v139, 0xffff0000, v111
    v_mfma_f32_16x16x32_bf16 v[48:51], a[248:251], a[104:107], v[48:51]
    v_sub_f32 v124, v196, v132
    v_sub_f32 v125, v197, v133
    v_mfma_f32_16x16x32_bf16 v[48:51], a[252:255], a[120:123], v[48:51]
    buffer_load_dwordx4 a[192:195], v2, s[36:39], s55 offen offset:2048
    v_sub_f32 v126, v198, v134
    v_mfma_f32_16x16x32_bf16 v[68:71], a[252:255], a[124:127], v[68:71]
    v_sub_f32 v127, v199, v135
    v_sub_f32 v128, v200, v136
    v_mfma_f32_16x16x32_bf16 v[68:71], a[248:251], a[108:111], v[68:71]
    v_sub_f32 v129, v201, v137
    v_sub_f32 v130, v202, v138
    v_sub_f32 v131, v203, v139
    v_mfma_f32_16x16x32_bf16 v[68:71], a[244:247], a[92:95], v[68:71]
    v_cvt_pk_bf16_f32 v140, v124, v125
    v_cvt_pk_bf16_f32 v141, v126, v127
    v_mfma_f32_16x16x32_bf16 a[16:19], a[244:247], a[96:99], a[16:19]
    buffer_load_dwordx4 a[196:199], v2, s[36:39], s55 offen offset:3072
    s_add_u32 s55, s24, 77824
    v_mfma_f32_16x16x32_bf16 a[16:19], a[248:251], a[112:115], a[16:19]
    v_cvt_pk_bf16_f32 v142, v128, v129
    v_cvt_pk_bf16_f32 v143, v130, v131
    v_mfma_f32_16x16x32_bf16 a[16:19], a[252:255], a[128:131], a[16:19]
    v_lshlrev_b32 v132, 16, v120
    v_and_b32 v133, 0xffff0000, v120
    v_mfma_f32_16x16x32_bf16 a[36:39], a[252:255], a[132:135], a[36:39]
    ds_write_b128 v7, v[140:143] offset:16640
    buffer_load_dwordx4 a[200:203], v2, s[36:39], s55 offen offset:0
    v_lshlrev_b32 v134, 16, v121
    v_mfma_f32_16x16x32_bf16 a[36:39], a[248:251], a[116:119], a[36:39]
    v_and_b32 v135, 0xffff0000, v121
    v_lshlrev_b32 v136, 16, v122
    v_mfma_f32_16x16x32_bf16 a[36:39], a[244:247], a[100:103], a[36:39]
    v_and_b32 v137, 0xffff0000, v122
    s_waitcnt vmcnt(18) lgkmcnt(3)
    v_mfma_f32_16x16x32_bf16 v[32:35], a[136:139], a[40:43], v[32:35]
    buffer_load_dwordx4 a[204:207], v2, s[36:39], s55 offen offset:1024
    v_lshlrev_b32 v138, 16, v123
    v_mfma_f32_16x16x32_bf16 v[32:35], a[140:143], a[56:59], v[32:35]
    v_and_b32 v139, 0xffff0000, v123
    v_sub_f32 v124, v188, v132
    v_mfma_f32_16x16x32_bf16 v[32:35], a[144:147], a[72:75], v[32:35]
    v_sub_f32 v125, v189, v133
    v_sub_f32 v126, v190, v134
    v_sub_f32 v127, v191, v135
    v_mfma_f32_16x16x32_bf16 v[52:55], a[144:147], a[76:79], v[52:55]
    buffer_load_dwordx4 a[208:211], v2, s[36:39], s55 offen offset:2048
    v_sub_f32 v128, v192, v136
    v_mfma_f32_16x16x32_bf16 v[52:55], a[140:143], a[60:63], v[52:55]
    v_sub_f32 v129, v193, v137
    v_sub_f32 v130, v194, v138
    v_mfma_f32_16x16x32_bf16 v[52:55], a[136:139], a[44:47], v[52:55]
    v_sub_f32 v131, v195, v139
    v_cvt_pk_bf16_f32 v152, v124, v125
    v_mfma_f32_16x16x32_bf16 a[0:3], a[136:139], a[48:51], a[0:3]
    buffer_load_dwordx4 a[212:215], v2, s[36:39], s55 offen offset:3072
    s_add_u32 s55, s24, 81920
    v_mfma_f32_16x16x32_bf16 a[0:3], a[140:143], a[64:67], a[0:3]
    v_cvt_pk_bf16_f32 v153, v126, v127
    v_cvt_pk_bf16_f32 v154, v128, v129
    v_cvt_pk_bf16_f32 v155, v130, v131
    v_mfma_f32_16x16x32_bf16 a[0:3], a[144:147], a[80:83], a[0:3]
    s_waitcnt vmcnt(14)
    v_lshlrev_b32 v188, 16, v96
    v_mfma_f32_16x16x32_bf16 a[20:23], a[144:147], a[84:87], a[20:23]
    ds_write_b128 v7, v[152:155] offset:29120
    buffer_load_dwordx4 v[112:115], v2, s[20:23], s11 offen offset:2048
    v_mfma_f32_16x16x32_bf16 a[20:23], a[140:143], a[68:71], a[20:23]
    v_and_b32 v189, 0xffff0000, v96
    v_lshlrev_b32 v190, 16, v97
    v_mfma_f32_16x16x32_bf16 a[20:23], a[136:139], a[52:55], a[20:23]
    v_and_b32 v191, 0xffff0000, v97
    v_lshlrev_b32 v192, 16, v98
    v_mfma_f32_16x16x32_bf16 v[36:39], a[148:151], a[40:43], v[36:39]
    v_and_b32 v193, 0xffff0000, v98
    v_lshlrev_b32 v194, 16, v99
    v_and_b32 v195, 0xffff0000, v99
    v_mfma_f32_16x16x32_bf16 v[36:39], a[152:155], a[56:59], v[36:39]
    s_waitcnt lgkmcnt(0)
    s_barrier
    v_mfma_f32_16x16x32_bf16 v[36:39], a[156:159], a[72:75], v[36:39]
    ds_read_b128 a[88:91], v5 offset:16640
    buffer_load_dwordx4 v[116:119], v244, s[20:23], s11 offen offset:0
    v_mfma_f32_16x16x32_bf16 v[56:59], a[156:159], a[76:79], v[56:59]
    ds_read_b128 a[104:107], v5 offset:16672
    v_lshlrev_b32 v196, 16, v100
    v_mfma_f32_16x16x32_bf16 v[56:59], a[152:155], a[60:63], v[56:59]
    ds_read_b128 a[120:123], v5 offset:16704
    v_and_b32 v197, 0xffff0000, v100
    v_mfma_f32_16x16x32_bf16 v[56:59], a[148:151], a[44:47], v[56:59]
    ds_read_b128 a[92:95], v5 offset:17152
    buffer_load_dwordx4 v[108:111], v2, s[40:43], s11 offen offset:0
    v_lshlrev_b32 v198, 16, v101
    v_mfma_f32_16x16x32_bf16 a[4:7], a[148:151], a[48:51], a[4:7]
    ds_read_b128 a[108:111], v5 offset:17184
    v_and_b32 v199, 0xffff0000, v101
    v_mfma_f32_16x16x32_bf16 a[4:7], a[152:155], a[64:67], a[4:7]
    ds_read_b128 a[124:127], v5 offset:17216
    v_lshlrev_b32 v200, 16, v102
    v_mfma_f32_16x16x32_bf16 a[4:7], a[156:159], a[80:83], a[4:7]
    ds_read_b128 a[96:99], v6 offset:16640
    buffer_load_dwordx4 v[120:123], v244, s[44:47], s11 offen offset:2048
    v_mfma_f32_16x16x32_bf16 a[24:27], a[156:159], a[84:87], a[24:27]
    ds_read_b128 a[112:115], v6 offset:16672
    v_and_b32 v201, 0xffff0000, v102
    v_mfma_f32_16x16x32_bf16 a[24:27], a[152:155], a[68:71], a[24:27]
    ds_read_b128 a[128:131], v6 offset:16704
    v_lshlrev_b32 v202, 16, v103
    v_and_b32 v203, 0xffff0000, v103
    v_mfma_f32_16x16x32_bf16 a[24:27], a[148:151], a[52:55], a[24:27]
    ds_read_b128 a[100:103], v6 offset:17152
    s_waitcnt vmcnt(15)
    v_mfma_f32_16x16x32_bf16 v[40:43], a[160:163], a[40:43], v[40:43]
    ds_read_b128 a[116:119], v6 offset:17184
    buffer_load_dwordx4 v28, s[36:39], s60 offen lds
    v_mfma_f32_16x16x32_bf16 v[40:43], a[164:167], a[56:59], v[40:43]
    ds_read_b128 a[132:135], v6 offset:17216
    v_add_f32 v124, v188, v196
    v_mfma_f32_16x16x32_bf16 v[40:43], a[168:171], a[72:75], v[40:43]
    v_add_f32 v125, v189, v197
    v_add_f32 v126, v190, v198
    v_mfma_f32_16x16x32_bf16 v[60:63], a[168:171], a[76:79], v[60:63]
    buffer_load_dwordx4 a[216:219], v2, s[36:39], s55 offen offset:0
    v_add_f32 v127, v191, v199
    v_add_f32 v128, v192, v200
    v_mfma_f32_16x16x32_bf16 v[60:63], a[164:167], a[60:63], v[60:63]
    v_add_f32 v129, v193, v201
    v_add_f32 v130, v194, v202
    v_mfma_f32_16x16x32_bf16 v[60:63], a[160:163], a[44:47], v[60:63]
    v_add_f32 v131, v195, v203
    v_cvt_pk_bf16_f32 v144, v124, v125
    v_mfma_f32_16x16x32_bf16 a[8:11], a[160:163], a[48:51], a[8:11]
    buffer_load_dwordx4 a[220:223], v2, s[36:39], s55 offen offset:1024
    v_cvt_pk_bf16_f32 v145, v126, v127
    v_mfma_f32_16x16x32_bf16 a[8:11], a[164:167], a[64:67], a[8:11]
    v_cvt_pk_bf16_f32 v146, v128, v129
    v_cvt_pk_bf16_f32 v147, v130, v131
    v_mfma_f32_16x16x32_bf16 a[8:11], a[168:171], a[80:83], a[8:11]
    v_sub_f32 v124, v196, v188
    v_sub_f32 v125, v197, v189
    v_sub_f32 v126, v198, v190
    v_mfma_f32_16x16x32_bf16 a[28:31], a[168:171], a[84:87], a[28:31]
    ds_write_b128 v7, v[144:147] offset:4160
    buffer_load_dwordx4 a[224:227], v2, s[36:39], s55 offen offset:2048
    v_mfma_f32_16x16x32_bf16 a[28:31], a[164:167], a[68:71], a[28:31]
    v_sub_f32 v127, v199, v191
    v_sub_f32 v128, v200, v192
    v_mfma_f32_16x16x32_bf16 a[28:31], a[160:163], a[52:55], a[28:31]
    v_sub_f32 v129, v201, v193
    s_waitcnt vmcnt(16)
    v_mfma_f32_16x16x32_bf16 v[44:47], a[172:175], a[40:43], v[44:47]
    buffer_load_dwordx4 a[228:231], v2, s[36:39], s55 offen offset:3072
    s_add_u32 s55, s24, 86016
    v_mfma_f32_16x16x32_bf16 v[44:47], a[176:179], a[56:59], v[44:47]
    v_sub_f32 v130, v202, v194
    v_sub_f32 v131, v203, v195
    v_cvt_pk_bf16_f32 v148, v124, v125
    v_mfma_f32_16x16x32_bf16 v[44:47], a[180:183], a[72:75], v[44:47]
    v_cvt_pk_bf16_f32 v149, v126, v127
    v_cvt_pk_bf16_f32 v150, v128, v129
    v_mfma_f32_16x16x32_bf16 v[64:67], a[180:183], a[76:79], v[64:67]
    buffer_load_dwordx4 a[232:235], v2, s[36:39], s55 offen offset:0
    v_cvt_pk_bf16_f32 v151, v130, v131
    v_mfma_f32_16x16x32_bf16 v[64:67], a[176:179], a[60:63], v[64:67]
    v_lshlrev_b32 v132, 16, v92
    v_and_b32 v133, 0xffff0000, v92
    v_mfma_f32_16x16x32_bf16 v[64:67], a[172:175], a[44:47], v[64:67]
    ds_write_b128 v7, v[148:151] offset:8320
    v_lshlrev_b32 v134, 16, v93
    v_mfma_f32_16x16x32_bf16 a[12:15], a[172:175], a[48:51], a[12:15]
    v_and_b32 v135, 0xffff0000, v93
    v_lshlrev_b32 v136, 16, v94
    v_and_b32 v137, 0xffff0000, v94
    v_mfma_f32_16x16x32_bf16 a[12:15], a[176:179], a[64:67], a[12:15]
    buffer_load_dwordx4 a[236:239], v2, s[36:39], s55 offen offset:1024
    v_lshlrev_b32 v138, 16, v95
    v_mfma_f32_16x16x32_bf16 a[12:15], a[180:183], a[80:83], a[12:15]
    v_and_b32 v139, 0xffff0000, v95
    v_sub_f32 v124, v196, v132
    v_mfma_f32_16x16x32_bf16 a[32:35], a[180:183], a[84:87], a[32:35]
    v_sub_f32 v125, v197, v133
    v_sub_f32 v126, v198, v134
    v_mfma_f32_16x16x32_bf16 a[32:35], a[176:179], a[68:71], a[32:35]
    buffer_load_dwordx4 a[240:243], v2, s[36:39], s55 offen offset:2048
    v_sub_f32 v127, v199, v135
    v_mfma_f32_16x16x32_bf16 a[32:35], a[172:175], a[52:55], a[32:35]
    v_sub_f32 v128, v200, v136
    v_sub_f32 v129, v201, v137
    s_waitcnt vmcnt(17)
    v_mfma_f32_16x16x32_bf16 v[48:51], a[184:187], a[40:43], v[48:51]
    v_sub_f32 v130, v202, v138
    v_sub_f32 v131, v203, v139
    v_mfma_f32_16x16x32_bf16 v[48:51], a[188:191], a[56:59], v[48:51]
    buffer_load_dwordx4 a[244:247], v2, s[36:39], s55 offen offset:3072
    s_add_u32 s55, s24, 90112
    v_mfma_f32_16x16x32_bf16 v[48:51], a[192:195], a[72:75], v[48:51]
    v_cvt_pk_bf16_f32 v140, v124, v125
    v_cvt_pk_bf16_f32 v141, v126, v127
    v_mfma_f32_16x16x32_bf16 v[68:71], a[192:195], a[76:79], v[68:71]
    v_cvt_pk_bf16_f32 v142, v128, v129
    v_cvt_pk_bf16_f32 v143, v130, v131
    v_mfma_f32_16x16x32_bf16 v[68:71], a[188:191], a[60:63], v[68:71]
    buffer_load_dwordx4 a[248:251], v2, s[36:39], s55 offen offset:0
    v_lshlrev_b32 v132, 16, v104
    v_and_b32 v133, 0xffff0000, v104
    v_mfma_f32_16x16x32_bf16 v[68:71], a[184:187], a[44:47], v[68:71]
    ds_write_b128 v7, v[140:143] offset:0
    v_lshlrev_b32 v134, 16, v105
    v_mfma_f32_16x16x32_bf16 a[16:19], a[184:187], a[48:51], a[16:19]
    v_and_b32 v135, 0xffff0000, v105
    v_lshlrev_b32 v136, 16, v106
    v_mfma_f32_16x16x32_bf16 a[16:19], a[188:191], a[64:67], a[16:19]
    buffer_load_dwordx4 a[252:255], v2, s[36:39], s55 offen offset:1024
    v_and_b32 v137, 0xffff0000, v106
    v_mfma_f32_16x16x32_bf16 a[16:19], a[192:195], a[80:83], a[16:19]
    v_lshlrev_b32 v138, 16, v107
    v_and_b32 v139, 0xffff0000, v107
    v_mfma_f32_16x16x32_bf16 a[36:39], a[192:195], a[84:87], a[36:39]
    v_sub_f32 v124, v188, v132
    v_sub_f32 v125, v189, v133
    v_sub_f32 v126, v190, v134
    v_mfma_f32_16x16x32_bf16 a[36:39], a[188:191], a[68:71], a[36:39]
    buffer_load_dwordx4 a[136:139], v2, s[36:39], s55 offen offset:2048
    v_sub_f32 v127, v191, v135
    v_mfma_f32_16x16x32_bf16 a[36:39], a[184:187], a[52:55], a[36:39]
    v_sub_f32 v128, v192, v136
    s_waitcnt vmcnt(18) lgkmcnt(3)
    v_mfma_f32_16x16x32_bf16 v[32:35], a[196:199], a[88:91], v[32:35]
    v_sub_f32 v129, v193, v137
    v_sub_f32 v130, v194, v138
    v_mfma_f32_16x16x32_bf16 v[32:35], a[200:203], a[104:107], v[32:35]
    v_sub_f32 v131, v195, v139
    v_cvt_pk_bf16_f32 v152, v124, v125
    v_mfma_f32_16x16x32_bf16 v[32:35], a[204:207], a[120:123], v[32:35]
    buffer_load_dwordx4 a[140:143], v2, s[36:39], s55 offen offset:3072
    s_add_u32 s55, s24, 94208
    v_cvt_pk_bf16_f32 v153, v126, v127
    v_mfma_f32_16x16x32_bf16 v[52:55], a[204:207], a[124:127], v[52:55]
    v_cvt_pk_bf16_f32 v154, v128, v129
    v_cvt_pk_bf16_f32 v155, v130, v131
    v_mfma_f32_16x16x32_bf16 v[52:55], a[200:203], a[108:111], v[52:55]
    s_waitcnt vmcnt(13)
    v_lshlrev_b32 v188, 16, v112
    v_mfma_f32_16x16x32_bf16 v[52:55], a[196:199], a[92:95], v[52:55]
    ds_write_b128 v7, v[152:155] offset:12480
    buffer_load_dwordx4 v[96:99], v2, s[20:23], s12 offen offset:2048
    v_mfma_f32_16x16x32_bf16 a[0:3], a[196:199], a[96:99], a[0:3]
    v_and_b32 v189, 0xffff0000, v112
    v_lshlrev_b32 v190, 16, v113
    v_mfma_f32_16x16x32_bf16 a[0:3], a[200:203], a[112:115], a[0:3]
    v_and_b32 v191, 0xffff0000, v113
    v_lshlrev_b32 v192, 16, v114
    v_and_b32 v193, 0xffff0000, v114
    v_mfma_f32_16x16x32_bf16 a[0:3], a[204:207], a[128:131], a[0:3]
    buffer_load_dwordx4 v[100:103], v244, s[20:23], s12 offen offset:0
    v_lshlrev_b32 v194, 16, v115
    v_mfma_f32_16x16x32_bf16 a[20:23], a[204:207], a[132:135], a[20:23]
    s_waitcnt vmcnt(14)
    s_waitcnt lgkmcnt(0)
    v_mfma_f32_16x16x32_bf16 a[20:23], a[200:203], a[116:119], a[20:23]
    s_barrier
    ds_read_b128 a[40:43], v5 offset:0
    v_mfma_f32_16x16x32_bf16 a[20:23], a[196:199], a[100:103], a[20:23]
    ds_read_b128 a[56:59], v5 offset:32
    s_waitcnt vmcnt(13)
    v_mfma_f32_16x16x32_bf16 v[36:39], a[208:211], a[88:91], v[36:39]
    ds_read_b128 a[72:75], v5 offset:64
    buffer_load_dwordx4 v[92:95], v2, s[40:43], s12 offen offset:0
    v_and_b32 v195, 0xffff0000, v115
    v_mfma_f32_16x16x32_bf16 v[36:39], a[212:215], a[104:107], v[36:39]
    ds_read_b128 a[44:47], v5 offset:512
    v_lshlrev_b32 v196, 16, v116
    v_mfma_f32_16x16x32_bf16 v[36:39], a[216:219], a[120:123], v[36:39]
    ds_read_b128 a[60:63], v5 offset:544
    v_and_b32 v197, 0xffff0000, v116
    v_mfma_f32_16x16x32_bf16 v[56:59], a[216:219], a[124:127], v[56:59]
    ds_read_b128 a[76:79], v5 offset:576
    buffer_load_dwordx4 v[104:107], v244, s[44:47], s12 offen offset:2048
    v_mfma_f32_16x16x32_bf16 v[56:59], a[212:215], a[108:111], v[56:59]
    ds_read_b128 a[48:51], v6 offset:0
    v_lshlrev_b32 v198, 16, v117
    v_mfma_f32_16x16x32_bf16 v[56:59], a[208:211], a[92:95], v[56:59]
    ds_read_b128 a[64:67], v6 offset:32
    v_and_b32 v199, 0xffff0000, v117
    v_lshlrev_b32 v200, 16, v118
    v_mfma_f32_16x16x32_bf16 a[4:7], a[208:211], a[96:99], a[4:7]
    ds_read_b128 a[80:83], v6 offset:64
    buffer_load_dwordx4 a[144:147], v2, s[36:39], s55 offen offset:0
    v_mfma_f32_16x16x32_bf16 a[4:7], a[212:215], a[112:115], a[4:7]
    ds_read_b128 a[52:55], v6 offset:512
    v_and_b32 v201, 0xffff0000, v118
    v_mfma_f32_16x16x32_bf16 a[4:7], a[216:219], a[128:131], a[4:7]
    ds_read_b128 a[68:71], v6 offset:544
    v_lshlrev_b32 v202, 16, v119
    v_mfma_f32_16x16x32_bf16 a[24:27], a[216:219], a[132:135], a[24:27]
    ds_read_b128 a[84:87], v6 offset:576
    buffer_load_dwordx4 a[148:151], v2, s[36:39], s55 offen offset:1024
    v_mfma_f32_16x16x32_bf16 a[24:27], a[212:215], a[116:119], a[24:27]
    ds_read_b128 v[172:175], v30 offset:0
    v_and_b32 v203, 0xffff0000, v119
    v_add_f32 v124, v188, v196
    v_mfma_f32_16x16x32_bf16 a[24:27], a[208:211], a[100:103], a[24:27]
    ds_read_b32 v184, v29 offset:256
    s_waitcnt vmcnt(14)
    v_mfma_f32_16x16x32_bf16 v[40:43], a[220:223], a[88:91], v[40:43]
    ds_read_b128 v[176:179], v30 offset:1280
    buffer_load_dwordx4 a[152:155], v2, s[36:39], s55 offen offset:2048
    v_mfma_f32_16x16x32_bf16 v[40:43], a[224:227], a[104:107], v[40:43]
    ds_read_b32 v185, v29 offset:1536
    v_add_f32 v125, v189, v197
    v_mfma_f32_16x16x32_bf16 v[40:43], a[228:231], a[120:123], v[40:43]
    ds_read_b128 v[180:183], v30 offset:2560
    v_add_f32 v126, v190, v198
    v_mfma_f32_16x16x32_bf16 v[60:63], a[228:231], a[124:127], v[60:63]
    ds_read_b32 v186, v29 offset:2816
    buffer_load_dwordx4 a[156:159], v2, s[36:39], s55 offen offset:3072
    s_add_u32 s55, s24, 98304
    v_mfma_f32_16x16x32_bf16 v[60:63], a[224:227], a[108:111], v[60:63]
    v_add_f32 v127, v191, v199
    v_add_f32 v128, v192, v200
    v_mfma_f32_16x16x32_bf16 v[60:63], a[220:223], a[92:95], v[60:63]
    v_add_f32 v129, v193, v201
    v_add_f32 v130, v194, v202
    v_mfma_f32_16x16x32_bf16 a[8:11], a[220:223], a[96:99], a[8:11]
    v_add_f32 v131, v195, v203
    v_cvt_pk_bf16_f32 v144, v124, v125
    v_mfma_f32_16x16x32_bf16 a[8:11], a[224:227], a[112:115], a[8:11]
    buffer_load_dwordx4 a[160:163], v2, s[36:39], s55 offen offset:0
    v_cvt_pk_bf16_f32 v145, v126, v127
    v_mfma_f32_16x16x32_bf16 a[8:11], a[228:231], a[128:131], a[8:11]
    v_cvt_pk_bf16_f32 v146, v128, v129
    v_cvt_pk_bf16_f32 v147, v130, v131
    v_sub_f32 v124, v196, v188
    v_mfma_f32_16x16x32_bf16 a[28:31], a[228:231], a[132:135], a[28:31]
    ds_write_b128 v7, v[144:147] offset:20800
    v_sub_f32 v125, v197, v189
    v_mfma_f32_16x16x32_bf16 a[28:31], a[224:227], a[116:119], a[28:31]
    buffer_load_dwordx4 a[164:167], v2, s[36:39], s55 offen offset:1024
    v_sub_f32 v126, v198, v190
    v_mfma_f32_16x16x32_bf16 a[28:31], a[220:223], a[100:103], a[28:31]
    v_sub_f32 v127, v199, v191
    s_waitcnt vmcnt(15)
    v_mfma_f32_16x16x32_bf16 v[44:47], a[232:235], a[88:91], v[44:47]
    v_sub_f32 v128, v200, v192
    v_sub_f32 v129, v201, v193
    v_mfma_f32_16x16x32_bf16 v[44:47], a[236:239], a[104:107], v[44:47]
    buffer_load_dwordx4 a[168:171], v2, s[36:39], s55 offen offset:2048
    v_sub_f32 v130, v202, v194
    v_sub_f32 v131, v203, v195
    v_mfma_f32_16x16x32_bf16 v[44:47], a[240:243], a[120:123], v[44:47]
    v_cvt_pk_bf16_f32 v148, v124, v125
    v_cvt_pk_bf16_f32 v149, v126, v127
    v_mfma_f32_16x16x32_bf16 v[64:67], a[240:243], a[124:127], v[64:67]
    v_cvt_pk_bf16_f32 v150, v128, v129
    v_cvt_pk_bf16_f32 v151, v130, v131
    v_mfma_f32_16x16x32_bf16 v[64:67], a[236:239], a[108:111], v[64:67]
    buffer_load_dwordx4 a[172:175], v2, s[36:39], s55 offen offset:3072
    s_add_u32 s55, s24, 102400
    v_mfma_f32_16x16x32_bf16 v[64:67], a[232:235], a[92:95], v[64:67]
    v_lshlrev_b32 v132, 16, v108
    v_and_b32 v133, 0xffff0000, v108
    v_mfma_f32_16x16x32_bf16 a[12:15], a[232:235], a[96:99], a[12:15]
    ds_write_b128 v7, v[148:151] offset:24960
    v_lshlrev_b32 v134, 16, v109
    v_and_b32 v135, 0xffff0000, v109
    v_mfma_f32_16x16x32_bf16 a[12:15], a[236:239], a[112:115], a[12:15]
    buffer_load_dwordx4 a[176:179], v2, s[36:39], s55 offen offset:0
    v_lshlrev_b32 v136, 16, v110
    v_mfma_f32_16x16x32_bf16 a[12:15], a[240:243], a[128:131], a[12:15]
    v_and_b32 v137, 0xffff0000, v110
    v_lshlrev_b32 v138, 16, v111
    v_mfma_f32_16x16x32_bf16 a[32:35], a[240:243], a[132:135], a[32:35]
    v_and_b32 v139, 0xffff0000, v111
    v_sub_f32 v124, v196, v132
    v_mfma_f32_16x16x32_bf16 a[32:35], a[236:239], a[116:119], a[32:35]
    buffer_load_dwordx4 a[180:183], v2, s[36:39], s55 offen offset:1024
    v_sub_f32 v125, v197, v133
    v_mfma_f32_16x16x32_bf16 a[32:35], a[232:235], a[100:103], a[32:35]
    v_sub_f32 v126, v198, v134
    v_sub_f32 v127, v199, v135
    s_waitcnt vmcnt(16)
    v_mfma_f32_16x16x32_bf16 v[48:51], a[244:247], a[88:91], v[48:51]
    v_sub_f32 v128, v200, v136
    v_sub_f32 v129, v201, v137
    v_mfma_f32_16x16x32_bf16 v[48:51], a[248:251], a[104:107], v[48:51]
    v_sub_f32 v130, v202, v138
    v_sub_f32 v131, v203, v139
    v_mfma_f32_16x16x32_bf16 v[48:51], a[252:255], a[120:123], v[48:51]
    buffer_load_dwordx4 a[184:187], v2, s[36:39], s55 offen offset:2048
    v_cvt_pk_bf16_f32 v140, v124, v125
    v_mfma_f32_16x16x32_bf16 v[68:71], a[252:255], a[124:127], v[68:71]
    v_cvt_pk_bf16_f32 v141, v126, v127
    v_cvt_pk_bf16_f32 v142, v128, v129
    v_mfma_f32_16x16x32_bf16 v[68:71], a[248:251], a[108:111], v[68:71]
    v_cvt_pk_bf16_f32 v143, v130, v131
    v_lshlrev_b32 v132, 16, v120
    v_and_b32 v133, 0xffff0000, v120
    v_mfma_f32_16x16x32_bf16 v[68:71], a[244:247], a[92:95], v[68:71]
    ds_write_b128 v7, v[140:143] offset:16640
    buffer_load_dwordx4 a[188:191], v2, s[36:39], s55 offen offset:3072
    v_mfma_f32_16x16x32_bf16 a[16:19], a[244:247], a[96:99], a[16:19]
    s_add_u32 s55, s24, 106496
    v_lshlrev_b32 v134, 16, v121
    v_mfma_f32_16x16x32_bf16 a[16:19], a[248:251], a[112:115], a[16:19]
    v_and_b32 v135, 0xffff0000, v121
    v_lshlrev_b32 v136, 16, v122
    v_mfma_f32_16x16x32_bf16 a[16:19], a[252:255], a[128:131], a[16:19]
    buffer_load_dwordx4 a[192:195], v2, s[36:39], s55 offen offset:0
    v_and_b32 v137, 0xffff0000, v122
    v_mfma_f32_16x16x32_bf16 a[36:39], a[252:255], a[132:135], a[36:39]
    v_lshlrev_b32 v138, 16, v123
    v_and_b32 v139, 0xffff0000, v123
    v_sub_f32 v124, v188, v132
    v_mfma_f32_16x16x32_bf16 a[36:39], a[248:251], a[116:119], a[36:39]
    v_sub_f32 v125, v189, v133
    v_sub_f32 v126, v190, v134
    v_mfma_f32_16x16x32_bf16 a[36:39], a[244:247], a[100:103], a[36:39]
    buffer_load_dwordx4 a[196:199], v2, s[36:39], s55 offen offset:1024
    s_waitcnt vmcnt(13) lgkmcnt(9)
    v_mfma_f32_16x16x32_bf16 v[32:35], a[136:139], a[40:43], v[32:35]
    v_sub_f32 v127, v191, v135
    v_sub_f32 v128, v192, v136
    v_mfma_f32_16x16x32_bf16 v[32:35], a[140:143], a[56:59], v[32:35]
    v_sub_f32 v129, v193, v137
    v_sub_f32 v130, v194, v138
    v_mfma_f32_16x16x32_bf16 v[32:35], a[144:147], a[72:75], v[32:35]
    buffer_load_dwordx4 a[200:203], v2, s[36:39], s55 offen offset:2048
    v_sub_f32 v131, v195, v139
    v_cvt_pk_bf16_f32 v152, v124, v125
    v_mfma_f32_16x16x32_bf16 v[52:55], a[144:147], a[76:79], v[52:55]
    v_cvt_pk_bf16_f32 v153, v126, v127
    v_cvt_pk_bf16_f32 v154, v128, v129
    v_mfma_f32_16x16x32_bf16 v[52:55], a[140:143], a[60:63], v[52:55]
    v_cvt_pk_bf16_f32 v155, v130, v131
    v_lshlrev_b32 v188, 16, v96
    v_mfma_f32_16x16x32_bf16 v[52:55], a[136:139], a[44:47], v[52:55]
    ds_write_b128 v7, v[152:155] offset:29120
    buffer_load_dwordx4 v[112:115], v2, s[20:23], s13 offen offset:2048
    v_mfma_f32_16x16x32_bf16 a[0:3], a[136:139], a[48:51], a[0:3]
    v_and_b32 v189, 0xffff0000, v96
    v_lshlrev_b32 v190, 16, v97
    v_mfma_f32_16x16x32_bf16 a[0:3], a[140:143], a[64:67], a[0:3]
    v_and_b32 v191, 0xffff0000, v97
    v_lshlrev_b32 v192, 16, v98
    v_and_b32 v193, 0xffff0000, v98
    v_mfma_f32_16x16x32_bf16 a[0:3], a[144:147], a[80:83], a[0:3]
    v_lshlrev_b32 v194, 16, v99
    v_and_b32 v195, 0xffff0000, v99
    v_mfma_f32_16x16x32_bf16 a[20:23], a[144:147], a[84:87], a[20:23]
    s_waitcnt lgkmcnt(0)
    s_barrier
    v_mfma_f32_16x16x32_bf16 a[20:23], a[140:143], a[68:71], a[20:23]
    ds_read_b128 a[88:91], v5 offset:16640
    buffer_load_dwordx4 v[116:119], v244, s[20:23], s13 offen offset:0
    v_mfma_f32_16x16x32_bf16 a[20:23], a[136:139], a[52:55], a[20:23]
    ds_read_b128 a[104:107], v5 offset:16672
    s_waitcnt vmcnt(13)
    v_mfma_f32_16x16x32_bf16 v[36:39], a[148:151], a[40:43], v[36:39]
    ds_read_b128 a[120:123], v5 offset:16704
    v_lshlrev_b32 v196, 16, v100
    v_and_b32 v197, 0xffff0000, v100
    v_mfma_f32_16x16x32_bf16 v[36:39], a[152:155], a[56:59], v[36:39]
    ds_read_b128 a[92:95], v5 offset:17152
    buffer_load_dwordx4 v[108:111], v2, s[40:43], s13 offen offset:0
    v_mfma_f32_16x16x32_bf16 v[36:39], a[156:159], a[72:75], v[36:39]
    ds_read_b128 a[108:111], v5 offset:17184
L_page4:
    s_cbranch_execz L_page5
    v_lshlrev_b32 v198, 16, v101
    v_mfma_f32_16x16x32_bf16 v[56:59], a[156:159], a[76:79], v[56:59]
    ds_read_b128 a[124:127], v5 offset:17216
    v_and_b32 v199, 0xffff0000, v101
    v_mfma_f32_16x16x32_bf16 v[56:59], a[152:155], a[60:63], v[56:59]
    ds_read_b128 a[96:99], v6 offset:16640
    buffer_load_dwordx4 v[120:123], v244, s[44:47], s13 offen offset:2048
    v_mfma_f32_16x16x32_bf16 v[56:59], a[148:151], a[44:47], v[56:59]
    ds_read_b128 a[112:115], v6 offset:16672
    v_lshlrev_b32 v200, 16, v102
    v_and_b32 v201, 0xffff0000, v102
    v_mfma_f32_16x16x32_bf16 a[4:7], a[148:151], a[48:51], a[4:7]
    ds_read_b128 a[128:131], v6 offset:16704
    v_lshlrev_b32 v202, 16, v103
    v_mfma_f32_16x16x32_bf16 a[4:7], a[152:155], a[64:67], a[4:7]
    ds_read_b128 a[100:103], v6 offset:17152
    buffer_load_dwordx4 a[204:207], v2, s[36:39], s55 offen offset:3072
    v_mfma_f32_16x16x32_bf16 a[4:7], a[156:159], a[80:83], a[4:7]
    ds_read_b128 a[116:119], v6 offset:17184
    s_add_u32 s55, s24, 110592
    v_mfma_f32_16x16x32_bf16 a[24:27], a[156:159], a[84:87], a[24:27]
    ds_read_b128 a[132:135], v6 offset:17216
    v_and_b32 v203, 0xffff0000, v103
    v_mfma_f32_16x16x32_bf16 a[24:27], a[152:155], a[68:71], a[24:27]
    buffer_load_dwordx4 a[208:211], v2, s[36:39], s55 offen offset:0
    v_add_f32 v124, v188, v196
    v_add_f32 v125, v189, v197
    v_mfma_f32_16x16x32_bf16 a[24:27], a[148:151], a[52:55], a[24:27]
    v_add_f32 v126, v190, v198
    s_waitcnt vmcnt(14)
    v_mfma_f32_16x16x32_bf16 v[40:43], a[160:163], a[40:43], v[40:43]
    v_add_f32 v127, v191, v199
    v_add_f32 v128, v192, v200
    v_mfma_f32_16x16x32_bf16 v[40:43], a[164:167], a[56:59], v[40:43]
    buffer_load_dwordx4 a[212:215], v2, s[36:39], s55 offen offset:1024
    v_add_f32 v129, v193, v201
    v_mfma_f32_16x16x32_bf16 v[40:43], a[168:171], a[72:75], v[40:43]
    v_add_f32 v130, v194, v202
    v_add_f32 v131, v195, v203
    v_mfma_f32_16x16x32_bf16 v[60:63], a[168:171], a[76:79], v[60:63]
    v_cvt_pk_bf16_f32 v144, v124, v125
    v_cvt_pk_bf16_f32 v145, v126, v127
    v_cvt_pk_bf16_f32 v146, v128, v129
    v_mfma_f32_16x16x32_bf16 v[60:63], a[164:167], a[60:63], v[60:63]
    v_cvt_pk_bf16_f32 v147, v130, v131
    v_sub_f32 v124, v196, v188
    v_mfma_f32_16x16x32_bf16 v[60:63], a[160:163], a[44:47], v[60:63]
    ds_write_b128 v7, v[144:147] offset:4160
    buffer_load_dwordx4 a[216:219], v2, s[36:39], s55 offen offset:2048
    v_mfma_f32_16x16x32_bf16 a[8:11], a[160:163], a[48:51], a[8:11]
    v_sub_f32 v125, v197, v189
    v_sub_f32 v126, v198, v190
    v_mfma_f32_16x16x32_bf16 a[8:11], a[164:167], a[64:67], a[8:11]
    v_sub_f32 v127, v199, v191
    v_sub_f32 v128, v200, v192
    v_mfma_f32_16x16x32_bf16 a[8:11], a[168:171], a[80:83], a[8:11]
    buffer_load_dwordx4 a[220:223], v2, s[36:39], s55 offen offset:3072
    s_add_u32 s55, s24, 114688
    v_sub_f32 v129, v201, v193
    v_mfma_f32_16x16x32_bf16 a[28:31], a[168:171], a[84:87], a[28:31]
    v_sub_f32 v130, v202, v194
    v_sub_f32 v131, v203, v195
    v_mfma_f32_16x16x32_bf16 a[28:31], a[164:167], a[68:71], a[28:31]
    v_cvt_pk_bf16_f32 v148, v124, v125
    v_cvt_pk_bf16_f32 v149, v126, v127
    v_mfma_f32_16x16x32_bf16 a[28:31], a[160:163], a[52:55], a[28:31]
    buffer_load_dwordx4 a[224:227], v2, s[36:39], s55 offen offset:0
    s_waitcnt vmcnt(15)
    v_mfma_f32_16x16x32_bf16 v[44:47], a[172:175], a[40:43], v[44:47]
    v_cvt_pk_bf16_f32 v150, v128, v129
    v_cvt_pk_bf16_f32 v151, v130, v131
    v_mfma_f32_16x16x32_bf16 v[44:47], a[176:179], a[56:59], v[44:47]
    v_lshlrev_b32 v132, 16, v92
    v_and_b32 v133, 0xffff0000, v92
    v_lshlrev_b32 v134, 16, v93
    v_mfma_f32_16x16x32_bf16 v[44:47], a[180:183], a[72:75], v[44:47]
    ds_write_b128 v7, v[148:151] offset:8320
    buffer_load_dwordx4 a[228:231], v2, s[36:39], s55 offen offset:1024
    v_mfma_f32_16x16x32_bf16 v[64:67], a[180:183], a[76:79], v[64:67]
    v_and_b32 v135, 0xffff0000, v93
    v_lshlrev_b32 v136, 16, v94
    v_mfma_f32_16x16x32_bf16 v[64:67], a[176:179], a[60:63], v[64:67]
    v_and_b32 v137, 0xffff0000, v94
    v_lshlrev_b32 v138, 16, v95
    v_mfma_f32_16x16x32_bf16 v[64:67], a[172:175], a[44:47], v[64:67]
    v_and_b32 v139, 0xffff0000, v95
    v_sub_f32 v124, v196, v132
    v_mfma_f32_16x16x32_bf16 a[12:15], a[172:175], a[48:51], a[12:15]
    buffer_load_dwordx4 a[232:235], v2, s[36:39], s55 offen offset:2048
    v_sub_f32 v125, v197, v133
    v_sub_f32 v126, v198, v134
    v_mfma_f32_16x16x32_bf16 a[12:15], a[176:179], a[64:67], a[12:15]
    v_sub_f32 v127, v199, v135
    v_sub_f32 v128, v200, v136
    v_mfma_f32_16x16x32_bf16 a[12:15], a[180:183], a[80:83], a[12:15]
    v_sub_f32 v129, v201, v137
    v_sub_f32 v130, v202, v138
    v_mfma_f32_16x16x32_bf16 a[32:35], a[180:183], a[84:87], a[32:35]
    buffer_load_dwordx4 a[236:239], v2, s[36:39], s55 offen offset:3072
    s_add_u32 s55, s24, 118784
    v_mfma_f32_16x16x32_bf16 a[32:35], a[176:179], a[68:71], a[32:35]
    v_sub_f32 v131, v203, v139
    v_cvt_pk_bf16_f32 v140, v124, v125
    v_mfma_f32_16x16x32_bf16 a[32:35], a[172:175], a[52:55], a[32:35]
    v_cvt_pk_bf16_f32 v141, v126, v127
    v_cvt_pk_bf16_f32 v142, v128, v129
    s_waitcnt vmcnt(15)
    v_mfma_f32_16x16x32_bf16 v[48:51], a[184:187], a[40:43], v[48:51]
    v_cvt_pk_bf16_f32 v143, v130, v131
    v_lshlrev_b32 v132, 16, v104
    v_mfma_f32_16x16x32_bf16 v[48:51], a[188:191], a[56:59], v[48:51]
    ds_write_b128 v7, v[140:143] offset:0
    buffer_load_dwordx4 a[240:243], v2, s[36:39], s55 offen offset:0
    v_mfma_f32_16x16x32_bf16 v[48:51], a[192:195], a[72:75], v[48:51]
    v_and_b32 v133, 0xffff0000, v104
    v_lshlrev_b32 v134, 16, v105
    v_mfma_f32_16x16x32_bf16 v[68:71], a[192:195], a[76:79], v[68:71]
    v_and_b32 v135, 0xffff0000, v105
    v_lshlrev_b32 v136, 16, v106
    v_mfma_f32_16x16x32_bf16 v[68:71], a[188:191], a[60:63], v[68:71]
    buffer_load_dwordx4 a[244:247], v2, s[36:39], s55 offen offset:1024
    v_and_b32 v137, 0xffff0000, v106
    v_lshlrev_b32 v138, 16, v107
    v_mfma_f32_16x16x32_bf16 v[68:71], a[184:187], a[44:47], v[68:71]
    v_and_b32 v139, 0xffff0000, v107
    v_sub_f32 v124, v188, v132
    v_mfma_f32_16x16x32_bf16 a[16:19], a[184:187], a[48:51], a[16:19]
    v_sub_f32 v125, v189, v133
    v_sub_f32 v126, v190, v134
    v_mfma_f32_16x16x32_bf16 a[16:19], a[188:191], a[64:67], a[16:19]
    v_sub_f32 v127, v191, v135
    v_sub_f32 v128, v192, v136
    v_mfma_f32_16x16x32_bf16 a[16:19], a[192:195], a[80:83], a[16:19]
    buffer_load_dwordx4 a[248:251], v2, s[36:39], s55 offen offset:2048
    v_sub_f32 v129, v193, v137
    v_mfma_f32_16x16x32_bf16 a[36:39], a[192:195], a[84:87], a[36:39]
    v_sub_f32 v130, v194, v138
    v_sub_f32 v131, v195, v139
    v_cvt_pk_bf16_f32 v152, v124, v125
    v_mfma_f32_16x16x32_bf16 a[36:39], a[188:191], a[68:71], a[36:39]
    v_cvt_pk_bf16_f32 v153, v126, v127
    v_cvt_pk_bf16_f32 v154, v128, v129
    v_mfma_f32_16x16x32_bf16 a[36:39], a[184:187], a[52:55], a[36:39]
    v_cvt_pk_bf16_f32 v155, v130, v131
    s_waitcnt vmcnt(11) lgkmcnt(3)
    v_mfma_f32_16x16x32_bf16 v[32:35], a[196:199], a[88:91], v[32:35]
    buffer_load_dwordx4 a[252:255], v2, s[36:39], s55 offen offset:3072
    s_add_u32 s55, s24, 122880
    v_mfma_f32_16x16x32_bf16 v[32:35], a[200:203], a[104:107], v[32:35]
    v_lshlrev_b32 v188, 16, v112
    v_and_b32 v189, 0xffff0000, v112
    v_mfma_f32_16x16x32_bf16 v[32:35], a[204:207], a[120:123], v[32:35]
    ds_write_b128 v7, v[152:155] offset:12480
    v_lshlrev_b32 v190, 16, v113
    v_and_b32 v191, 0xffff0000, v113
    v_mfma_f32_16x16x32_bf16 v[52:55], a[204:207], a[124:127], v[52:55]
    buffer_load_dwordx4 a[136:139], v2, s[36:39], s55 offen offset:0
    v_lshlrev_b32 v192, 16, v114
    v_mfma_f32_16x16x32_bf16 v[52:55], a[200:203], a[108:111], v[52:55]
    v_and_b32 v193, 0xffff0000, v114
    v_lshlrev_b32 v194, 16, v115
    v_mfma_f32_16x16x32_bf16 v[52:55], a[196:199], a[92:95], v[52:55]
    v_and_b32 v195, 0xffff0000, v115
    v_lshlrev_b32 v196, 16, v116
    v_mfma_f32_16x16x32_bf16 a[0:3], a[196:199], a[96:99], a[0:3]
    s_waitcnt lgkmcnt(0)
    s_barrier
    v_mfma_f32_16x16x32_bf16 a[0:3], a[200:203], a[112:115], a[0:3]
    ds_read_b128 a[40:43], v5 offset:0
    buffer_load_dwordx4 a[140:143], v2, s[36:39], s55 offen offset:1024
    v_and_b32 v197, 0xffff0000, v116
    v_mfma_f32_16x16x32_bf16 a[0:3], a[204:207], a[128:131], a[0:3]
    ds_read_b128 a[56:59], v5 offset:32
    v_lshlrev_b32 v198, 16, v117
    v_mfma_f32_16x16x32_bf16 a[20:23], a[204:207], a[132:135], a[20:23]
    ds_read_b128 a[72:75], v5 offset:64
    v_and_b32 v199, 0xffff0000, v117
    v_mfma_f32_16x16x32_bf16 a[20:23], a[200:203], a[116:119], a[20:23]
    ds_read_b128 a[44:47], v5 offset:512
    buffer_load_dwordx4 a[144:147], v2, s[36:39], s55 offen offset:2048
    v_mfma_f32_16x16x32_bf16 a[20:23], a[196:199], a[100:103], a[20:23]
    ds_read_b128 a[60:63], v5 offset:544
    s_waitcnt vmcnt(12)
    v_mfma_f32_16x16x32_bf16 v[36:39], a[208:211], a[88:91], v[36:39]
    ds_read_b128 a[76:79], v5 offset:576
    v_lshlrev_b32 v200, 16, v118
    v_and_b32 v201, 0xffff0000, v118
    v_mfma_f32_16x16x32_bf16 v[36:39], a[212:215], a[104:107], v[36:39]
    ds_read_b128 a[48:51], v6 offset:0
    v_lshlrev_b32 v202, 16, v119
    v_mfma_f32_16x16x32_bf16 v[36:39], a[216:219], a[120:123], v[36:39]
    ds_read_b128 a[64:67], v6 offset:32
    buffer_load_dwordx4 a[148:151], v2, s[36:39], s55 offen offset:3072
    v_mfma_f32_16x16x32_bf16 v[56:59], a[216:219], a[124:127], v[56:59]
    ds_read_b128 a[80:83], v6 offset:64
    s_add_u32 s55, s24, 126976
    v_mfma_f32_16x16x32_bf16 v[56:59], a[212:215], a[108:111], v[56:59]
    ds_read_b128 a[52:55], v6 offset:512
    v_and_b32 v203, 0xffff0000, v119
    v_mfma_f32_16x16x32_bf16 v[56:59], a[208:211], a[92:95], v[56:59]
    ds_read_b128 a[68:71], v6 offset:544
    v_add_f32 v124, v188, v196
    v_add_f32 v125, v189, v197
    v_mfma_f32_16x16x32_bf16 a[4:7], a[208:211], a[96:99], a[4:7]
    ds_read_b128 a[84:87], v6 offset:576
    buffer_load_dwordx4 a[152:155], v2, s[36:39], s55 offen offset:0
    v_mfma_f32_16x16x32_bf16 a[4:7], a[212:215], a[112:115], a[4:7]
    v_add_f32 v126, v190, v198
    v_add_f32 v127, v191, v199
    v_mfma_f32_16x16x32_bf16 a[4:7], a[216:219], a[128:131], a[4:7]
    v_add_f32 v128, v192, v200
    v_add_f32 v129, v193, v201
    v_mfma_f32_16x16x32_bf16 a[24:27], a[216:219], a[132:135], a[24:27]
    buffer_load_dwordx2 v[248:249], v254, s[36:39], s65 offen sc1
    v_add_f32 v130, v194, v202
    v_mfma_f32_16x16x32_bf16 a[24:27], a[212:215], a[116:119], a[24:27]
    v_add_f32 v131, v195, v203
    v_cvt_pk_bf16_f32 v144, v124, v125
    v_cvt_pk_bf16_f32 v145, v126, v127
    v_mfma_f32_16x16x32_bf16 a[24:27], a[208:211], a[100:103], a[24:27]
    v_cvt_pk_bf16_f32 v146, v128, v129
    s_waitcnt vmcnt(12)
    v_mfma_f32_16x16x32_bf16 v[40:43], a[220:223], a[88:91], v[40:43]
    v_cvt_pk_bf16_f32 v147, v130, v131
    v_sub_f32 v124, v196, v188
    v_mfma_f32_16x16x32_bf16 v[40:43], a[224:227], a[104:107], v[40:43]
    ds_write_b128 v7, v[144:147] offset:20800
    buffer_load_dwordx4 a[156:159], v2, s[36:39], s55 offen offset:1024
    v_mfma_f32_16x16x32_bf16 v[40:43], a[228:231], a[120:123], v[40:43]
    v_sub_f32 v125, v197, v189
    v_sub_f32 v126, v198, v190
    v_mfma_f32_16x16x32_bf16 v[60:63], a[228:231], a[124:127], v[60:63]
    v_sub_f32 v127, v199, v191
    v_sub_f32 v128, v200, v192
    v_sub_f32 v129, v201, v193
    v_mfma_f32_16x16x32_bf16 v[60:63], a[224:227], a[108:111], v[60:63]
    buffer_load_dwordx4 a[160:163], v2, s[36:39], s55 offen offset:2048
    v_sub_f32 v130, v202, v194
    v_mfma_f32_16x16x32_bf16 v[60:63], a[220:223], a[92:95], v[60:63]
    v_sub_f32 v131, v203, v195
    v_cvt_pk_bf16_f32 v148, v124, v125
    v_mfma_f32_16x16x32_bf16 a[8:11], a[220:223], a[96:99], a[8:11]
    v_cvt_pk_bf16_f32 v149, v126, v127
    v_cvt_pk_bf16_f32 v150, v128, v129
    v_mfma_f32_16x16x32_bf16 a[8:11], a[224:227], a[112:115], a[8:11]
    v_cvt_pk_bf16_f32 v151, v130, v131
    v_lshlrev_b32 v132, 16, v108
    v_mfma_f32_16x16x32_bf16 a[8:11], a[228:231], a[128:131], a[8:11]
    ds_write_b128 v7, v[148:151] offset:24960
    buffer_load_dwordx4 a[164:167], v2, s[36:39], s55 offen offset:3072
    s_add_u32 s55, s24, 131072
    v_mfma_f32_16x16x32_bf16 a[28:31], a[228:231], a[132:135], a[28:31]
    v_and_b32 v133, 0xffff0000, v108
    v_lshlrev_b32 v134, 16, v109
    v_mfma_f32_16x16x32_bf16 a[28:31], a[224:227], a[116:119], a[28:31]
    v_and_b32 v135, 0xffff0000, v109
    v_lshlrev_b32 v136, 16, v110
    v_mfma_f32_16x16x32_bf16 a[28:31], a[220:223], a[100:103], a[28:31]
    v_and_b32 v137, 0xffff0000, v110
    s_waitcnt vmcnt(12)
    v_mfma_f32_16x16x32_bf16 v[44:47], a[232:235], a[88:91], v[44:47]
    buffer_load_dwordx4 a[168:171], v2, s[36:39], s55 offen offset:0
    v_lshlrev_b32 v138, 16, v111
    v_mfma_f32_16x16x32_bf16 v[44:47], a[236:239], a[104:107], v[44:47]
    v_and_b32 v139, 0xffff0000, v111
    v_sub_f32 v124, v196, v132
    v_sub_f32 v125, v197, v133
    v_mfma_f32_16x16x32_bf16 v[44:47], a[240:243], a[120:123], v[44:47]
    v_sub_f32 v126, v198, v134
    v_sub_f32 v127, v199, v135
    v_mfma_f32_16x16x32_bf16 v[64:67], a[240:243], a[124:127], v[64:67]
    buffer_load_dwordx4 a[172:175], v2, s[36:39], s55 offen offset:1024
    v_sub_f32 v128, v200, v136
    v_mfma_f32_16x16x32_bf16 v[64:67], a[236:239], a[108:111], v[64:67]
    v_sub_f32 v129, v201, v137
    v_sub_f32 v130, v202, v138
    v_mfma_f32_16x16x32_bf16 v[64:67], a[232:235], a[92:95], v[64:67]
    v_sub_f32 v131, v203, v139
    v_cvt_pk_bf16_f32 v140, v124, v125
    v_mfma_f32_16x16x32_bf16 a[12:15], a[232:235], a[96:99], a[12:15]
    v_cvt_pk_bf16_f32 v141, v126, v127
    v_cvt_pk_bf16_f32 v142, v128, v129
    v_cvt_pk_bf16_f32 v143, v130, v131
    v_mfma_f32_16x16x32_bf16 a[12:15], a[236:239], a[112:115], a[12:15]
    buffer_load_dwordx4 a[176:179], v2, s[36:39], s55 offen offset:2048
    v_lshlrev_b32 v132, 16, v120
    v_mfma_f32_16x16x32_bf16 a[12:15], a[240:243], a[128:131], a[12:15]
    ds_write_b128 v7, v[140:143] offset:16640
    v_and_b32 v133, 0xffff0000, v120
    v_mfma_f32_16x16x32_bf16 a[32:35], a[240:243], a[132:135], a[32:35]
    v_lshlrev_b32 v134, 16, v121
    v_and_b32 v135, 0xffff0000, v121
    v_mfma_f32_16x16x32_bf16 a[32:35], a[236:239], a[116:119], a[32:35]
    buffer_load_dwordx4 a[180:183], v2, s[36:39], s55 offen offset:3072
    s_add_u32 s55, s24, 135168
    v_mfma_f32_16x16x32_bf16 a[32:35], a[232:235], a[100:103], a[32:35]
    v_lshlrev_b32 v136, 16, v122
    v_and_b32 v137, 0xffff0000, v122
    s_waitcnt vmcnt(13)
    v_mfma_f32_16x16x32_bf16 v[48:51], a[244:247], a[88:91], v[48:51]
    v_lshlrev_b32 v138, 16, v123
    v_and_b32 v139, 0xffff0000, v123
    v_mfma_f32_16x16x32_bf16 v[48:51], a[248:251], a[104:107], v[48:51]
    v_sub_f32 v124, v188, v132
    v_sub_f32 v125, v189, v133
    v_mfma_f32_16x16x32_bf16 v[48:51], a[252:255], a[120:123], v[48:51]
    buffer_load_dwordx4 a[184:187], v2, s[36:39], s55 offen offset:0
    v_sub_f32 v126, v190, v134
    v_mfma_f32_16x16x32_bf16 v[68:71], a[252:255], a[124:127], v[68:71]
    v_sub_f32 v127, v191, v135
    v_sub_f32 v128, v192, v136
    v_mfma_f32_16x16x32_bf16 v[68:71], a[248:251], a[108:111], v[68:71]
    v_sub_f32 v129, v193, v137
    v_sub_f32 v130, v194, v138
    v_sub_f32 v131, v195, v139
    v_mfma_f32_16x16x32_bf16 v[68:71], a[244:247], a[92:95], v[68:71]
    v_cvt_pk_bf16_f32 v152, v124, v125
    v_cvt_pk_bf16_f32 v153, v126, v127
    v_mfma_f32_16x16x32_bf16 a[16:19], a[244:247], a[96:99], a[16:19]
    buffer_load_dwordx4 a[188:191], v2, s[36:39], s55 offen offset:1024
    v_cvt_pk_bf16_f32 v154, v128, v129
    v_mfma_f32_16x16x32_bf16 a[16:19], a[248:251], a[112:115], a[16:19]
    v_cvt_pk_bf16_f32 v155, v130, v131
    v_add_f32 v172, v172, v176
    v_mfma_f32_16x16x32_bf16 a[16:19], a[252:255], a[128:131], a[16:19]
    ds_write_b128 v7, v[152:155] offset:29120
    v_add_f32 v173, v173, v177
    v_mfma_f32_16x16x32_bf16 a[36:39], a[252:255], a[132:135], a[36:39]
    buffer_load_dwordx4 a[192:195], v2, s[36:39], s55 offen offset:2048
    v_add_f32 v174, v174, v178
    v_add_f32 v175, v175, v179
    v_mfma_f32_16x16x32_bf16 a[36:39], a[248:251], a[116:119], a[36:39]
    v_add_f32 v184, v184, v185
    v_add_f32 v172, v172, v180
    v_mfma_f32_16x16x32_bf16 a[36:39], a[244:247], a[100:103], a[36:39]
    v_add_f32 v173, v173, v181
    s_waitcnt vmcnt(13) lgkmcnt(4)
    v_mfma_f32_16x16x32_bf16 v[32:35], a[136:139], a[40:43], v[32:35]
    v_add_f32 v174, v174, v182
    v_add_f32 v175, v175, v183
    v_mfma_f32_16x16x32_bf16 v[32:35], a[140:143], a[56:59], v[32:35]
    s_waitcnt lgkmcnt(0)
    s_barrier
    v_mfma_f32_16x16x32_bf16 v[32:35], a[144:147], a[72:75], v[32:35]
    ds_read_b128 a[88:91], v5 offset:16640
    buffer_load_dwordx4 a[196:199], v2, s[36:39], s55 offen offset:3072
    v_mfma_f32_16x16x32_bf16 v[52:55], a[144:147], a[76:79], v[52:55]
    ds_read_b128 a[104:107], v5 offset:16672
    s_add_u32 s55, s24, 139264
    v_mfma_f32_16x16x32_bf16 v[52:55], a[140:143], a[60:63], v[52:55]
    ds_read_b128 a[120:123], v5 offset:16704
    v_add_f32 v184, v184, v186
    v_mfma_f32_16x16x32_bf16 v[52:55], a[136:139], a[44:47], v[52:55]
    ds_read_b128 a[92:95], v5 offset:17152
    buffer_load_dwordx4 a[200:203], v2, s[36:39], s55 offen offset:0
    v_mfma_f32_16x16x32_bf16 a[0:3], a[136:139], a[48:51], a[0:3]
    ds_read_b128 a[108:111], v5 offset:17184
    v_mov_b32 v187, 1.0
    v_mfma_f32_16x16x32_bf16 a[0:3], a[140:143], a[64:67], a[0:3]
    ds_read_b128 a[124:127], v5 offset:17216
    v_mfma_f32_16x16x32_bf16 a[0:3], a[144:147], a[80:83], a[0:3]
    ds_read_b128 a[96:99], v6 offset:16640
    v_mfma_f32_16x16x32_bf16 a[20:23], a[144:147], a[84:87], a[20:23]
    ds_read_b128 a[112:115], v6 offset:16672
    buffer_load_dwordx4 a[204:207], v2, s[36:39], s55 offen offset:1024
    v_mfma_f32_16x16x32_bf16 a[20:23], a[140:143], a[68:71], a[20:23]
    ds_read_b128 a[128:131], v6 offset:16704
    v_mfma_f32_16x16x4_f32 v[224:227], v172, v187, 0
    v_mfma_f32_16x16x32_bf16 a[20:23], a[136:139], a[52:55], a[20:23]
    ds_read_b128 a[100:103], v6 offset:17152
    s_waitcnt vmcnt(12) lgkmcnt(7)
    v_mfma_f32_16x16x32_bf16 v[32:35], a[148:151], a[88:91], v[32:35]
    ds_read_b128 a[116:119], v6 offset:17184
    v_mfma_f32_16x16x32_bf16 v[32:35], a[152:155], a[104:107], v[32:35]
    ds_read_b128 a[132:135], v6 offset:17216
    buffer_load_dwordx4 a[208:211], v2, s[36:39], s55 offen offset:2048
    v_mfma_f32_16x16x32_bf16 v[32:35], a[156:159], a[120:123], v[32:35]
    s_waitcnt lgkmcnt(6)
    v_mfma_f32_16x16x32_bf16 v[52:55], a[156:159], a[124:127], v[52:55]
    v_mfma_f32_16x16x4_f32 v[228:231], v173, v187, 0
    v_mfma_f32_16x16x32_bf16 v[52:55], a[152:155], a[108:111], v[52:55]
    buffer_load_dwordx4 a[212:215], v2, s[36:39], s55 offen offset:3072
    s_add_u32 s55, s24, 143360
    v_mfma_f32_16x16x32_bf16 v[52:55], a[148:151], a[92:95], v[52:55]
    s_waitcnt lgkmcnt(3)
    v_mfma_f32_16x16x32_bf16 a[0:3], a[148:151], a[96:99], a[0:3]
    v_mfma_f32_16x16x4_f32 v[232:235], v174, v187, 0
    v_mfma_f32_16x16x32_bf16 a[0:3], a[152:155], a[112:115], a[0:3]
    v_mfma_f32_16x16x32_bf16 a[0:3], a[156:159], a[128:131], a[0:3]
    buffer_load_dwordx4 a[216:219], v2, s[36:39], s55 offen offset:0
    s_waitcnt lgkmcnt(0)
    v_mfma_f32_16x16x32_bf16 a[20:23], a[156:159], a[132:135], a[20:23]
    v_mfma_f32_16x16x4_f32 v[236:239], v175, v187, 0
    v_mfma_f32_16x16x32_bf16 a[20:23], a[152:155], a[116:119], a[20:23]
    ds_write_b128 v9, v[32:35] offset:0
    v_mfma_f32_16x16x32_bf16 a[20:23], a[148:151], a[100:103], a[20:23]
    s_waitcnt vmcnt(12)
    v_mfma_f32_16x16x32_bf16 v[36:39], a[160:163], a[40:43], v[36:39]
    buffer_load_dwordx4 a[220:223], v2, s[36:39], s55 offen offset:1024
    v_mfma_f32_16x16x4_f32 v[240:243], v184, v187, 0
    v_mfma_f32_16x16x32_bf16 v[36:39], a[164:167], a[56:59], v[36:39]
    ds_write_b128 v9, v[52:55] offset:5120
    v_mov_b32 v24, 0
    v_mfma_f32_16x16x32_bf16 v[36:39], a[168:171], a[72:75], v[36:39]
    v_mov_b32 v25, 0
    s_waitcnt vmcnt(10)
    v_mfma_f32_16x16x32_bf16 v[36:39], a[172:175], a[88:91], v[36:39]
    buffer_load_dwordx4 a[224:227], v2, s[36:39], s55 offen offset:2048
    v_mov_b32 v26, 0
    v_mfma_f32_16x16x32_bf16 v[36:39], a[176:179], a[104:107], v[36:39]
    ds_write_b128 v9, a[0:3] offset:10240
    v_mov_b32 v27, 0
    v_mfma_f32_16x16x32_bf16 v[36:39], a[180:183], a[120:123], v[36:39]
    v_mfma_f32_16x16x32_bf16 v[56:59], a[180:183], a[124:127], v[56:59]
    v_mfma_f32_16x16x32_bf16 v[56:59], a[176:179], a[108:111], v[56:59]
    ds_write_b128 v9, a[20:23] offset:15360
    buffer_load_dwordx4 a[228:231], v2, s[36:39], s55 offen offset:3072
    v_mfma_f32_16x16x32_bf16 v[56:59], a[172:175], a[92:95], v[56:59]
    s_add_u32 s55, s24, 147456
    v_mfma_f32_16x16x32_bf16 v[56:59], a[168:171], a[76:79], v[56:59]
    v_mfma_f32_16x16x32_bf16 v[56:59], a[164:167], a[60:63], v[56:59]
    v_mfma_f32_16x16x32_bf16 v[56:59], a[160:163], a[44:47], v[56:59]
    buffer_load_dwordx4 a[232:235], v2, s[36:39], s55 offen offset:0
    v_mfma_f32_16x16x32_bf16 a[4:7], a[160:163], a[48:51], a[4:7]
    v_mfma_f32_16x16x32_bf16 a[4:7], a[164:167], a[64:67], a[4:7]
    ds_write_b128 v9, v[36:39] offset:1024
    s_waitcnt lgkmcnt(1)
    v_mfma_f32_16x16x32_bf16 a[4:7], a[168:171], a[80:83], a[4:7]
    s_barrier
    ds_read_b128 v[92:95], v10 offset:0
    v_mfma_f32_16x16x32_bf16 a[4:7], a[172:175], a[96:99], a[4:7]
    ds_read_b128 v[96:99], v10 offset:5120
    buffer_load_dwordx4 a[236:239], v2, s[36:39], s55 offen offset:1024
    v_mfma_f32_16x16x32_bf16 a[4:7], a[176:179], a[112:115], a[4:7]
    ds_read_b128 v[100:103], v11 offset:0
    v_mfma_f32_16x16x32_bf16 a[4:7], a[180:183], a[128:131], a[4:7]
    ds_read_b128 v[104:107], v11 offset:5120
    v_mfma_f32_16x16x32_bf16 a[24:27], a[180:183], a[132:135], a[24:27]
    buffer_load_dwordx4 a[240:243], v2, s[36:39], s55 offen offset:2048
    v_mfma_f32_16x16x32_bf16 a[24:27], a[176:179], a[116:119], a[24:27]
    ds_write_b128 v9, v[56:59] offset:6144
    v_mfma_f32_16x16x32_bf16 a[24:27], a[172:175], a[100:103], a[24:27]
    v_mfma_f32_16x16x32_bf16 a[24:27], a[168:171], a[84:87], a[24:27]
    v_mfma_f32_16x16x32_bf16 a[24:27], a[164:167], a[68:71], a[24:27]
    buffer_load_dwordx4 a[244:247], v2, s[36:39], s55 offen offset:3072
    s_add_u32 s55, s24, 151552
    v_mfma_f32_16x16x32_bf16 a[24:27], a[160:163], a[52:55], a[24:27]
    s_waitcnt lgkmcnt(1)
    s_waitcnt vmcnt(13)
    v_mfma_f32_16x16x32_bf16 v[40:43], a[184:187], a[40:43], v[40:43]
    v_fma_f32 v32, v32, s14, v224
    v_fma_f32 v33, v33, s14, v225
    v_mfma_f32_16x16x32_bf16 v[40:43], a[188:191], a[56:59], v[40:43]
    ds_write_b128 v9, a[4:7] offset:11264
    v_fma_f32 v34, v34, s14, v226
    v_mfma_f32_16x16x32_bf16 v[40:43], a[192:195], a[72:75], v[40:43]
    buffer_load_dwordx4 a[248:251], v2, s[36:39], s55 offen offset:0
    s_waitcnt vmcnt(11)
    v_mfma_f32_16x16x32_bf16 v[40:43], a[196:199], a[88:91], v[40:43]
    v_fma_f32 v35, v35, s14, v227
    v_fma_f32 v52, v52, s14, v224
    v_mfma_f32_16x16x32_bf16 v[40:43], a[200:203], a[104:107], v[40:43]
    v_fma_f32 v53, v53, s14, v225
    v_fma_f32 v54, v54, s14, v226
    v_mfma_f32_16x16x32_bf16 v[40:43], a[204:207], a[120:123], v[40:43]
    buffer_load_dwordx4 a[252:255], v2, s[36:39], s55 offen offset:1024
    v_cmp_ne_u64 vcc, s[52:53], v[248:249]
    v_mfma_f32_16x16x32_bf16 v[60:63], a[204:207], a[124:127], v[60:63]
    s_and_b64 vcc, vcc, -1
    s_cbranch_scc1 L_late_slow
L_late_ok:
    s_add_u32 s55, s24, 162816
    v_mfma_f32_16x16x32_bf16 v[60:63], a[200:203], a[108:111], v[60:63]
    ds_write_b128 v9, a[24:27] offset:16384
    v_fma_f32 v55, v55, s14, v227
    v_mfma_f32_16x16x32_bf16 v[60:63], a[196:199], a[92:95], v[60:63]
    v_fma_f32 v32, v92, s16, v32
    v_fma_f32 v33, v93, s16, v33
    v_mfma_f32_16x16x32_bf16 v[60:63], a[192:195], a[76:79], v[60:63]
    buffer_load_dwordx4 a[136:139], v2, s[36:39], s55 offen offset:0
    v_fma_f32 v34, v94, s16, v34
    v_mfma_f32_16x16x32_bf16 v[60:63], a[188:191], a[60:63], v[60:63]
    v_fma_f32 v35, v95, s16, v35
    v_fma_f32 v52, v96, s16, v52
    v_mfma_f32_16x16x32_bf16 v[60:63], a[184:187], a[44:47], v[60:63]
    v_fma_f32 v53, v97, s16, v53
    v_fma_f32 v54, v98, s16, v54
    v_mfma_f32_16x16x32_bf16 a[8:11], a[184:187], a[48:51], a[8:11]
    s_getpc_b64 s[0:1]
L_pc2:
    v_min_u32 v253, L_done-L_pc2, v253
    v_fma_f32 v55, v99, s16, v55
    v_mfma_f32_16x16x32_bf16 a[8:11], a[188:191], a[64:67], a[8:11]
    ds_write_b128 v9, v[40:43] offset:2048
    s_waitcnt lgkmcnt(1)
    v_mfma_f32_16x16x32_bf16 a[8:11], a[192:195], a[80:83], a[8:11]
    s_barrier
    ds_read_b128 v[108:111], v10 offset:1024
    v_mfma_f32_16x16x32_bf16 a[8:11], a[196:199], a[96:99], a[8:11]
    ds_read_b128 v[112:115], v10 offset:6144
    global_load_dword v0, v253, s[0:1] sc1
    v_mfma_f32_16x16x32_bf16 a[8:11], a[200:203], a[112:115], a[8:11]
    ds_read_b128 v[116:119], v11 offset:1024
    v_fma_f32 v32, v100, s18, v32
    v_mfma_f32_16x16x32_bf16 a[8:11], a[204:207], a[128:131], a[8:11]
    ds_read_b128 v[120:123], v11 offset:6144
    v_fma_f32 v33, v101, s18, v33
    v_mfma_f32_16x16x32_bf16 a[28:31], a[204:207], a[132:135], a[28:31]
    buffer_load_dwordx4 a[140:143], v2, s[36:39], s55 offen offset:1024
    v_fma_f32 v34, v102, s18, v34
    v_mfma_f32_16x16x32_bf16 a[28:31], a[200:203], a[116:119], a[28:31]
    ds_write_b128 v9, v[60:63] offset:7168
    v_fma_f32 v35, v103, s18, v35
    v_mfma_f32_16x16x32_bf16 a[28:31], a[196:199], a[100:103], a[28:31]
    v_fma_f32 v52, v104, s18, v52
    v_fma_f32 v53, v105, s18, v53
    v_mfma_f32_16x16x32_bf16 a[28:31], a[192:195], a[84:87], a[28:31]
    v_fma_f32 v54, v106, s18, v54
    v_fma_f32 v55, v107, s18, v55
    v_mfma_f32_16x16x32_bf16 a[28:31], a[188:191], a[68:71], a[28:31]
    buffer_load_dwordx4 a[144:147], v2, s[36:39], s55 offen offset:2048
    v_fmac_f32 v24, v32, v32
    v_mfma_f32_16x16x32_bf16 a[28:31], a[184:187], a[52:55], a[28:31]
    v_fmac_f32 v25, v33, v33
    s_waitcnt vmcnt(13)
    v_mfma_f32_16x16x32_bf16 v[44:47], a[208:211], a[40:43], v[44:47]
    v_add_f32 v26, v26, v32
    v_add_f32 v27, v27, v33
    v_mfma_f32_16x16x32_bf16 v[44:47], a[212:215], a[56:59], v[44:47]
    ds_write_b128 v9, a[8:11] offset:12288
    v_fmac_f32 v24, v34, v34
    v_mfma_f32_16x16x32_bf16 v[44:47], a[216:219], a[72:75], v[44:47]
    buffer_load_dwordx4 a[148:151], v2, s[36:39], s55 offen offset:3072
    s_waitcnt vmcnt(11)
    v_mfma_f32_16x16x32_bf16 v[44:47], a[220:223], a[88:91], v[44:47]
    s_add_u32 s55, s24, 166912
    v_fmac_f32 v25, v35, v35
    v_mfma_f32_16x16x32_bf16 v[44:47], a[224:227], a[104:107], v[44:47]
    v_add_f32 v26, v26, v34
    v_add_f32 v27, v27, v35
    v_mfma_f32_16x16x32_bf16 v[44:47], a[228:231], a[120:123], v[44:47]
    buffer_load_dwordx4 a[152:155], v2, s[36:39], s55 offen offset:0
    v_fmac_f32 v24, v52, v52
    v_mfma_f32_16x16x32_bf16 v[64:67], a[228:231], a[124:127], v[64:67]
    v_fmac_f32 v25, v53, v53
    v_add_f32 v26, v26, v52
    v_mfma_f32_16x16x32_bf16 v[64:67], a[224:227], a[108:111], v[64:67]
    ds_write_b128 v9, a[28:31] offset:17408
    v_add_f32 v27, v27, v53
    v_mfma_f32_16x16x32_bf16 v[64:67], a[220:223], a[92:95], v[64:67]
    v_fmac_f32 v24, v54, v54
    v_fmac_f32 v25, v55, v55
    v_mfma_f32_16x16x32_bf16 v[64:67], a[216:219], a[76:79], v[64:67]
    buffer_load_dwordx4 a[156:159], v2, s[36:39], s55 offen offset:1024
    v_add_f32 v26, v26, v54
    v_mfma_f32_16x16x32_bf16 v[64:67], a[212:215], a[60:63], v[64:67]
    v_add_f32 v27, v27, v55
    s_waitcnt lgkmcnt(3)
    v_mfma_f32_16x16x32_bf16 v[64:67], a[208:211], a[44:47], v[64:67]
    v_fma_f32 v36, v36, s14, v228
    v_fma_f32 v37, v37, s14, v229
    v_mfma_f32_16x16x32_bf16 a[12:15], a[208:211], a[48:51], a[12:15]
    v_fma_f32 v38, v38, s14, v230
    v_fma_f32 v39, v39, s14, v231
    v_mfma_f32_16x16x32_bf16 a[12:15], a[212:215], a[64:67], a[12:15]
    ds_write_b128 v9, v[44:47] offset:3072
    s_waitcnt lgkmcnt(1)
    v_mfma_f32_16x16x32_bf16 a[12:15], a[216:219], a[80:83], a[12:15]
    s_barrier
    ds_read_b128 v[124:127], v10 offset:2048
    v_mfma_f32_16x16x32_bf16 a[12:15], a[220:223], a[96:99], a[12:15]
    ds_read_b128 v[128:131], v10 offset:7168
    buffer_load_dwordx4 a[160:163], v2, s[36:39], s55 offen offset:2048
    v_mfma_f32_16x16x32_bf16 a[12:15], a[224:227], a[112:115], a[12:15]
    ds_read_b128 v[132:135], v11 offset:2048
    v_fma_f32 v56, v56, s14, v228
    v_mfma_f32_16x16x32_bf16 a[12:15], a[228:231], a[128:131], a[12:15]
    ds_read_b128 v[136:139], v11 offset:7168
    v_fma_f32 v57, v57, s14, v229
    v_mfma_f32_16x16x32_bf16 a[32:35], a[228:231], a[132:135], a[32:35]
    buffer_load_dwordx4 a[164:167], v2, s[36:39], s55 offen offset:3072
    s_add_u32 s55, s24, 171008
    v_mfma_f32_16x16x32_bf16 a[32:35], a[224:227], a[116:119], a[32:35]
    ds_write_b128 v9, v[64:67] offset:8192
    v_fma_f32 v58, v58, s14, v230
    v_mfma_f32_16x16x32_bf16 a[32:35], a[220:223], a[100:103], a[32:35]
    v_fma_f32 v59, v59, s14, v231
    v_fma_f32 v36, v108, s16, v36
    v_mfma_f32_16x16x32_bf16 a[32:35], a[216:219], a[84:87], a[32:35]
    v_fma_f32 v37, v109, s16, v37
    v_fma_f32 v38, v110, s16, v38
    v_mfma_f32_16x16x32_bf16 a[32:35], a[212:215], a[68:71], a[32:35]
L_page5:
    s_cbranch_execz L_page6
    buffer_load_dwordx4 a[168:171], v2, s[36:39], s55 offen offset:0
    v_fma_f32 v39, v111, s16, v39
    v_mfma_f32_16x16x32_bf16 a[32:35], a[208:211], a[52:55], a[32:35]
    v_fma_f32 v56, v112, s16, v56
    s_waitcnt vmcnt(13)
    v_mfma_f32_16x16x32_bf16 v[48:51], a[232:235], a[40:43], v[48:51]
    v_fma_f32 v57, v113, s16, v57
    v_fma_f32 v58, v114, s16, v58
    v_mfma_f32_16x16x32_bf16 v[48:51], a[236:239], a[56:59], v[48:51]
    ds_write_b128 v9, a[12:15] offset:13312
    v_fma_f32 v59, v115, s16, v59
    v_mfma_f32_16x16x32_bf16 v[48:51], a[240:243], a[72:75], v[48:51]
    buffer_load_dwordx4 a[172:175], v2, s[36:39], s55 offen offset:1024
    s_waitcnt vmcnt(11)
    v_mfma_f32_16x16x32_bf16 v[48:51], a[244:247], a[88:91], v[48:51]
    v_fma_f32 v36, v116, s18, v36
    v_fma_f32 v37, v117, s18, v37
    v_mfma_f32_16x16x32_bf16 v[48:51], a[248:251], a[104:107], v[48:51]
    v_fma_f32 v38, v118, s18, v38
    v_fma_f32 v39, v119, s18, v39
    v_mfma_f32_16x16x32_bf16 v[48:51], a[252:255], a[120:123], v[48:51]
    buffer_load_dwordx4 a[176:179], v2, s[36:39], s55 offen offset:2048
    v_fma_f32 v56, v120, s18, v56
    v_mfma_f32_16x16x32_bf16 v[68:71], a[252:255], a[124:127], v[68:71]
    v_fma_f32 v57, v121, s18, v57
    v_fma_f32 v58, v122, s18, v58
    v_mfma_f32_16x16x32_bf16 v[68:71], a[248:251], a[108:111], v[68:71]
    ds_write_b128 v9, a[32:35] offset:18432
    v_fma_f32 v59, v123, s18, v59
    v_mfma_f32_16x16x32_bf16 v[68:71], a[244:247], a[92:95], v[68:71]
    v_fmac_f32 v24, v36, v36
    v_fmac_f32 v25, v37, v37
    v_mfma_f32_16x16x32_bf16 v[68:71], a[240:243], a[76:79], v[68:71]
    buffer_load_dwordx4 a[180:183], v2, s[36:39], s55 offen offset:3072
    s_add_u32 s55, s24, 175104
    v_mfma_f32_16x16x32_bf16 v[68:71], a[236:239], a[60:63], v[68:71]
    v_add_f32 v26, v26, v36
    v_add_f32 v27, v27, v37
    v_mfma_f32_16x16x32_bf16 v[68:71], a[232:235], a[44:47], v[68:71]
    v_fmac_f32 v24, v38, v38
    v_fmac_f32 v25, v39, v39
    v_mfma_f32_16x16x32_bf16 a[16:19], a[232:235], a[48:51], a[16:19]
    v_add_f32 v26, v26, v38
    v_add_f32 v27, v27, v39
    v_mfma_f32_16x16x32_bf16 a[16:19], a[236:239], a[64:67], a[16:19]
    ds_write_b128 v9, v[48:51] offset:4096
    s_waitcnt lgkmcnt(1)
    v_mfma_f32_16x16x32_bf16 a[16:19], a[240:243], a[80:83], a[16:19]
    s_barrier
    ds_read_b128 v[92:95], v10 offset:3072
    v_mfma_f32_16x16x32_bf16 a[16:19], a[244:247], a[96:99], a[16:19]
    ds_read_b128 v[96:99], v10 offset:8192
    buffer_load_dwordx4 a[184:187], v2, s[36:39], s55 offen offset:0
    v_mfma_f32_16x16x32_bf16 a[16:19], a[248:251], a[112:115], a[16:19]
    ds_read_b128 v[100:103], v11 offset:3072
    v_fmac_f32 v24, v56, v56
    v_mfma_f32_16x16x32_bf16 a[16:19], a[252:255], a[128:131], a[16:19]
    ds_read_b128 v[104:107], v11 offset:8192
    v_fmac_f32 v25, v57, v57
    v_mfma_f32_16x16x32_bf16 a[36:39], a[252:255], a[132:135], a[36:39]
    buffer_load_dwordx4 a[188:191], v2, s[36:39], s55 offen offset:1024
    v_add_f32 v26, v26, v56
    v_mfma_f32_16x16x32_bf16 a[36:39], a[248:251], a[116:119], a[36:39]
    ds_write_b128 v9, v[68:71] offset:9216
    v_add_f32 v27, v27, v57
    v_mfma_f32_16x16x32_bf16 a[36:39], a[244:247], a[100:103], a[36:39]
    v_fmac_f32 v24, v58, v58
    v_fmac_f32 v25, v59, v59
    v_mfma_f32_16x16x32_bf16 a[36:39], a[240:243], a[84:87], a[36:39]
    v_add_f32 v26, v26, v58
    v_add_f32 v27, v27, v59
    v_mfma_f32_16x16x32_bf16 a[36:39], a[236:239], a[68:71], a[36:39]
    buffer_load_dwordx4 a[192:195], v2, s[36:39], s55 offen offset:2048
    v_fma_f32 v40, v40, s14, v232
    v_mfma_f32_16x16x32_bf16 a[36:39], a[232:235], a[52:55], a[36:39]
    v_fma_f32 v41, v41, s14, v233
    v_fma_f32 v42, v42, s14, v234
    buffer_load_dwordx4 a[196:199], v2, s[36:39], s55 offen offset:3072
    v_fma_f32 v43, v43, s14, v235
    v_pk_fma_f32 v[60:61], v[60:61], s[14:15], v[232:233] op_sel_hi:[1,0,1]
    v_pk_fma_f32 v[62:63], v[62:63], s[14:15], v[234:235] op_sel_hi:[1,0,1]
    ds_write_b128 v9, a[16:19] offset:14336
    v_pk_fma_f32 v[40:41], v[124:125], s[16:17], v[40:41] op_sel_hi:[1,0,1]
    v_pk_fma_f32 v[42:43], v[126:127], s[16:17], v[42:43] op_sel_hi:[1,0,1]
    v_pk_fma_f32 v[60:61], v[128:129], s[16:17], v[60:61] op_sel_hi:[1,0,1]
    v_pk_fma_f32 v[62:63], v[130:131], s[16:17], v[62:63] op_sel_hi:[1,0,1]
    ds_write_b128 v9, a[36:39] offset:19456
    v_pk_fma_f32 v[40:41], v[132:133], s[18:19], v[40:41] op_sel_hi:[1,0,1]
    v_pk_fma_f32 v[42:43], v[134:135], s[18:19], v[42:43] op_sel_hi:[1,0,1]
    v_pk_fma_f32 v[60:61], v[136:137], s[18:19], v[60:61] op_sel_hi:[1,0,1]
    v_pk_fma_f32 v[62:63], v[138:139], s[18:19], v[62:63] op_sel_hi:[1,0,1]
    v_pk_fma_f32 v[24:25], v[40:41], v[40:41], v[24:25]
    v_pk_add_f32 v[26:27], v[26:27], v[40:41]
    v_pk_fma_f32 v[24:25], v[42:43], v[42:43], v[24:25]
    v_pk_add_f32 v[26:27], v[26:27], v[42:43]
    v_pk_fma_f32 v[24:25], v[60:61], v[60:61], v[24:25]
    v_pk_add_f32 v[26:27], v[26:27], v[60:61]
    v_pk_fma_f32 v[24:25], v[62:63], v[62:63], v[24:25]
    v_pk_add_f32 v[26:27], v[26:27], v[62:63]
    s_waitcnt lgkmcnt(3)
    v_pk_fma_f32 v[44:45], v[44:45], s[14:15], v[236:237] op_sel_hi:[1,0,1]
    v_pk_fma_f32 v[46:47], v[46:47], s[14:15], v[238:239] op_sel_hi:[1,0,1]
    v_pk_fma_f32 v[64:65], v[64:65], s[14:15], v[236:237] op_sel_hi:[1,0,1]
    s_waitcnt lgkmcnt(0)
    s_barrier
    ds_read_b128 v[108:111], v10 offset:4096
    ds_read_b128 v[112:115], v10 offset:9216
    ds_read_b128 v[116:119], v11 offset:4096
    ds_read_b128 v[120:123], v11 offset:9216
    v_pk_fma_f32 v[66:67], v[66:67], s[14:15], v[238:239] op_sel_hi:[1,0,1]
    v_pk_fma_f32 v[44:45], v[92:93], s[16:17], v[44:45] op_sel_hi:[1,0,1]
    v_pk_fma_f32 v[46:47], v[94:95], s[16:17], v[46:47] op_sel_hi:[1,0,1]
    v_pk_fma_f32 v[64:65], v[96:97], s[16:17], v[64:65] op_sel_hi:[1,0,1]
    v_pk_fma_f32 v[66:67], v[98:99], s[16:17], v[66:67] op_sel_hi:[1,0,1]
    v_pk_fma_f32 v[44:45], v[100:101], s[18:19], v[44:45] op_sel_hi:[1,0,1]
    v_pk_fma_f32 v[46:47], v[102:103], s[18:19], v[46:47] op_sel_hi:[1,0,1]
    v_pk_fma_f32 v[64:65], v[104:105], s[18:19], v[64:65] op_sel_hi:[1,0,1]
    v_pk_fma_f32 v[66:67], v[106:107], s[18:19], v[66:67] op_sel_hi:[1,0,1]
    v_pk_fma_f32 v[24:25], v[44:45], v[44:45], v[24:25]
    v_pk_add_f32 v[26:27], v[26:27], v[44:45]
    v_pk_fma_f32 v[24:25], v[46:47], v[46:47], v[24:25]
    v_pk_add_f32 v[26:27], v[26:27], v[46:47]
    v_pk_fma_f32 v[24:25], v[64:65], v[64:65], v[24:25]
    v_pk_add_f32 v[26:27], v[26:27], v[64:65]
    v_pk_fma_f32 v[24:25], v[66:67], v[66:67], v[24:25]
    v_pk_add_f32 v[26:27], v[26:27], v[66:67]
    s_waitcnt lgkmcnt(0)
    v_pk_fma_f32 v[48:49], v[48:49], s[14:15], v[240:241] op_sel_hi:[1,0,1]
    v_pk_fma_f32 v[50:51], v[50:51], s[14:15], v[242:243] op_sel_hi:[1,0,1]
    v_pk_fma_f32 v[68:69], v[68:69], s[14:15], v[240:241] op_sel_hi:[1,0,1]
    v_pk_fma_f32 v[70:71], v[70:71], s[14:15], v[242:243] op_sel_hi:[1,0,1]
    v_pk_fma_f32 v[48:49], v[108:109], s[16:17], v[48:49] op_sel_hi:[1,0,1]
    v_pk_fma_f32 v[50:51], v[110:111], s[16:17], v[50:51] op_sel_hi:[1,0,1]
    v_pk_fma_f32 v[68:69], v[112:113], s[16:17], v[68:69] op_sel_hi:[1,0,1]
    v_pk_fma_f32 v[70:71], v[114:115], s[16:17], v[70:71] op_sel_hi:[1,0,1]
    v_pk_fma_f32 v[48:49], v[116:117], s[18:19], v[48:49] op_sel_hi:[1,0,1]
    v_pk_fma_f32 v[50:51], v[118:119], s[18:19], v[50:51] op_sel_hi:[1,0,1]
    v_pk_fma_f32 v[68:69], v[120:121], s[18:19], v[68:69] op_sel_hi:[1,0,1]
    v_pk_fma_f32 v[70:71], v[122:123], s[18:19], v[70:71] op_sel_hi:[1,0,1]
    v_pk_fma_f32 v[24:25], v[48:49], v[48:49], v[24:25]
    v_pk_add_f32 v[26:27], v[26:27], v[48:49]
    v_pk_fma_f32 v[24:25], v[50:51], v[50:51], v[24:25]
    v_pk_add_f32 v[26:27], v[26:27], v[50:51]
    v_pk_fma_f32 v[24:25], v[68:69], v[68:69], v[24:25]
    v_pk_add_f32 v[26:27], v[26:27], v[68:69]
    v_pk_fma_f32 v[24:25], v[70:71], v[70:71], v[24:25]
    v_pk_add_f32 v[26:27], v[26:27], v[70:71]
    v_add_f32 v21, v24, v25
    v_add_f32 v20, v26, v27
    s_nop 0
    s_lshl_b32 s70, s3, 3
    v_add_f32_dpp v20, v20, v20 row_shr:1 row_mask:0xf bank_mask:0xf bound_ctrl:0
    v_add_f32_dpp v21, v21, v21 row_shr:1 row_mask:0xf bank_mask:0xf bound_ctrl:0
    s_add_u32 s70, s70, 115264
    v_add_f32_dpp v20, v20, v20 row_shr:2 row_mask:0xf bank_mask:0xf bound_ctrl:0
    v_add_f32_dpp v21, v21, v21 row_shr:2 row_mask:0xf bank_mask:0xf bound_ctrl:0
    v_mov_b32 v29, s70
    v_add_f32_dpp v20, v20, v20 row_shr:4 row_mask:0xf bank_mask:0xf bound_ctrl:0
    v_add_f32_dpp v21, v21, v21 row_shr:4 row_mask:0xf bank_mask:0xf bound_ctrl:0
    s_lshl_b32 s70, s49, 4
    v_add_f32_dpp v20, v20, v20 row_shr:8 row_mask:0xf bank_mask:0xf bound_ctrl:0
    v_add_f32_dpp v21, v21, v21 row_shr:8 row_mask:0xf bank_mask:0xf bound_ctrl:0
    s_add_u32 s70, s70, s69
    v_add_f32_dpp v20, v20, v20 row_bcast:15 row_mask:0xa bank_mask:0xf
    v_add_f32_dpp v21, v21, v21 row_bcast:15 row_mask:0xa bank_mask:0xf
    s_nop 0
    v_add_f32_dpp v20, v20, v20 row_bcast:31 row_mask:0xc bank_mask:0xf
    v_add_f32_dpp v21, v21, v21 row_bcast:31 row_mask:0xc bank_mask:0xf
    s_mov_b32 exec_lo, 0
    s_mov_b32 exec_hi, 0x80000000
    ds_write_b64 v29, v[20:21]
    s_mov_b64 exec, -1
    s_cmp_lg_u32 s3, 0
    s_waitcnt lgkmcnt(0)
    s_barrier
    s_cbranch_scc1 L_nopub1
    ds_read_b128 v[24:27], v29 offset:16
    ds_read_b128 v[28:31], v29
    s_add_u32 s70, s70, 65536
    s_mov_b64 exec, 1
    s_waitcnt lgkmcnt(0)
    v_pk_add_f32 v[24:25], v[24:25], v[26:27]
    v_pk_add_f32 v[28:29], v[28:29], v[30:31]
    v_pk_add_f32 v[20:21], v[24:25], v[28:29]
    buffer_store_dwordx4 v[20:23], v2, s[36:39], s70 offen sc1
    s_mov_b64 exec, -1
L_nopub1:
    s_add_u32 s55, s24, 153600
    buffer_load_dwordx4 a[88:91], v2, s[36:39], s55 offen offset:0
    buffer_load_dwordx4 a[92:95], v2, s[36:39], s55 offen offset:1024
    buffer_load_dwordx4 a[96:99], v2, s[36:39], s55 offen offset:2048
    buffer_load_dwordx4 a[100:103], v2, s[36:39], s55 offen offset:3072
    s_add_u32 s55, s24, 157696
    buffer_load_dwordx4 a[104:107], v2, s[36:39], s55 offen offset:0
    buffer_load_dwordx4 a[108:111], v2, s[36:39], s55 offen offset:1024
    s_add_u32 s61, s61, 0x10000
    s_add_u32 s62, s62, 0x10000
    s_add_u32 s40, s40, 0x500000
    s_addc_u32 s41, s41, 0
    s_add_u32 s20, s20, 0x500000
    s_addc_u32 s21, s21, 0
    s_add_u32 s44, s44, 0x500000
    s_addc_u32 s45, s45, 0
    ds_read_b128 v[156:159], v15 offset:640
    ds_read_b128 v[160:163], v15 offset:704
    ds_read_b128 v[164:167], v15 offset:768
    ds_read_b128 v[168:171], v15 offset:832
    ds_read_b128 v[172:175], v15 offset:896
    ds_read_b128 v[176:179], v15 offset:960
    ds_read_b128 v[180:183], v15 offset:1024
    ds_read_b128 v[184:187], v15 offset:1088
    ds_read_b128 v[188:191], v15 offset:1152
    ds_read_b128 v[192:195], v15 offset:1216
    v_permlane16_swap_b32 v72, v74
    v_permlane16_swap_b32 v73, v75
    v_permlane16_swap_b32 v76, v78
    v_permlane16_swap_b32 v77, v79
    v_permlane16_swap_b32 v80, v82
    v_permlane16_swap_b32 v81, v83
    v_permlane16_swap_b32 v84, v86
    v_permlane16_swap_b32 v85, v87
    v_permlane16_swap_b32 v88, v90
    v_permlane16_swap_b32 v89, v91
    v_lshlrev_b32 v204, 16, v72
    v_and_b32 v205, 0xffff0000, v72
    v_lshlrev_b32 v206, 16, v73
    v_and_b32 v207, 0xffff0000, v73
    v_lshlrev_b32 v224, 16, v74
    v_and_b32 v225, 0xffff0000, v74
    v_lshlrev_b32 v226, 16, v75
    v_and_b32 v227, 0xffff0000, v75
    v_lshlrev_b32 v208, 16, v76
    v_and_b32 v209, 0xffff0000, v76
    v_lshlrev_b32 v210, 16, v77
    v_and_b32 v211, 0xffff0000, v77
    v_lshlrev_b32 v228, 16, v78
    v_and_b32 v229, 0xffff0000, v78
    v_lshlrev_b32 v230, 16, v79
    v_and_b32 v231, 0xffff0000, v79
    v_lshlrev_b32 v212, 16, v80
    v_and_b32 v213, 0xffff0000, v80
    v_lshlrev_b32 v214, 16, v81
    v_and_b32 v215, 0xffff0000, v81
    v_lshlrev_b32 v232, 16, v82
    v_and_b32 v233, 0xffff0000, v82
    v_lshlrev_b32 v234, 16, v83
    v_and_b32 v235, 0xffff0000, v83
    v_lshlrev_b32 v216, 16, v84
    v_and_b32 v217, 0xffff0000, v84
    v_lshlrev_b32 v218, 16, v85
    v_and_b32 v219, 0xffff0000, v85
    v_lshlrev_b32 v236, 16, v86
    v_and_b32 v237, 0xffff0000, v86
    v_lshlrev_b32 v238, 16, v87
    v_and_b32 v239, 0xffff0000, v87
    v_lshlrev_b32 v220, 16, v88
    v_and_b32 v221, 0xffff0000, v88
    v_lshlrev_b32 v222, 16, v89
    v_and_b32 v223, 0xffff0000, v89
    v_lshlrev_b32 v240, 16, v90
    v_and_b32 v241, 0xffff0000, v90
    v_lshlrev_b32 v242, 16, v91
    v_and_b32 v243, 0xffff0000, v91
    s_waitcnt lgkmcnt(5)
    v_pk_mul_f32 v[32:33], v[32:33], v[156:157]
    v_pk_mul_f32 v[34:35], v[34:35], v[158:159]
    v_pk_mul_f32 v[36:37], v[36:37], v[160:161]
    v_pk_mul_f32 v[38:39], v[38:39], v[162:163]
    v_pk_mul_f32 v[40:41], v[40:41], v[164:165]
    v_pk_mul_f32 v[42:43], v[42:43], v[166:167]
    v_pk_mul_f32 v[44:45], v[44:45], v[168:169]
    v_pk_mul_f32 v[46:47], v[46:47], v[170:171]
    v_pk_mul_f32 v[48:49], v[48:49], v[172:173]
    v_pk_mul_f32 v[50:51], v[50:51], v[174:175]
    v_pk_mul_f32 v[52:53], v[52:53], v[156:157]
    v_pk_mul_f32 v[54:55], v[54:55], v[158:159]
    v_pk_mul_f32 v[56:57], v[56:57], v[160:161]
    v_pk_mul_f32 v[58:59], v[58:59], v[162:163]
    v_pk_mul_f32 v[60:61], v[60:61], v[164:165]
    v_pk_mul_f32 v[62:63], v[62:63], v[166:167]
    v_pk_mul_f32 v[64:65], v[64:65], v[168:169]
    v_pk_mul_f32 v[66:67], v[66:67], v[170:171]
    v_pk_mul_f32 v[68:69], v[68:69], v[172:173]
    v_pk_mul_f32 v[70:71], v[70:71], v[174:175]
    s_cmp_lg_u32 s3, 0
    s_cbranch_scc1 L_nohop3
    s_mov_b64 exec, 0
    s_branch L_chain3
L_back3:
    s_mov_b64 exec, -1
L_nohop3:
    s_cmp_lg_u32 s3, 2
    s_cbranch_scc1 L_nohop4
    s_mov_b64 exec, 0
    s_branch L_chain4
L_back4:
    s_mov_b64 exec, -1
L_nohop4:
    s_cmp_lg_u32 s3, 3
    s_cbranch_scc1 L_noepoch
    s_cmp_lg_u32 s2, 0
    s_cbranch_scc1 L_noepoch
    v_lshlrev_b32 v24, 6, v1
    s_mov_b32 s70, 262400
    s_mov_b32 s71, 266496
    s_mov_b32 s72, 271104
    s_mov_b32 s73, 275200
    s_mov_b32 s76, 0
L_pepoch:
    buffer_load_dwordx2 v[92:93], v24, s[36:39], s70 offen sc1
    buffer_load_dwordx2 v[94:95], v24, s[36:39], s71 offen sc1
    buffer_load_dwordx2 v[96:97], v24, s[36:39], s72 offen sc1
    buffer_load_dwordx2 v[98:99], v24, s[36:39], s73 offen sc1
    s_add_u32 s76, s76, 1
    s_cmp_gt_u32 s76, 0x20000
    s_cbranch_scc1 L_pepoch_out
    s_waitcnt vmcnt(0)
    v_cmp_ne_u64 vcc, s[52:53], v[92:93]
    v_cmp_ne_u64 s[74:75], s[52:53], v[94:95]
    s_or_b64 vcc, vcc, s[74:75]
    v_cmp_ne_u64 s[74:75], s[52:53], v[96:97]
    s_or_b64 vcc, vcc, s[74:75]
    v_cmp_ne_u64 s[74:75], s[52:53], v[98:99]
    s_or_b64 vcc, vcc, s[74:75]
    s_cbranch_vccnz L_pepoch
L_pepoch_out:
    s_waitcnt vmcnt(0)
    s_mov_b64 exec, 1
    buffer_store_dwordx2 v[22:23], v2, s[36:39], 0 offen sc1
    s_mov_b64 exec, -1
L_noepoch:
    s_cmp_lg_u32 s3, 0
    s_cbranch_scc1 L_mid_nopoll
    s_add_u32 s70, s69, 0x10000
    s_mov_b32 exec_hi, 0
    buffer_load_dwordx4 v[24:27], v2, s[36:39], s70 offen sc1
    s_mov_b32 exec_hi, -1
L_mid_nopoll:
    s_barrier
    buffer_load_dwordx4 a[112:115], v2, s[36:39], s55 offen offset:2048
    buffer_load_dwordx4 a[116:119], v2, s[36:39], s55 offen offset:3072
    s_add_u32 s55, s24, 161792
    buffer_load_dwordx4 a[120:123], v2, s[36:39], s55 offen offset:0
    s_add_u32 s55, s24, 179200
    buffer_load_dwordx4 a[200:203], v2, s[36:39], s55 offen offset:0
    buffer_load_dwordx4 a[204:207], v2, s[36:39], s55 offen offset:1024
    buffer_load_dwordx4 a[208:211], v2, s[36:39], s55 offen offset:2048
    buffer_load_dwordx4 a[212:215], v2, s[36:39], s55 offen offset:3072
    s_add_u32 s55, s24, 183296
    buffer_load_dwordx4 a[216:219], v2, s[36:39], s55 offen offset:0
    s_cmp_lg_u32 s3, 0
    s_cbranch_scc1 L_mid_done
    s_add_u32 s70, s69, 65536
    s_mov_b32 s71, 0x364ccccd
    v_mov_b32 v19, 0x3727c5ac
    v_mov_b32 v18, 115296
    s_mov_b32 exec_hi, 0
    s_mov_b32 s76, 0
    s_waitcnt vmcnt(8)
    v_cmp_ne_u64 vcc, s[52:53], v[26:27]
    s_cbranch_vccz L_pstat1_hit
L_pstat1:
    buffer_load_dwordx4 v[24:27], v2, s[36:39], s70 offen sc1
    s_add_u32 s76, s76, 1
    s_cmp_gt_u32 s76, 0x20000
    s_cbranch_scc1 L_pstat1_out
    s_waitcnt vmcnt(0)
    v_cmp_ne_u64 vcc, s[52:53], v[26:27]
    s_cbranch_vccnz L_pstat1
L_pstat1_out:
    s_waitcnt vmcnt(0)
L_pstat1_hit:
    s_nop 0
    v_add_f32_dpp v24, v24, v24 row_shr:1 row_mask:0xf bank_mask:0xf bound_ctrl:0
    v_add_f32_dpp v25, v25, v25 row_shr:1 row_mask:0xf bank_mask:0xf bound_ctrl:0
    s_nop 0
    v_add_f32_dpp v24, v24, v24 row_shr:2 row_mask:0xf bank_mask:0xf bound_ctrl:0
    v_add_f32_dpp v25, v25, v25 row_shr:2 row_mask:0xf bank_mask:0xf bound_ctrl:0
    s_nop 0
    v_add_f32_dpp v24, v24, v24 row_shr:4 row_mask:0xf bank_mask:0xf bound_ctrl:0
    v_add_f32_dpp v25, v25, v25 row_shr:4 row_mask:0xf bank_mask:0xf bound_ctrl:0
    s_nop 0
    v_add_f32_dpp v24, v24, v24 row_shr:8 row_mask:0xf bank_mask:0xf bound_ctrl:0
    v_add_f32_dpp v25, v25, v25 row_shr:8 row_mask:0xf bank_mask:0xf bound_ctrl:0
    s_nop 0
    v_add_f32_dpp v24, v24, v24 row_bcast:15 row_mask:0xa bank_mask:0xf
    v_add_f32_dpp v25, v25, v25 row_bcast:15 row_mask:0xa bank_mask:0xf
    v_mul_f32 v24, s71, v24
    v_fma_f32 v25, v25, s71, v19
    v_fma_f32 v25, -v24, v24, v25
    v_max_f32 v25, v19, v25
    v_rsq_f32 v25, v25
    s_mov_b32 exec_lo, 0x80000000
    v_mul_f32 v26, s64, v25
    v_mul_f32 v27, -v24, v26
    ds_write_b64 v18, v[26:27]
    s_mov_b64 exec, -1
L_mid_done:
    v_mov_b32 v24, 115296
    s_waitcnt lgkmcnt(0)
    s_barrier
    ds_read_b64 v[18:19], v24
    s_mov_b32 s70, s63
    s_waitcnt lgkmcnt(0)
    v_pk_fma_f32 v[176:177], v[156:157], v[18:19], v[176:177] op_sel:[0,1,0] op_sel_hi:[1,1,1]
    v_pk_fma_f32 v[178:179], v[158:159], v[18:19], v[178:179] op_sel:[0,1,0] op_sel_hi:[1,1,1]
    v_pk_fma_f32 v[32:33], v[32:33], v[18:19], v[176:177] op_sel_hi:[1,0,1]
    v_pk_fma_f32 v[34:35], v[34:35], v[18:19], v[178:179] op_sel_hi:[1,0,1]
    v_pk_fma_f32 v[52:53], v[52:53], v[18:19], v[176:177] op_sel_hi:[1,0,1]
    v_pk_fma_f32 v[54:55], v[54:55], v[18:19], v[178:179] op_sel_hi:[1,0,1]
    v_exp_f32 v92, v32
    v_exp_f32 v93, v33
    v_exp_f32 v94, v34
    v_exp_f32 v95, v35
    v_exp_f32 v96, v52
    v_exp_f32 v97, v53
    v_exp_f32 v98, v54
    v_exp_f32 v99, v55
    v_pk_fma_f32 v[180:181], v[160:161], v[18:19], v[180:181] op_sel:[0,1,0] op_sel_hi:[1,1,1]
    v_pk_fma_f32 v[182:183], v[162:163], v[18:19], v[182:183] op_sel:[0,1,0] op_sel_hi:[1,1,1]
    v_pk_fma_f32 v[92:93], v[92:93], s[64:65], s[64:65] op_sel_hi:[1,0,0]
    v_pk_fma_f32 v[94:95], v[94:95], s[64:65], s[64:65] op_sel_hi:[1,0,0]
    v_pk_fma_f32 v[36:37], v[36:37], v[18:19], v[180:181] op_sel_hi:[1,0,1]
    v_pk_fma_f32 v[38:39], v[38:39], v[18:19], v[182:183] op_sel_hi:[1,0,1]
    v_pk_fma_f32 v[96:97], v[96:97], s[64:65], s[64:65] op_sel_hi:[1,0,0]
    v_pk_fma_f32 v[98:99], v[98:99], s[64:65], s[64:65] op_sel_hi:[1,0,0]
    v_rcp_f32 v92, v92
    v_rcp_f32 v93, v93
    v_rcp_f32 v94, v94
    v_rcp_f32 v95, v95
    v_pk_fma_f32 v[56:57], v[56:57], v[18:19], v[180:181] op_sel_hi:[1,0,1]
    v_pk_fma_f32 v[58:59], v[58:59], v[18:19], v[182:183] op_sel_hi:[1,0,1]
    v_rcp_f32 v96, v96
    v_rcp_f32 v97, v97
    v_rcp_f32 v98, v98
    v_rcp_f32 v99, v99
    v_exp_f32 v100, v36
    v_pk_mul_f32 v[92:93], v[32:33], v[92:93]
    v_pk_mul_f32 v[96:97], v[52:53], v[96:97]
    v_exp_f32 v101, v37
    v_pk_mul_f32 v[94:95], v[34:35], v[94:95]
    v_pk_mul_f32 v[98:99], v[54:55], v[98:99]
    v_exp_f32 v102, v38
    v_cvt_pk_bf16_f32 v108, v92, v93
    v_cvt_pk_bf16_f32 v110, v96, v97
    v_exp_f32 v103, v39
    v_cvt_pk_bf16_f32 v109, v94, v95
    v_cvt_pk_bf16_f32 v111, v98, v99
    v_exp_f32 v104, v56
    v_permlane16_swap_b32 v108, v110
    s_nop 0
    v_permlane16_swap_b32 v109, v111
    v_exp_f32 v105, v57
    buffer_store_dwordx4 v[108:111], v4, s[20:23], s70 offen sc1
    v_exp_f32 v106, v58
    ds_write_b128 v13, v[108:111] offset:0
    v_exp_f32 v107, v59
    v_pk_fma_f32 v[184:185], v[164:165], v[18:19], v[184:185] op_sel:[0,1,0] op_sel_hi:[1,1,1]
    v_pk_fma_f32 v[186:187], v[166:167], v[18:19], v[186:187] op_sel:[0,1,0] op_sel_hi:[1,1,1]
    v_pk_fma_f32 v[100:101], v[100:101], s[64:65], s[64:65] op_sel_hi:[1,0,0]
    v_pk_fma_f32 v[102:103], v[102:103], s[64:65], s[64:65] op_sel_hi:[1,0,0]
    v_pk_fma_f32 v[40:41], v[40:41], v[18:19], v[184:185] op_sel_hi:[1,0,1]
    v_pk_fma_f32 v[42:43], v[42:43], v[18:19], v[186:187] op_sel_hi:[1,0,1]
    v_pk_fma_f32 v[104:105], v[104:105], s[64:65], s[64:65] op_sel_hi:[1,0,0]
    v_pk_fma_f32 v[106:107], v[106:107], s[64:65], s[64:65] op_sel_hi:[1,0,0]
    v_rcp_f32 v100, v100
    v_rcp_f32 v101, v101
    v_rcp_f32 v102, v102
    v_rcp_f32 v103, v103
    v_pk_fma_f32 v[60:61], v[60:61], v[18:19], v[184:185] op_sel_hi:[1,0,1]
    v_pk_fma_f32 v[62:63], v[62:63], v[18:19], v[186:187] op_sel_hi:[1,0,1]
    v_rcp_f32 v104, v104
    v_rcp_f32 v105, v105
    v_rcp_f32 v106, v106
    v_rcp_f32 v107, v107
    v_exp_f32 v92, v40
    v_pk_mul_f32 v[100:101], v[36:37], v[100:101]
    v_pk_mul_f32 v[104:105], v[56:57], v[104:105]
    v_exp_f32 v93, v41
    v_pk_mul_f32 v[102:103], v[38:39], v[102:103]
    v_pk_mul_f32 v[106:107], v[58:59], v[106:107]
    v_exp_f32 v94, v42
    v_cvt_pk_bf16_f32 v112, v100, v101
    v_cvt_pk_bf16_f32 v114, v104, v105
    v_exp_f32 v95, v43
    v_cvt_pk_bf16_f32 v113, v102, v103
    v_cvt_pk_bf16_f32 v115, v106, v107
    v_exp_f32 v96, v60
    v_permlane16_swap_b32 v112, v114
    s_add_u32 s70, s70, 131072
    v_permlane16_swap_b32 v113, v115
    v_exp_f32 v97, v61
    buffer_store_dwordx4 v[112:115], v4, s[20:23], s70 offen sc1
    v_exp_f32 v98, v62
    ds_write_b128 v13, v[112:115] offset:4096
    v_exp_f32 v99, v63
    v_pk_fma_f32 v[188:189], v[168:169], v[18:19], v[188:189] op_sel:[0,1,0] op_sel_hi:[1,1,1]
    v_pk_fma_f32 v[190:191], v[170:171], v[18:19], v[190:191] op_sel:[0,1,0] op_sel_hi:[1,1,1]
    v_pk_fma_f32 v[92:93], v[92:93], s[64:65], s[64:65] op_sel_hi:[1,0,0]
    v_pk_fma_f32 v[94:95], v[94:95], s[64:65], s[64:65] op_sel_hi:[1,0,0]
    v_pk_fma_f32 v[44:45], v[44:45], v[18:19], v[188:189] op_sel_hi:[1,0,1]
    v_pk_fma_f32 v[46:47], v[46:47], v[18:19], v[190:191] op_sel_hi:[1,0,1]
    v_pk_fma_f32 v[96:97], v[96:97], s[64:65], s[64:65] op_sel_hi:[1,0,0]
    v_pk_fma_f32 v[98:99], v[98:99], s[64:65], s[64:65] op_sel_hi:[1,0,0]
    v_rcp_f32 v92, v92
    v_rcp_f32 v93, v93
    v_rcp_f32 v94, v94
    v_rcp_f32 v95, v95
    v_pk_fma_f32 v[64:65], v[64:65], v[18:19], v[188:189] op_sel_hi:[1,0,1]
    v_pk_fma_f32 v[66:67], v[66:67], v[18:19], v[190:191] op_sel_hi:[1,0,1]
    v_rcp_f32 v96, v96
    v_rcp_f32 v97, v97
    v_rcp_f32 v98, v98
    v_rcp_f32 v99, v99
    v_exp_f32 v100, v44
    v_pk_mul_f32 v[92:93], v[40:41], v[92:93]
    v_pk_mul_f32 v[96:97], v[60:61], v[96:97]
    v_exp_f32 v101, v45
    v_pk_mul_f32 v[94:95], v[42:43], v[94:95]
    v_pk_mul_f32 v[98:99], v[62:63], v[98:99]
    v_exp_f32 v102, v46
    v_cvt_pk_bf16_f32 v116, v92, v93
    v_cvt_pk_bf16_f32 v118, v96, v97
    v_exp_f32 v103, v47
    v_cvt_pk_bf16_f32 v117, v94, v95
    v_cvt_pk_bf16_f32 v119, v98, v99
    v_exp_f32 v104, v64
    v_permlane16_swap_b32 v116, v118
    s_add_u32 s70, s70, 131072
    v_permlane16_swap_b32 v117, v119
    v_exp_f32 v105, v65
    buffer_store_dwordx4 v[116:119], v4, s[20:23], s70 offen sc1
    v_exp_f32 v106, v66
    ds_write_b128 v13, v[116:119] offset:8192
    v_exp_f32 v107, v67
    v_pk_fma_f32 v[192:193], v[172:173], v[18:19], v[192:193] op_sel:[0,1,0] op_sel_hi:[1,1,1]
    v_pk_fma_f32 v[194:195], v[174:175], v[18:19], v[194:195] op_sel:[0,1,0] op_sel_hi:[1,1,1]
    v_pk_fma_f32 v[100:101], v[100:101], s[64:65], s[64:65] op_sel_hi:[1,0,0]
    v_pk_fma_f32 v[102:103], v[102:103], s[64:65], s[64:65] op_sel_hi:[1,0,0]
    v_pk_fma_f32 v[48:49], v[48:49], v[18:19], v[192:193] op_sel_hi:[1,0,1]
    v_pk_fma_f32 v[50:51], v[50:51], v[18:19], v[194:195] op_sel_hi:[1,0,1]
    v_pk_fma_f32 v[104:105], v[104:105], s[64:65], s[64:65] op_sel_hi:[1,0,0]
    v_pk_fma_f32 v[106:107], v[106:107], s[64:65], s[64:65] op_sel_hi:[1,0,0]
    v_rcp_f32 v100, v100
    v_rcp_f32 v101, v101
    v_rcp_f32 v102, v102
    v_rcp_f32 v103, v103
    v_pk_fma_f32 v[68:69], v[68:69], v[18:19], v[192:193] op_sel_hi:[1,0,1]
    v_pk_fma_f32 v[70:71], v[70:71], v[18:19], v[194:195] op_sel_hi:[1,0,1]
    v_rcp_f32 v104, v104
    v_rcp_f32 v105, v105
    v_rcp_f32 v106, v106
    v_rcp_f32 v107, v107
    v_exp_f32 v92, v48
    v_pk_mul_f32 v[100:101], v[44:45], v[100:101]
    v_pk_mul_f32 v[104:105], v[64:65], v[104:105]
    v_exp_f32 v93, v49
    v_pk_mul_f32 v[102:103], v[46:47], v[102:103]
    v_pk_mul_f32 v[106:107], v[66:67], v[106:107]
    v_exp_f32 v94, v50
    v_cvt_pk_bf16_f32 v120, v100, v101
    v_cvt_pk_bf16_f32 v122, v104, v105
    v_exp_f32 v95, v51
    v_cvt_pk_bf16_f32 v121, v102, v103
    v_cvt_pk_bf16_f32 v123, v106, v107
    v_exp_f32 v96, v68
    v_permlane16_swap_b32 v120, v122
    s_add_u32 s70, s70, 131072
    v_permlane16_swap_b32 v121, v123
    v_exp_f32 v97, v69
    buffer_store_dwordx4 v[120:123], v4, s[20:23], s70 offen sc1
    v_exp_f32 v98, v70
    ds_write_b128 v13, v[120:123] offset:12288
    v_exp_f32 v99, v71
    v_pk_fma_f32 v[92:93], v[92:93], s[64:65], s[64:65] op_sel_hi:[1,0,0]
    v_pk_fma_f32 v[94:95], v[94:95], s[64:65], s[64:65] op_sel_hi:[1,0,0]
    v_pk_fma_f32 v[96:97], v[96:97], s[64:65], s[64:65] op_sel_hi:[1,0,0]
    v_pk_fma_f32 v[98:99], v[98:99], s[64:65], s[64:65] op_sel_hi:[1,0,0]
    v_rcp_f32 v92, v92
    v_rcp_f32 v93, v93
    v_rcp_f32 v94, v94
    v_rcp_f32 v95, v95
    v_rcp_f32 v96, v96
    v_rcp_f32 v97, v97
    v_rcp_f32 v98, v98
    v_rcp_f32 v99, v99
    v_pk_mul_f32 v[92:93], v[48:49], v[92:93]
    v_pk_mul_f32 v[96:97], v[68:69], v[96:97]
    v_pk_mul_f32 v[94:95], v[50:51], v[94:95]
    v_pk_mul_f32 v[98:99], v[70:71], v[98:99]
    v_cvt_pk_bf16_f32 v124, v92, v93
    v_cvt_pk_bf16_f32 v126, v96, v97
    v_cvt_pk_bf16_f32 v125, v94, v95
    v_cvt_pk_bf16_f32 v127, v98, v99
    v_permlane16_swap_b32 v124, v126
    s_add_u32 s70, s70, 131072
    v_permlane16_swap_b32 v125, v127
    buffer_store_dwordx4 v[124:127], v4, s[20:23], s70 offen sc1
    s_waitcnt vmcnt(3) lgkmcnt(0)
    s_barrier
    buffer_store_dwordx2 v[22:23], v16, s[36:39], s61 offen offset:256 sc1
    s_waitcnt vmcnt(1)
    buffer_load_dwordx2 v[248:249], v246, s[36:39], s61 offen sc1
    s_mov_b32 s76, 0
    s_waitcnt vmcnt(0)
L_pact1:
    v_cmp_ne_u64 vcc, s[52:53], v[248:249]
    s_and_b64 vcc, vcc, s[66:67]
    s_cbranch_scc0 L_pact1_out
    s_add_u32 s76, s76, 1
    s_cmp_gt_u32 s76, 0x20000
    s_cbranch_scc1 L_pact1_out
    buffer_load_dwordx2 v[248:249], v246, s[36:39], s61 offen sc1
    s_waitcnt vmcnt(0)
    s_branch L_pact1
L_pact1_out:
    s_barrier
    buffer_load_dwordx4 v[92:95], v2, s[40:43], s4 offen offset:0
    buffer_load_dwordx4 v[104:107], v244, s[44:47], s4 offen offset:2048
    buffer_load_dwordx4 v[112:115], v2, s[20:23], s5 offen offset:2048
    buffer_load_dwordx4 v[116:119], v244, s[20:23], s5 offen offset:0
    buffer_load_dwordx4 v[108:111], v2, s[40:43], s5 offen offset:0
    buffer_load_dwordx4 v[120:123], v244, s[44:47], s5 offen offset:2048
    ds_read_b128 v[96:99], v14 offset:0
    ds_read_b128 v[100:103], v14 offset:2048
    buffer_store_dwordx2 v[22:23], v16, s[36:39], s62 offen offset:256 sc1
    s_waitcnt lgkmcnt(0)
    v_lshlrev_b32 v188, 16, v96
    v_and_b32 v189, 0xffff0000, v96
    v_lshlrev_b32 v190, 16, v97
    v_and_b32 v191, 0xffff0000, v97
    v_lshlrev_b32 v192, 16, v98
    v_and_b32 v193, 0xffff0000, v98
    v_lshlrev_b32 v194, 16, v99
    v_and_b32 v195, 0xffff0000, v99
    v_lshlrev_b32 v196, 16, v100
    v_and_b32 v197, 0xffff0000, v100
    v_lshlrev_b32 v198, 16, v101
    v_and_b32 v199, 0xffff0000, v101
    v_lshlrev_b32 v200, 16, v102
    v_and_b32 v201, 0xffff0000, v102
    v_lshlrev_b32 v202, 16, v103
    v_and_b32 v203, 0xffff0000, v103
    v_pk_add_f32 v[124:125], v[188:189], v[196:197]
    v_pk_add_f32 v[126:127], v[190:191], v[198:199]
    v_pk_add_f32 v[128:129], v[192:193], v[200:201]
    v_pk_add_f32 v[130:131], v[194:195], v[202:203]
    v_cvt_pk_bf16_f32 v144, v124, v125
    v_cvt_pk_bf16_f32 v145, v126, v127
    v_cvt_pk_bf16_f32 v146, v128, v129
L_page6:
    s_cbranch_execz L_back1
    v_cvt_pk_bf16_f32 v147, v130, v131
    ds_write_b128 v7, v[144:147] offset:4160
    v_pk_add_f32 v[124:125], v[196:197], v[188:189] neg_lo:[0,1] neg_hi:[0,1]
    v_pk_add_f32 v[126:127], v[198:199], v[190:191] neg_lo:[0,1] neg_hi:[0,1]
    v_pk_add_f32 v[128:129], v[200:201], v[192:193] neg_lo:[0,1] neg_hi:[0,1]
    v_pk_add_f32 v[130:131], v[202:203], v[194:195] neg_lo:[0,1] neg_hi:[0,1]
    v_cvt_pk_bf16_f32 v148, v124, v125
    v_cvt_pk_bf16_f32 v149, v126, v127
    v_cvt_pk_bf16_f32 v150, v128, v129
    v_cvt_pk_bf16_f32 v151, v130, v131
    ds_write_b128 v7, v[148:151] offset:8320
    s_waitcnt vmcnt(6)
    v_lshlrev_b32 v132, 16, v92
    v_and_b32 v133, 0xffff0000, v92
    v_lshlrev_b32 v134, 16, v93
    v_and_b32 v135, 0xffff0000, v93
    v_lshlrev_b32 v136, 16, v94
    v_and_b32 v137, 0xffff0000, v94
    v_lshlrev_b32 v138, 16, v95
    v_and_b32 v139, 0xffff0000, v95
    v_pk_add_f32 v[124:125], v[196:197], v[132:133] neg_lo:[0,1] neg_hi:[0,1]
    v_pk_add_f32 v[126:127], v[198:199], v[134:135] neg_lo:[0,1] neg_hi:[0,1]
    v_pk_add_f32 v[128:129], v[200:201], v[136:137] neg_lo:[0,1] neg_hi:[0,1]
    v_pk_add_f32 v[130:131], v[202:203], v[138:139] neg_lo:[0,1] neg_hi:[0,1]
    v_cvt_pk_bf16_f32 v140, v124, v125
    v_cvt_pk_bf16_f32 v141, v126, v127
    v_cvt_pk_bf16_f32 v142, v128, v129
    v_cvt_pk_bf16_f32 v143, v130, v131
    ds_write_b128 v7, v[140:143] offset:0
    s_waitcnt vmcnt(5)
    v_lshlrev_b32 v132, 16, v104
    v_and_b32 v133, 0xffff0000, v104
    v_lshlrev_b32 v134, 16, v105
    v_and_b32 v135, 0xffff0000, v105
    v_lshlrev_b32 v136, 16, v106
    v_and_b32 v137, 0xffff0000, v106
    v_lshlrev_b32 v138, 16, v107
    v_and_b32 v139, 0xffff0000, v107
    v_pk_add_f32 v[124:125], v[188:189], v[132:133] neg_lo:[0,1] neg_hi:[0,1]
    v_pk_add_f32 v[126:127], v[190:191], v[134:135] neg_lo:[0,1] neg_hi:[0,1]
    v_pk_add_f32 v[128:129], v[192:193], v[136:137] neg_lo:[0,1] neg_hi:[0,1]
    v_pk_add_f32 v[130:131], v[194:195], v[138:139] neg_lo:[0,1] neg_hi:[0,1]
    v_cvt_pk_bf16_f32 v152, v124, v125
    v_cvt_pk_bf16_f32 v153, v126, v127
    v_cvt_pk_bf16_f32 v154, v128, v129
    v_cvt_pk_bf16_f32 v155, v130, v131
    ds_write_b128 v7, v[152:155] offset:12480
    buffer_load_dwordx4 a[220:223], v2, s[36:39], s55 offen offset:1024
    buffer_load_dwordx4 a[224:227], v2, s[36:39], s55 offen offset:2048
    buffer_load_dwordx4 a[228:231], v2, s[36:39], s55 offen offset:3072
    s_add_u32 s55, s24, 187392
    buffer_load_dwordx4 a[232:235], v2, s[36:39], s55 offen offset:0
    buffer_load_dwordx4 a[236:239], v2, s[36:39], s55 offen offset:1024
    buffer_load_dwordx4 a[240:243], v2, s[36:39], s55 offen offset:2048
    buffer_load_dwordx4 v[96:99], v2, s[20:23], s6 offen offset:2048
    buffer_load_dwordx4 v[100:103], v244, s[20:23], s6 offen offset:0
    s_waitcnt lgkmcnt(0)
    s_barrier
    ds_read_b128 a[40:43], v5 offset:0
    ds_read_b128 a[56:59], v5 offset:32
    ds_read_b128 a[72:75], v5 offset:64
    ds_read_b128 a[44:47], v5 offset:512
    ds_read_b128 a[60:63], v5 offset:544
    ds_read_b128 a[76:79], v5 offset:576
    buffer_load_dwordx4 v[92:95], v2, s[40:43], s6 offen offset:0
    buffer_load_dwordx4 v[104:107], v244, s[44:47], s6 offen offset:2048
    s_waitcnt vmcnt(11)
    v_lshlrev_b32 v188, 16, v112
    v_and_b32 v189, 0xffff0000, v112
    v_lshlrev_b32 v190, 16, v113
    v_and_b32 v191, 0xffff0000, v113
    v_lshlrev_b32 v192, 16, v114
    v_and_b32 v193, 0xffff0000, v114
    v_lshlrev_b32 v194, 16, v115
    v_and_b32 v195, 0xffff0000, v115
    v_lshlrev_b32 v196, 16, v116
    v_and_b32 v197, 0xffff0000, v116
    v_lshlrev_b32 v198, 16, v117
    v_and_b32 v199, 0xffff0000, v117
    v_lshlrev_b32 v200, 16, v118
    v_and_b32 v201, 0xffff0000, v118
    v_lshlrev_b32 v202, 16, v119
    v_and_b32 v203, 0xffff0000, v119
    s_waitcnt lgkmcnt(3)
    v_mfma_f32_16x16x32_bf16 v[32:35], a[40:43], a[88:91], 0
    ds_read_b128 a[48:51], v6 offset:0
    v_add_f32 v124, v188, v196
    v_add_f32 v125, v189, v197
    v_mfma_f32_16x16x32_bf16 v[32:35], a[56:59], a[92:95], v[32:35]
    ds_read_b128 a[64:67], v6 offset:32
    v_add_f32 v126, v190, v198
    v_mfma_f32_16x16x32_bf16 v[32:35], a[72:75], a[96:99], v[32:35]
    ds_read_b128 a[80:83], v6 offset:64
    buffer_load_dwordx4 a[244:247], v2, s[36:39], s55 offen offset:3072
    s_waitcnt lgkmcnt(3)
    v_mfma_f32_16x16x32_bf16 v[52:55], a[76:79], a[96:99], 0
    ds_read_b128 a[52:55], v6 offset:512
    s_add_u32 s55, s24, 191488
    v_mfma_f32_16x16x32_bf16 v[52:55], a[60:63], a[92:95], v[52:55]
    ds_read_b128 a[68:71], v6 offset:544
    v_add_f32 v127, v191, v199
    v_add_f32 v128, v192, v200
    v_mfma_f32_16x16x32_bf16 v[52:55], a[44:47], a[88:91], v[52:55]
    ds_read_b128 a[84:87], v6 offset:576
    buffer_load_dwordx4 a[248:251], v2, s[36:39], s55 offen offset:0
    s_waitcnt lgkmcnt(3)
    v_mfma_f32_16x16x32_bf16 a[0:3], a[48:51], a[88:91], 0
    v_add_f32 v129, v193, v201
    v_add_f32 v130, v194, v202
    v_mfma_f32_16x16x32_bf16 a[0:3], a[64:67], a[92:95], a[0:3]
    v_add_f32 v131, v195, v203
    v_cvt_pk_bf16_f32 v144, v124, v125
    v_cvt_pk_bf16_f32 v145, v126, v127
    v_mfma_f32_16x16x32_bf16 a[0:3], a[80:83], a[96:99], a[0:3]
    v_cvt_pk_bf16_f32 v146, v128, v129
    s_waitcnt lgkmcnt(0)
    v_mfma_f32_16x16x32_bf16 a[20:23], a[84:87], a[96:99], 0
    buffer_load_dwordx4 a[252:255], v2, s[36:39], s55 offen offset:1024
    v_cvt_pk_bf16_f32 v147, v130, v131
    v_sub_f32 v124, v196, v188
    v_mfma_f32_16x16x32_bf16 a[20:23], a[68:71], a[92:95], a[20:23]
    ds_write_b128 v7, v[144:147] offset:20800
    v_sub_f32 v125, v197, v189
    v_sub_f32 v126, v198, v190
    v_mfma_f32_16x16x32_bf16 a[20:23], a[52:55], a[88:91], a[20:23]
    v_sub_f32 v127, v199, v191
    v_sub_f32 v128, v200, v192
    v_mfma_f32_16x16x32_bf16 v[36:39], a[40:43], a[100:103], 0
    v_sub_f32 v129, v201, v193
    v_sub_f32 v130, v202, v194
    v_sub_f32 v131, v203, v195
    v_mfma_f32_16x16x32_bf16 v[36:39], a[56:59], a[104:107], v[36:39]
    buffer_load_dwordx4 v[156:159], v2, s[36:39], s55 offen offset:2048
    v_cvt_pk_bf16_f32 v148, v124, v125
    v_cvt_pk_bf16_f32 v149, v126, v127
    v_mfma_f32_16x16x32_bf16 v[36:39], a[72:75], a[108:111], v[36:39]
    v_cvt_pk_bf16_f32 v150, v128, v129
    v_cvt_pk_bf16_f32 v151, v130, v131
    v_mfma_f32_16x16x32_bf16 v[56:59], a[76:79], a[108:111], 0
    buffer_load_dwordx2 v[248:249], v255, s[36:39], s62 offen sc1
    v_lshlrev_b32 v132, 16, v108
    v_and_b32 v133, 0xffff0000, v108
    v_mfma_f32_16x16x32_bf16 v[56:59], a[60:63], a[104:107], v[56:59]
    ds_write_b128 v7, v[148:151] offset:24960
    v_lshlrev_b32 v134, 16, v109
    v_mfma_f32_16x16x32_bf16 v[56:59], a[44:47], a[100:103], v[56:59]
    buffer_load_dwordx4 v[160:163], v2, s[36:39], s55 offen offset:3072
    s_add_u32 s55, s24, 195584
    v_and_b32 v135, 0xffff0000, v109
    v_mfma_f32_16x16x32_bf16 a[4:7], a[48:51], a[100:103], 0
    v_lshlrev_b32 v136, 16, v110
    v_and_b32 v137, 0xffff0000, v110
    v_lshlrev_b32 v138, 16, v111
    v_mfma_f32_16x16x32_bf16 a[4:7], a[64:67], a[104:107], a[4:7]
    v_and_b32 v139, 0xffff0000, v111
    v_sub_f32 v124, v196, v132
    v_mfma_f32_16x16x32_bf16 a[4:7], a[80:83], a[108:111], a[4:7]
    buffer_load_dwordx4 v[164:167], v2, s[36:39], s55 offen offset:0
    v_sub_f32 v125, v197, v133
    v_sub_f32 v126, v198, v134
    v_mfma_f32_16x16x32_bf16 a[24:27], a[84:87], a[108:111], 0
    v_sub_f32 v127, v199, v135
    v_sub_f32 v128, v200, v136
    v_sub_f32 v129, v201, v137
    v_mfma_f32_16x16x32_bf16 a[24:27], a[68:71], a[104:107], a[24:27]
    v_sub_f32 v130, v202, v138
    v_sub_f32 v131, v203, v139
    v_mfma_f32_16x16x32_bf16 a[24:27], a[52:55], a[100:103], a[24:27]
    v_cvt_pk_bf16_f32 v140, v124, v125
    v_cvt_pk_bf16_f32 v141, v126, v127
    v_cvt_pk_bf16_f32 v142, v128, v129
    v_mfma_f32_16x16x32_bf16 v[40:43], a[40:43], a[112:115], 0
    buffer_load_dwordx4 v[168:171], v2, s[36:39], s55 offen offset:1024
    v_cvt_pk_bf16_f32 v143, v130, v131
    v_mfma_f32_16x16x32_bf16 v[40:43], a[56:59], a[116:119], v[40:43]
    v_lshlrev_b32 v132, 16, v120
    v_and_b32 v133, 0xffff0000, v120
    v_lshlrev_b32 v134, 16, v121
    v_mfma_f32_16x16x32_bf16 v[40:43], a[72:75], a[120:123], v[40:43]
    ds_write_b128 v7, v[140:143] offset:16640
    v_and_b32 v135, 0xffff0000, v121
    v_lshlrev_b32 v136, 16, v122
    v_mfma_f32_16x16x32_bf16 v[60:63], a[76:79], a[120:123], 0
    v_and_b32 v137, 0xffff0000, v122
    v_lshlrev_b32 v138, 16, v123
    v_mfma_f32_16x16x32_bf16 v[60:63], a[60:63], a[116:119], v[60:63]
    buffer_load_dwordx4 v[172:175], v2, s[36:39], s55 offen offset:2048
    v_and_b32 v139, 0xffff0000, v123
    v_sub_f32 v124, v188, v132
    v_mfma_f32_16x16x32_bf16 v[60:63], a[44:47], a[112:115], v[60:63]
    v_sub_f32 v125, v189, v133
    v_sub_f32 v126, v190, v134
    v_sub_f32 v127, v191, v135
    v_mfma_f32_16x16x32_bf16 a[8:11], a[48:51], a[112:115], 0
    v_sub_f32 v128, v192, v136
    v_sub_f32 v129, v193, v137
    v_mfma_f32_16x16x32_bf16 a[8:11], a[64:67], a[116:119], a[8:11]
    v_sub_f32 v130, v194, v138
    v_sub_f32 v131, v195, v139
    v_cvt_pk_bf16_f32 v152, v124, v125
    v_mfma_f32_16x16x32_bf16 a[8:11], a[80:83], a[120:123], a[8:11]
    buffer_load_dwordx4 v[176:179], v2, s[36:39], s55 offen offset:3072
    v_cvt_pk_bf16_f32 v153, v126, v127
    v_mfma_f32_16x16x32_bf16 a[28:31], a[84:87], a[120:123], 0
    v_cvt_pk_bf16_f32 v154, v128, v129
    v_cvt_pk_bf16_f32 v155, v130, v131
    s_waitcnt vmcnt(10)
    v_mfma_f32_16x16x32_bf16 a[28:31], a[68:71], a[116:119], a[28:31]
    ds_write_b128 v7, v[152:155] offset:29120
    v_lshlrev_b32 v188, 16, v96
    v_and_b32 v189, 0xffff0000, v96
    v_mfma_f32_16x16x32_bf16 a[28:31], a[52:55], a[112:115], a[28:31]
    buffer_load_dwordx4 v[112:115], v2, s[20:23], s7 offen offset:2048
    v_lshlrev_b32 v190, 16, v97
    v_mfma_f32_16x16x32_bf16 v[44:47], a[40:43], a[136:139], 0
    v_and_b32 v191, 0xffff0000, v97
    v_lshlrev_b32 v192, 16, v98
    v_and_b32 v193, 0xffff0000, v98
    v_mfma_f32_16x16x32_bf16 v[44:47], a[56:59], a[140:143], v[44:47]
    v_lshlrev_b32 v194, 16, v99
    v_and_b32 v195, 0xffff0000, v99
    v_mfma_f32_16x16x32_bf16 v[44:47], a[72:75], a[144:147], v[44:47]
    s_waitcnt lgkmcnt(0)
    s_barrier
    ds_read_b128 a[88:91], v5 offset:16640
    v_mfma_f32_16x16x32_bf16 v[64:67], a[76:79], a[144:147], 0
    ds_read_b128 a[104:107], v5 offset:16672
    buffer_load_dwordx4 v[116:119], v244, s[20:23], s7 offen offset:0
    v_lshlrev_b32 v196, 16, v100
    v_mfma_f32_16x16x32_bf16 v[64:67], a[60:63], a[140:143], v[64:67]
    ds_read_b128 a[120:123], v5 offset:16704
    v_and_b32 v197, 0xffff0000, v100
    v_mfma_f32_16x16x32_bf16 v[64:67], a[44:47], a[136:139], v[64:67]
    ds_read_b128 a[92:95], v5 offset:17152
    v_lshlrev_b32 v198, 16, v101
    v_and_b32 v199, 0xffff0000, v101
    v_mfma_f32_16x16x32_bf16 a[12:15], a[48:51], a[136:139], 0
    ds_read_b128 a[108:111], v5 offset:17184
    v_lshlrev_b32 v200, 16, v102
    v_and_b32 v201, 0xffff0000, v102
    v_mfma_f32_16x16x32_bf16 a[12:15], a[64:67], a[140:143], a[12:15]
    ds_read_b128 a[124:127], v5 offset:17216
    buffer_load_dwordx4 v[108:111], v2, s[40:43], s7 offen offset:0
    v_mfma_f32_16x16x32_bf16 a[12:15], a[80:83], a[144:147], a[12:15]
    ds_read_b128 a[96:99], v6 offset:16640
    v_lshlrev_b32 v202, 16, v103
    v_and_b32 v203, 0xffff0000, v103
    v_mfma_f32_16x16x32_bf16 a[32:35], a[84:87], a[144:147], 0
    ds_read_b128 a[112:115], v6 offset:16672
    v_add_f32 v124, v188, v196
    v_mfma_f32_16x16x32_bf16 a[32:35], a[68:71], a[140:143], a[32:35]
    ds_read_b128 a[128:131], v6 offset:16704
    v_add_f32 v125, v189, v197
    v_add_f32 v126, v190, v198
    v_mfma_f32_16x16x32_bf16 a[32:35], a[52:55], a[136:139], a[32:35]
    ds_read_b128 a[100:103], v6 offset:17152
    buffer_load_dwordx4 v[120:123], v244, s[44:47], s7 offen offset:2048
    s_add_u32 s55, s24, 199680
    v_mfma_f32_16x16x32_bf16 v[48:51], a[40:43], a[148:151], 0
    ds_read_b128 a[116:119], v6 offset:17184
    v_add_f32 v127, v191, v199
    v_mfma_f32_16x16x32_bf16 v[48:51], a[56:59], a[152:155], v[48:51]
    ds_read_b128 a[132:135], v6 offset:17216
    v_add_f32 v128, v192, v200
    v_add_f32 v129, v193, v201
    v_mfma_f32_16x16x32_bf16 v[48:51], a[72:75], a[156:159], v[48:51]
    buffer_load_dwordx4 a[136:139], v2, s[36:39], s55 offen offset:0
    v_add_f32 v130, v194, v202
    v_add_f32 v131, v195, v203
    v_mfma_f32_16x16x32_bf16 v[68:71], a[76:79], a[156:159], 0
    v_cvt_pk_bf16_f32 v144, v124, v125
    v_cvt_pk_bf16_f32 v145, v126, v127
    v_mfma_f32_16x16x32_bf16 v[68:71], a[60:63], a[152:155], v[68:71]
    v_cvt_pk_bf16_f32 v146, v128, v129
    v_cvt_pk_bf16_f32 v147, v130, v131
    v_sub_f32 v124, v196, v188
    v_mfma_f32_16x16x32_bf16 v[68:71], a[44:47], a[148:151], v[68:71]
    ds_write_b128 v7, v[144:147] offset:4160
    v_sub_f32 v125, v197, v189
    v_mfma_f32_16x16x32_bf16 a[16:19], a[48:51], a[148:151], 0
    buffer_load_dwordx4 a[140:143], v2, s[36:39], s55 offen offset:1024
    v_sub_f32 v126, v198, v190
    v_sub_f32 v127, v199, v191
    v_mfma_f32_16x16x32_bf16 a[16:19], a[64:67], a[152:155], a[16:19]
    v_sub_f32 v128, v200, v192
    v_sub_f32 v129, v201, v193
    v_sub_f32 v130, v202, v194
    v_mfma_f32_16x16x32_bf16 a[16:19], a[80:83], a[156:159], a[16:19]
    v_sub_f32 v131, v203, v195
    v_cvt_pk_bf16_f32 v148, v124, v125
    v_mfma_f32_16x16x32_bf16 a[36:39], a[84:87], a[156:159], 0
    v_cvt_pk_bf16_f32 v149, v126, v127
    v_cvt_pk_bf16_f32 v150, v128, v129
    v_cvt_pk_bf16_f32 v151, v130, v131
    v_mfma_f32_16x16x32_bf16 a[36:39], a[68:71], a[152:155], a[36:39]
    buffer_load_dwordx4 a[144:147], v2, s[36:39], s55 offen offset:2048
    v_lshlrev_b32 v132, 16, v92
    v_mfma_f32_16x16x32_bf16 a[36:39], a[52:55], a[148:151], a[36:39]
    ds_write_b128 v7, v[148:151] offset:8320
    s_mov_b32 s58, s25
    s_waitcnt lgkmcnt(11)
    v_mfma_f32_16x16x32_bf16 v[32:35], a[88:91], a[160:163], v[32:35]
    s_mov_b32 s59, 0
    s_waitcnt vmcnt(12)
    v_cmp_ne_u64 vcc, s[52:53], v[248:249]
    v_mfma_f32_16x16x32_bf16 v[32:35], a[104:107], a[164:167], v[32:35]
    s_and_b64 vcc, vcc, s[58:59]
    s_cbranch_scc1 L_actb1_slow
L_actb1_ok:
    buffer_load_dwordx4 a[148:151], v2, s[36:39], s55 offen offset:3072
    v_mfma_f32_16x16x32_bf16 v[32:35], a[120:123], a[168:171], v[32:35]
    s_add_u32 s55, s24, 203776
    v_and_b32 v133, 0xffff0000, v92
    s_waitcnt lgkmcnt(8)
    v_mfma_f32_16x16x32_bf16 v[52:55], a[124:127], a[168:171], v[52:55]
    v_lshlrev_b32 v134, 16, v93
    v_and_b32 v135, 0xffff0000, v93
    v_lshlrev_b32 v136, 16, v94
    v_mfma_f32_16x16x32_bf16 v[52:55], a[108:111], a[164:167], v[52:55]
    v_and_b32 v137, 0xffff0000, v94
    v_lshlrev_b32 v138, 16, v95
    v_mfma_f32_16x16x32_bf16 v[52:55], a[92:95], a[160:163], v[52:55]
    buffer_load_dwordx4 a[152:155], v2, s[36:39], s55 offen offset:0
    v_and_b32 v139, 0xffff0000, v95
    s_waitcnt lgkmcnt(5)
    v_mfma_f32_16x16x32_bf16 a[0:3], a[96:99], a[160:163], a[0:3]
    v_sub_f32 v124, v196, v132
    v_sub_f32 v125, v197, v133
    v_mfma_f32_16x16x32_bf16 a[0:3], a[112:115], a[164:167], a[0:3]
    v_sub_f32 v126, v198, v134
    v_sub_f32 v127, v199, v135
    v_sub_f32 v128, v200, v136
    v_mfma_f32_16x16x32_bf16 a[0:3], a[128:131], a[168:171], a[0:3]
    v_sub_f32 v129, v201, v137
    v_sub_f32 v130, v202, v138
    s_waitcnt lgkmcnt(2)
    v_mfma_f32_16x16x32_bf16 a[20:23], a[132:135], a[168:171], a[20:23]
    buffer_load_dwordx4 a[156:159], v2, s[36:39], s55 offen offset:1024
    v_sub_f32 v131, v203, v139
    v_mfma_f32_16x16x32_bf16 a[20:23], a[116:119], a[164:167], a[20:23]
    v_cvt_pk_bf16_f32 v140, v124, v125
    v_cvt_pk_bf16_f32 v141, v126, v127
    v_cvt_pk_bf16_f32 v142, v128, v129
    v_mfma_f32_16x16x32_bf16 a[20:23], a[100:103], a[160:163], a[20:23]
    v_cvt_pk_bf16_f32 v143, v130, v131
    v_lshlrev_b32 v132, 16, v104
    v_and_b32 v133, 0xffff0000, v104
    v_mfma_f32_16x16x32_bf16 v[36:39], a[88:91], a[172:175], v[36:39]
    ds_write_b128 v7, v[140:143] offset:0
    v_lshlrev_b32 v134, 16, v105
    v_mfma_f32_16x16x32_bf16 v[36:39], a[104:107], a[176:179], v[36:39]
    buffer_load_dwordx4 a[160:163], v2, s[36:39], s55 offen offset:2048
    v_and_b32 v135, 0xffff0000, v105
    v_lshlrev_b32 v136, 16, v106
    v_mfma_f32_16x16x32_bf16 v[36:39], a[120:123], a[180:183], v[36:39]
    v_and_b32 v137, 0xffff0000, v106
    v_lshlrev_b32 v138, 16, v107
    v_mfma_f32_16x16x32_bf16 v[56:59], a[124:127], a[180:183], v[56:59]
    v_and_b32 v139, 0xffff0000, v107
    v_sub_f32 v124, v188, v132
    v_sub_f32 v125, v189, v133
    v_mfma_f32_16x16x32_bf16 v[56:59], a[108:111], a[176:179], v[56:59]
    buffer_load_dwordx4 a[164:167], v2, s[36:39], s55 offen offset:3072
    s_add_u32 s55, s24, 207872
    v_sub_f32 v126, v190, v134
    v_mfma_f32_16x16x32_bf16 v[56:59], a[92:95], a[172:175], v[56:59]
    v_sub_f32 v127, v191, v135
    v_sub_f32 v128, v192, v136
    v_mfma_f32_16x16x32_bf16 a[4:7], a[96:99], a[172:175], a[4:7]
    v_sub_f32 v129, v193, v137
    v_sub_f32 v130, v194, v138
    v_sub_f32 v131, v195, v139
    v_mfma_f32_16x16x32_bf16 a[4:7], a[112:115], a[176:179], a[4:7]
    v_cvt_pk_bf16_f32 v152, v124, v125
    v_cvt_pk_bf16_f32 v153, v126, v127
    v_cvt_pk_bf16_f32 v154, v128, v129
    v_mfma_f32_16x16x32_bf16 a[4:7], a[128:131], a[180:183], a[4:7]
    buffer_load_dwordx4 a[168:171], v2, s[36:39], s55 offen offset:0
    v_cvt_pk_bf16_f32 v155, v130, v131
    v_mfma_f32_16x16x32_bf16 a[24:27], a[132:135], a[180:183], a[24:27]
    s_waitcnt vmcnt(9)
    v_lshlrev_b32 v188, 16, v112
    v_and_b32 v189, 0xffff0000, v112
    v_mfma_f32_16x16x32_bf16 a[24:27], a[116:119], a[176:179], a[24:27]
    ds_write_b128 v7, v[152:155] offset:12480
    ds_read_b128 v[96:99], v14 offset:8192
    v_mfma_f32_16x16x32_bf16 a[24:27], a[100:103], a[172:175], a[24:27]
    ds_read_b128 v[100:103], v14 offset:10240
    v_lshlrev_b32 v190, 16, v113
    v_and_b32 v191, 0xffff0000, v113
    v_mfma_f32_16x16x32_bf16 v[40:43], a[88:91], a[184:187], v[40:43]
    buffer_load_dwordx4 v[92:95], v2, s[40:43], s8 offen offset:0
    v_lshlrev_b32 v192, 16, v114
    v_and_b32 v193, 0xffff0000, v114
    v_mfma_f32_16x16x32_bf16 v[40:43], a[104:107], a[188:191], v[40:43]
    v_lshlrev_b32 v194, 16, v115
    v_and_b32 v195, 0xffff0000, v115
    v_mfma_f32_16x16x32_bf16 v[40:43], a[120:123], a[192:195], v[40:43]
    s_waitcnt lgkmcnt(2)
    s_barrier
    ds_read_b128 a[40:43], v5 offset:0
    v_mfma_f32_16x16x32_bf16 v[60:63], a[124:127], a[192:195], v[60:63]
    ds_read_b128 a[56:59], v5 offset:32
    v_lshlrev_b32 v196, 16, v116
    v_mfma_f32_16x16x32_bf16 v[60:63], a[108:111], a[188:191], v[60:63]
    ds_read_b128 a[72:75], v5 offset:64
    buffer_load_dwordx4 v[104:107], v244, s[44:47], s8 offen offset:2048
    v_and_b32 v197, 0xffff0000, v116
    v_mfma_f32_16x16x32_bf16 v[60:63], a[92:95], a[184:187], v[60:63]
    ds_read_b128 a[44:47], v5 offset:512
    v_lshlrev_b32 v198, 16, v117
    v_and_b32 v199, 0xffff0000, v117
    v_mfma_f32_16x16x32_bf16 a[8:11], a[96:99], a[184:187], a[8:11]
    ds_read_b128 a[60:63], v5 offset:544
    v_lshlrev_b32 v200, 16, v118
    v_mfma_f32_16x16x32_bf16 a[8:11], a[112:115], a[188:191], a[8:11]
    ds_read_b128 a[76:79], v5 offset:576
    buffer_load_dwordx4 a[172:175], v2, s[36:39], s55 offen offset:1024
    v_and_b32 v201, 0xffff0000, v118
    v_mfma_f32_16x16x32_bf16 a[8:11], a[128:131], a[192:195], a[8:11]
    ds_read_b128 a[48:51], v6 offset:0
    v_lshlrev_b32 v202, 16, v119
    v_and_b32 v203, 0xffff0000, v119
    v_mfma_f32_16x16x32_bf16 a[28:31], a[132:135], a[192:195], a[28:31]
    ds_read_b128 a[64:67], v6 offset:32
    v_add_f32 v124, v188, v196
    v_mfma_f32_16x16x32_bf16 a[28:31], a[116:119], a[188:191], a[28:31]
    ds_read_b128 a[80:83], v6 offset:64
    v_add_f32 v125, v189, v197
    v_add_f32 v126, v190, v198
    v_mfma_f32_16x16x32_bf16 a[28:31], a[100:103], a[184:187], a[28:31]
    ds_read_b128 a[52:55], v6 offset:512
    buffer_load_dwordx4 a[176:179], v2, s[36:39], s55 offen offset:2048
    v_mfma_f32_16x16x32_bf16 v[44:47], a[88:91], a[196:199], v[44:47]
    ds_read_b128 a[68:71], v6 offset:544
    v_add_f32 v127, v191, v199
    v_add_f32 v128, v192, v200
    v_mfma_f32_16x16x32_bf16 v[44:47], a[104:107], a[200:203], v[44:47]
    ds_read_b128 a[84:87], v6 offset:576
    v_add_f32 v129, v193, v201
    v_add_f32 v130, v194, v202
    v_mfma_f32_16x16x32_bf16 v[44:47], a[120:123], a[204:207], v[44:47]
    v_add_f32 v131, v195, v203
    v_cvt_pk_bf16_f32 v144, v124, v125
    v_mfma_f32_16x16x32_bf16 v[64:67], a[124:127], a[204:207], v[64:67]
    buffer_load_dwordx4 a[180:183], v2, s[36:39], s55 offen offset:3072
    s_add_u32 s55, s24, 211968
    v_cvt_pk_bf16_f32 v145, v126, v127
    v_mfma_f32_16x16x32_bf16 v[64:67], a[108:111], a[200:203], v[64:67]
    v_cvt_pk_bf16_f32 v146, v128, v129
    v_cvt_pk_bf16_f32 v147, v130, v131
    v_sub_f32 v124, v196, v188
    v_mfma_f32_16x16x32_bf16 v[64:67], a[92:95], a[196:199], v[64:67]
    ds_write_b128 v7, v[144:147] offset:20800
    v_sub_f32 v125, v197, v189
    v_mfma_f32_16x16x32_bf16 a[12:15], a[96:99], a[196:199], a[12:15]
    v_sub_f32 v126, v198, v190
    v_sub_f32 v127, v199, v191
    v_sub_f32 v128, v200, v192
    v_mfma_f32_16x16x32_bf16 a[12:15], a[112:115], a[200:203], a[12:15]
    buffer_load_dwordx4 a[184:187], v2, s[36:39], s55 offen offset:0
    v_sub_f32 v129, v201, v193
    v_mfma_f32_16x16x32_bf16 a[12:15], a[128:131], a[204:207], a[12:15]
    v_sub_f32 v130, v202, v194
    v_sub_f32 v131, v203, v195
    v_cvt_pk_bf16_f32 v148, v124, v125
    v_mfma_f32_16x16x32_bf16 a[32:35], a[132:135], a[204:207], a[32:35]
    v_cvt_pk_bf16_f32 v149, v126, v127
    v_cvt_pk_bf16_f32 v150, v128, v129
    v_cvt_pk_bf16_f32 v151, v130, v131
    v_mfma_f32_16x16x32_bf16 a[32:35], a[116:119], a[200:203], a[32:35]
    buffer_load_dwordx4 a[188:191], v2, s[36:39], s55 offen offset:1024
    v_lshlrev_b32 v132, 16, v108
    v_mfma_f32_16x16x32_bf16 a[32:35], a[100:103], a[196:199], a[32:35]
    ds_write_b128 v7, v[148:151] offset:24960
    v_and_b32 v133, 0xffff0000, v108
    v_lshlrev_b32 v134, 16, v109
    v_mfma_f32_16x16x32_bf16 v[48:51], a[88:91], a[208:211], v[48:51]
    v_and_b32 v135, 0xffff0000, v109
    v_lshlrev_b32 v136, 16, v110
    v_mfma_f32_16x16x32_bf16 v[48:51], a[104:107], a[212:215], v[48:51]
    v_and_b32 v137, 0xffff0000, v110
    v_lshlrev_b32 v138, 16, v111
    v_and_b32 v139, 0xffff0000, v111
    v_mfma_f32_16x16x32_bf16 v[48:51], a[120:123], a[216:219], v[48:51]
    buffer_load_dwordx4 a[192:195], v2, s[36:39], s55 offen offset:2048
    v_sub_f32 v124, v196, v132
    v_sub_f32 v125, v197, v133
    v_mfma_f32_16x16x32_bf16 v[68:71], a[124:127], a[216:219], v[68:71]
    v_sub_f32 v126, v198, v134
    v_sub_f32 v127, v199, v135
    v_mfma_f32_16x16x32_bf16 v[68:71], a[108:111], a[212:215], v[68:71]
    v_sub_f32 v128, v200, v136
    v_sub_f32 v129, v201, v137
    v_sub_f32 v130, v202, v138
    v_mfma_f32_16x16x32_bf16 v[68:71], a[92:95], a[208:211], v[68:71]
    v_sub_f32 v131, v203, v139
    v_cvt_pk_bf16_f32 v140, v124, v125
    v_cvt_pk_bf16_f32 v141, v126, v127
    v_mfma_f32_16x16x32_bf16 a[16:19], a[96:99], a[208:211], a[16:19]
    buffer_load_dwordx4 a[196:199], v2, s[36:39], s55 offen offset:3072
    s_add_u32 s55, s24, 216064
    v_mfma_f32_16x16x32_bf16 a[16:19], a[112:115], a[212:215], a[16:19]
    v_cvt_pk_bf16_f32 v142, v128, v129
    v_cvt_pk_bf16_f32 v143, v130, v131
    v_lshlrev_b32 v132, 16, v120
    v_mfma_f32_16x16x32_bf16 a[16:19], a[128:131], a[216:219], a[16:19]
    ds_write_b128 v7, v[140:143] offset:16640
    v_and_b32 v133, 0xffff0000, v120
    v_mfma_f32_16x16x32_bf16 a[36:39], a[132:135], a[216:219], a[36:39]
    v_lshlrev_b32 v134, 16, v121
    v_and_b32 v135, 0xffff0000, v121
    v_lshlrev_b32 v136, 16, v122
    v_mfma_f32_16x16x32_bf16 a[36:39], a[116:119], a[212:215], a[36:39]
    buffer_load_dwordx4 a[200:203], v2, s[36:39], s55 offen offset:0
    v_and_b32 v137, 0xffff0000, v122
    v_lshlrev_b32 v138, 16, v123
    v_mfma_f32_16x16x32_bf16 a[36:39], a[100:103], a[208:211], a[36:39]
    v_and_b32 v139, 0xffff0000, v123
    s_waitcnt lgkmcnt(3)
    v_mfma_f32_16x16x32_bf16 v[32:35], a[40:43], a[220:223], v[32:35]
    v_sub_f32 v124, v188, v132
    v_sub_f32 v125, v189, v133
    v_mfma_f32_16x16x32_bf16 v[32:35], a[56:59], a[224:227], v[32:35]
    buffer_load_dwordx4 a[204:207], v2, s[36:39], s55 offen offset:1024
    v_sub_f32 v126, v190, v134
    v_sub_f32 v127, v191, v135
    v_mfma_f32_16x16x32_bf16 v[32:35], a[72:75], a[228:231], v[32:35]
    v_sub_f32 v128, v192, v136
    v_sub_f32 v129, v193, v137
    v_mfma_f32_16x16x32_bf16 v[52:55], a[76:79], a[228:231], v[52:55]
    v_sub_f32 v130, v194, v138
    v_sub_f32 v131, v195, v139
    v_mfma_f32_16x16x32_bf16 v[52:55], a[60:63], a[224:227], v[52:55]
    v_cvt_pk_bf16_f32 v152, v124, v125
    v_cvt_pk_bf16_f32 v153, v126, v127
    v_mfma_f32_16x16x32_bf16 v[52:55], a[44:47], a[220:223], v[52:55]
    buffer_load_dwordx4 a[208:211], v2, s[36:39], s55 offen offset:2048
    v_cvt_pk_bf16_f32 v154, v128, v129
    v_mfma_f32_16x16x32_bf16 a[0:3], a[48:51], a[220:223], a[0:3]
    v_cvt_pk_bf16_f32 v155, v130, v131
    v_lshlrev_b32 v188, 16, v96
    v_mfma_f32_16x16x32_bf16 a[0:3], a[64:67], a[224:227], a[0:3]
    ds_write_b128 v7, v[152:155] offset:29120
    v_and_b32 v189, 0xffff0000, v96
    v_mfma_f32_16x16x32_bf16 a[0:3], a[80:83], a[228:231], a[0:3]
    v_lshlrev_b32 v190, 16, v97
    v_and_b32 v191, 0xffff0000, v97
    v_mfma_f32_16x16x32_bf16 a[20:23], a[84:87], a[228:231], a[20:23]
    buffer_load_dwordx4 v[112:115], v2, s[20:23], s9 offen offset:2048
    v_lshlrev_b32 v192, 16, v98
    v_mfma_f32_16x16x32_bf16 a[20:23], a[68:71], a[224:227], a[20:23]
    v_and_b32 v193, 0xffff0000, v98
    v_lshlrev_b32 v194, 16, v99
    v_mfma_f32_16x16x32_bf16 a[20:23], a[52:55], a[220:223], a[20:23]
    s_waitcnt lgkmcnt(0)
    s_barrier
    ds_read_b128 a[88:91], v5 offset:16640
    v_mfma_f32_16x16x32_bf16 v[36:39], a[40:43], a[232:235], v[36:39]
    ds_read_b128 a[104:107], v5 offset:16672
    buffer_load_dwordx4 v[116:119], v244, s[20:23], s9 offen offset:0
    v_mfma_f32_16x16x32_bf16 v[36:39], a[56:59], a[236:239], v[36:39]
    ds_read_b128 a[120:123], v5 offset:16704
    v_and_b32 v195, 0xffff0000, v99
    v_mfma_f32_16x16x32_bf16 v[36:39], a[72:75], a[240:243], v[36:39]
    ds_read_b128 a[92:95], v5 offset:17152
    v_lshlrev_b32 v196, 16, v100
    v_mfma_f32_16x16x32_bf16 v[56:59], a[76:79], a[240:243], v[56:59]
    ds_read_b128 a[108:111], v5 offset:17184
    v_and_b32 v197, 0xffff0000, v100
    v_mfma_f32_16x16x32_bf16 v[56:59], a[60:63], a[236:239], v[56:59]
    ds_read_b128 a[124:127], v5 offset:17216
    buffer_load_dwordx4 v[108:111], v2, s[40:43], s9 offen offset:0
    v_mfma_f32_16x16x32_bf16 v[56:59], a[44:47], a[232:235], v[56:59]
    ds_read_b128 a[96:99], v6 offset:16640
    v_lshlrev_b32 v198, 16, v101
    v_mfma_f32_16x16x32_bf16 a[4:7], a[48:51], a[232:235], a[4:7]
    ds_read_b128 a[112:115], v6 offset:16672
    v_and_b32 v199, 0xffff0000, v101
    v_mfma_f32_16x16x32_bf16 a[4:7], a[64:67], a[236:239], a[4:7]
    ds_read_b128 a[128:131], v6 offset:16704
    v_lshlrev_b32 v200, 16, v102
    v_mfma_f32_16x16x32_bf16 a[4:7], a[80:83], a[240:243], a[4:7]
    ds_read_b128 a[100:103], v6 offset:17152
    buffer_load_dwordx4 v[120:123], v244, s[44:47], s9 offen offset:2048
    v_mfma_f32_16x16x32_bf16 a[24:27], a[84:87], a[240:243], a[24:27]
    ds_read_b128 a[116:119], v6 offset:17184
    v_and_b32 v201, 0xffff0000, v102
    v_lshlrev_b32 v202, 16, v103
    v_mfma_f32_16x16x32_bf16 a[24:27], a[68:71], a[236:239], a[24:27]
    ds_read_b128 a[132:135], v6 offset:17216
    v_and_b32 v203, 0xffff0000, v103
    v_mfma_f32_16x16x32_bf16 a[24:27], a[52:55], a[232:235], a[24:27]
    v_add_f32 v124, v188, v196
    v_add_f32 v125, v189, v197
    v_mfma_f32_16x16x32_bf16 v[40:43], a[40:43], a[244:247], v[40:43]
    buffer_load_dwordx4 a[212:215], v2, s[36:39], s55 offen offset:3072
    s_add_u32 s55, s24, 220160
    v_mfma_f32_16x16x32_bf16 v[40:43], a[56:59], a[248:251], v[40:43]
    v_add_f32 v126, v190, v198
    v_add_f32 v127, v191, v199
    v_mfma_f32_16x16x32_bf16 v[40:43], a[72:75], a[252:255], v[40:43]
    v_add_f32 v128, v192, v200
    v_add_f32 v129, v193, v201
    v_mfma_f32_16x16x32_bf16 v[60:63], a[76:79], a[252:255], v[60:63]
    buffer_load_dwordx4 a[216:219], v2, s[36:39], s55 offen offset:0
    v_add_f32 v130, v194, v202
    v_mfma_f32_16x16x32_bf16 v[60:63], a[60:63], a[248:251], v[60:63]
    v_add_f32 v131, v195, v203
    v_cvt_pk_bf16_f32 v144, v124, v125
    v_mfma_f32_16x16x32_bf16 v[60:63], a[44:47], a[244:247], v[60:63]
L_chain2:
L_page7:
    s_cbranch_execz L_page8
    v_cvt_pk_bf16_f32 v145, v126, v127
    v_cvt_pk_bf16_f32 v146, v128, v129
    v_mfma_f32_16x16x32_bf16 a[8:11], a[48:51], a[244:247], a[8:11]
    v_cvt_pk_bf16_f32 v147, v130, v131
    v_sub_f32 v124, v196, v188
    v_mfma_f32_16x16x32_bf16 a[8:11], a[64:67], a[248:251], a[8:11]
    ds_write_b128 v7, v[144:147] offset:4160
    buffer_load_dwordx4 a[220:223], v2, s[36:39], s55 offen offset:1024
    v_sub_f32 v125, v197, v189
    v_mfma_f32_16x16x32_bf16 a[8:11], a[80:83], a[252:255], a[8:11]
    v_sub_f32 v126, v198, v190
    v_sub_f32 v127, v199, v191
    v_mfma_f32_16x16x32_bf16 a[28:31], a[84:87], a[252:255], a[28:31]
    v_sub_f32 v128, v200, v192
    v_sub_f32 v129, v201, v193
    v_mfma_f32_16x16x32_bf16 a[28:31], a[68:71], a[248:251], a[28:31]
    v_sub_f32 v130, v202, v194
    v_sub_f32 v131, v203, v195
    v_mfma_f32_16x16x32_bf16 a[28:31], a[52:55], a[244:247], a[28:31]
    buffer_load_dwordx4 a[224:227], v2, s[36:39], s55 offen offset:2048
    v_cvt_pk_bf16_f32 v148, v124, v125
    v_mfma_f32_16x16x32_bf16 v[44:47], a[40:43], v[156:159], v[44:47]
    v_cvt_pk_bf16_f32 v149, v126, v127
    v_cvt_pk_bf16_f32 v150, v128, v129
    v_mfma_f32_16x16x32_bf16 v[44:47], a[56:59], v[160:163], v[44:47]
    v_cvt_pk_bf16_f32 v151, v130, v131
    s_waitcnt vmcnt(18)
    v_mfma_f32_16x16x32_bf16 v[44:47], a[72:75], v[164:167], v[44:47]
    ds_write_b128 v7, v[148:151] offset:8320
    v_lshlrev_b32 v132, 16, v92
    v_mfma_f32_16x16x32_bf16 v[64:67], a[76:79], v[164:167], v[64:67]
    buffer_load_dwordx4 a[228:231], v2, s[36:39], s55 offen offset:3072
    s_add_u32 s55, s24, 224256
    v_mfma_f32_16x16x32_bf16 v[64:67], a[60:63], v[160:163], v[64:67]
    v_and_b32 v133, 0xffff0000, v92
    v_lshlrev_b32 v134, 16, v93
    v_mfma_f32_16x16x32_bf16 v[64:67], a[44:47], v[156:159], v[64:67]
    v_and_b32 v135, 0xffff0000, v93
    v_lshlrev_b32 v136, 16, v94
    v_and_b32 v137, 0xffff0000, v94
    v_mfma_f32_16x16x32_bf16 a[12:15], a[48:51], v[156:159], a[12:15]
    buffer_load_dwordx4 a[232:235], v2, s[36:39], s55 offen offset:0
    v_lshlrev_b32 v138, 16, v95
    v_mfma_f32_16x16x32_bf16 a[12:15], a[64:67], v[160:163], a[12:15]
    v_and_b32 v139, 0xffff0000, v95
    v_sub_f32 v124, v196, v132
    v_mfma_f32_16x16x32_bf16 a[12:15], a[80:83], v[164:167], a[12:15]
    v_sub_f32 v125, v197, v133
    v_sub_f32 v126, v198, v134
    v_mfma_f32_16x16x32_bf16 a[32:35], a[84:87], v[164:167], a[32:35]
    v_sub_f32 v127, v199, v135
    v_sub_f32 v128, v200, v136
    v_mfma_f32_16x16x32_bf16 a[32:35], a[68:71], v[160:163], a[32:35]
    buffer_load_dwordx4 a[236:239], v2, s[36:39], s55 offen offset:1024
    v_sub_f32 v129, v201, v137
    v_mfma_f32_16x16x32_bf16 a[32:35], a[52:55], v[156:159], a[32:35]
    v_sub_f32 v130, v202, v138
    v_sub_f32 v131, v203, v139
    v_mfma_f32_16x16x32_bf16 v[48:51], a[40:43], v[168:171], v[48:51]
    v_cvt_pk_bf16_f32 v140, v124, v125
    v_cvt_pk_bf16_f32 v141, v126, v127
    v_mfma_f32_16x16x32_bf16 v[48:51], a[56:59], v[172:175], v[48:51]
    v_cvt_pk_bf16_f32 v142, v128, v129
    v_cvt_pk_bf16_f32 v143, v130, v131
    v_mfma_f32_16x16x32_bf16 v[48:51], a[72:75], v[176:179], v[48:51]
    buffer_load_dwordx4 a[240:243], v2, s[36:39], s55 offen offset:2048
    v_lshlrev_b32 v132, 16, v104
    v_mfma_f32_16x16x32_bf16 v[68:71], a[76:79], v[176:179], v[68:71]
    ds_write_b128 v7, v[140:143] offset:0
    v_and_b32 v133, 0xffff0000, v104
    v_lshlrev_b32 v134, 16, v105
    v_mfma_f32_16x16x32_bf16 v[68:71], a[60:63], v[172:175], v[68:71]
    v_and_b32 v135, 0xffff0000, v105
    v_lshlrev_b32 v136, 16, v106
    v_mfma_f32_16x16x32_bf16 v[68:71], a[44:47], v[168:171], v[68:71]
    v_and_b32 v137, 0xffff0000, v106
    v_lshlrev_b32 v138, 16, v107
    v_mfma_f32_16x16x32_bf16 a[16:19], a[48:51], v[168:171], a[16:19]
    buffer_load_dwordx4 a[244:247], v2, s[36:39], s55 offen offset:3072
    s_add_u32 s55, s24, 228352
    v_mfma_f32_16x16x32_bf16 a[16:19], a[64:67], v[172:175], a[16:19]
    v_and_b32 v139, 0xffff0000, v107
    v_sub_f32 v124, v188, v132
    v_mfma_f32_16x16x32_bf16 a[16:19], a[80:83], v[176:179], a[16:19]
    v_sub_f32 v125, v189, v133
    v_sub_f32 v126, v190, v134
    v_mfma_f32_16x16x32_bf16 a[36:39], a[84:87], v[176:179], a[36:39]
    buffer_load_dwordx4 a[248:251], v2, s[36:39], s55 offen offset:0
    v_sub_f32 v127, v191, v135
    v_mfma_f32_16x16x32_bf16 a[36:39], a[68:71], v[172:175], a[36:39]
    v_sub_f32 v128, v192, v136
    v_sub_f32 v129, v193, v137
    v_mfma_f32_16x16x32_bf16 a[36:39], a[52:55], v[168:171], a[36:39]
    v_sub_f32 v130, v194, v138
    s_waitcnt lgkmcnt(3)
    v_mfma_f32_16x16x32_bf16 v[32:35], a[88:91], a[136:139], v[32:35]
    v_sub_f32 v131, v195, v139
    v_cvt_pk_bf16_f32 v152, v124, v125
    v_mfma_f32_16x16x32_bf16 v[32:35], a[104:107], a[140:143], v[32:35]
    buffer_load_dwordx4 a[252:255], v2, s[36:39], s55 offen offset:1024
    v_cvt_pk_bf16_f32 v153, v126, v127
    v_cvt_pk_bf16_f32 v154, v128, v129
    v_mfma_f32_16x16x32_bf16 v[32:35], a[120:123], a[144:147], v[32:35]
    v_cvt_pk_bf16_f32 v155, v130, v131
    s_waitcnt vmcnt(11)
    v_mfma_f32_16x16x32_bf16 v[52:55], a[124:127], a[144:147], v[52:55]
    ds_write_b128 v7, v[152:155] offset:12480
    v_lshlrev_b32 v188, 16, v112
    v_mfma_f32_16x16x32_bf16 v[52:55], a[108:111], a[140:143], v[52:55]
    v_and_b32 v189, 0xffff0000, v112
    v_lshlrev_b32 v190, 16, v113
    v_mfma_f32_16x16x32_bf16 v[52:55], a[92:95], a[136:139], v[52:55]
    buffer_load_dwordx4 v[96:99], v2, s[20:23], s10 offen offset:2048
    v_and_b32 v191, 0xffff0000, v113
    v_mfma_f32_16x16x32_bf16 a[0:3], a[96:99], a[136:139], a[0:3]
    v_lshlrev_b32 v192, 16, v114
    v_and_b32 v193, 0xffff0000, v114
    v_mfma_f32_16x16x32_bf16 a[0:3], a[112:115], a[140:143], a[0:3]
    s_waitcnt lgkmcnt(0)
    s_barrier
    v_mfma_f32_16x16x32_bf16 a[0:3], a[128:131], a[144:147], a[0:3]
    ds_read_b128 a[40:43], v5 offset:0
    v_lshlrev_b32 v194, 16, v115
    v_mfma_f32_16x16x32_bf16 a[20:23], a[132:135], a[144:147], a[20:23]
    ds_read_b128 a[56:59], v5 offset:32
    buffer_load_dwordx4 v[100:103], v244, s[20:23], s10 offen offset:0
    v_mfma_f32_16x16x32_bf16 a[20:23], a[116:119], a[140:143], a[20:23]
    ds_read_b128 a[72:75], v5 offset:64
    v_and_b32 v195, 0xffff0000, v115
    v_mfma_f32_16x16x32_bf16 a[20:23], a[100:103], a[136:139], a[20:23]
    ds_read_b128 a[44:47], v5 offset:512
    v_lshlrev_b32 v196, 16, v116
    v_and_b32 v197, 0xffff0000, v116
    v_mfma_f32_16x16x32_bf16 v[36:39], a[88:91], a[148:151], v[36:39]
    ds_read_b128 a[60:63], v5 offset:544
    buffer_load_dwordx4 v[92:95], v2, s[40:43], s10 offen offset:0
    v_mfma_f32_16x16x32_bf16 v[36:39], a[104:107], a[152:155], v[36:39]
    ds_read_b128 a[76:79], v5 offset:576
    v_lshlrev_b32 v198, 16, v117
    v_mfma_f32_16x16x32_bf16 v[36:39], a[120:123], a[156:159], v[36:39]
    ds_read_b128 a[48:51], v6 offset:0
    v_and_b32 v199, 0xffff0000, v117
    v_mfma_f32_16x16x32_bf16 v[56:59], a[124:127], a[156:159], v[56:59]
    ds_read_b128 a[64:67], v6 offset:32
    v_lshlrev_b32 v200, 16, v118
    v_mfma_f32_16x16x32_bf16 v[56:59], a[108:111], a[152:155], v[56:59]
    ds_read_b128 a[80:83], v6 offset:64
    buffer_load_dwordx4 v[104:107], v244, s[44:47], s10 offen offset:2048
    v_mfma_f32_16x16x32_bf16 v[56:59], a[92:95], a[148:151], v[56:59]
    ds_read_b128 a[52:55], v6 offset:512
    v_and_b32 v201, 0xffff0000, v118
    v_mfma_f32_16x16x32_bf16 a[4:7], a[96:99], a[148:151], a[4:7]
    ds_read_b128 a[68:71], v6 offset:544
    v_lshlrev_b32 v202, 16, v119
    v_mfma_f32_16x16x32_bf16 a[4:7], a[112:115], a[152:155], a[4:7]
    ds_read_b128 a[84:87], v6 offset:576
    v_and_b32 v203, 0xffff0000, v119
    v_mfma_f32_16x16x32_bf16 a[4:7], a[128:131], a[156:159], a[4:7]
    buffer_load_dwordx4 a[136:139], v2, s[36:39], s55 offen offset:2048
    v_add_f32 v124, v188, v196
    v_mfma_f32_16x16x32_bf16 a[24:27], a[132:135], a[156:159], a[24:27]
    v_add_f32 v125, v189, v197
    v_add_f32 v126, v190, v198
    v_add_f32 v127, v191, v199
    v_mfma_f32_16x16x32_bf16 a[24:27], a[116:119], a[152:155], a[24:27]
    v_add_f32 v128, v192, v200
    v_add_f32 v129, v193, v201
    v_mfma_f32_16x16x32_bf16 a[24:27], a[100:103], a[148:151], a[24:27]
    v_add_f32 v130, v194, v202
    v_add_f32 v131, v195, v203
    v_mfma_f32_16x16x32_bf16 v[40:43], a[88:91], a[160:163], v[40:43]
    buffer_load_dwordx4 a[140:143], v2, s[36:39], s55 offen offset:3072
    s_add_u32 s55, s24, 232448
    v_mfma_f32_16x16x32_bf16 v[40:43], a[104:107], a[164:167], v[40:43]
    v_cvt_pk_bf16_f32 v144, v124, v125
    v_cvt_pk_bf16_f32 v145, v126, v127
    v_mfma_f32_16x16x32_bf16 v[40:43], a[120:123], a[168:171], v[40:43]
    v_cvt_pk_bf16_f32 v146, v128, v129
    v_cvt_pk_bf16_f32 v147, v130, v131
    v_mfma_f32_16x16x32_bf16 v[60:63], a[124:127], a[168:171], v[60:63]
    buffer_load_dwordx4 a[144:147], v2, s[36:39], s55 offen offset:0
    v_sub_f32 v124, v196, v188
    v_mfma_f32_16x16x32_bf16 v[60:63], a[108:111], a[164:167], v[60:63]
    ds_write_b128 v7, v[144:147] offset:20800
    v_sub_f32 v125, v197, v189
    v_mfma_f32_16x16x32_bf16 v[60:63], a[92:95], a[160:163], v[60:63]
    v_sub_f32 v126, v198, v190
    v_sub_f32 v127, v199, v191
    v_mfma_f32_16x16x32_bf16 a[8:11], a[96:99], a[160:163], a[8:11]
    v_sub_f32 v128, v200, v192
    v_sub_f32 v129, v201, v193
    v_mfma_f32_16x16x32_bf16 a[8:11], a[112:115], a[164:167], a[8:11]
    buffer_load_dwordx4 a[148:151], v2, s[36:39], s55 offen offset:1024
    v_sub_f32 v130, v202, v194
    v_sub_f32 v131, v203, v195
    v_mfma_f32_16x16x32_bf16 a[8:11], a[128:131], a[168:171], a[8:11]
    v_cvt_pk_bf16_f32 v148, v124, v125
    v_cvt_pk_bf16_f32 v149, v126, v127
    v_mfma_f32_16x16x32_bf16 a[28:31], a[132:135], a[168:171], a[28:31]
    v_cvt_pk_bf16_f32 v150, v128, v129
    v_cvt_pk_bf16_f32 v151, v130, v131
    v_mfma_f32_16x16x32_bf16 a[28:31], a[116:119], a[164:167], a[28:31]
    v_lshlrev_b32 v132, 16, v108
    v_and_b32 v133, 0xffff0000, v108
    v_mfma_f32_16x16x32_bf16 a[28:31], a[100:103], a[160:163], a[28:31]
    ds_write_b128 v7, v[148:151] offset:24960
    buffer_load_dwordx4 a[152:155], v2, s[36:39], s55 offen offset:2048
    v_mfma_f32_16x16x32_bf16 v[44:47], a[88:91], a[172:175], v[44:47]
    v_lshlrev_b32 v134, 16, v109
    v_and_b32 v135, 0xffff0000, v109
    v_mfma_f32_16x16x32_bf16 v[44:47], a[104:107], a[176:179], v[44:47]
    v_lshlrev_b32 v136, 16, v110
    v_and_b32 v137, 0xffff0000, v110
    v_mfma_f32_16x16x32_bf16 v[44:47], a[120:123], a[180:183], v[44:47]
    buffer_load_dwordx4 a[156:159], v2, s[36:39], s55 offen offset:3072
    s_add_u32 s55, s24, 236544
    v_mfma_f32_16x16x32_bf16 v[64:67], a[124:127], a[180:183], v[64:67]
    v_lshlrev_b32 v138, 16, v111
    v_and_b32 v139, 0xffff0000, v111
    v_mfma_f32_16x16x32_bf16 v[64:67], a[108:111], a[176:179], v[64:67]
    v_sub_f32 v124, v196, v132
    v_sub_f32 v125, v197, v133
    v_mfma_f32_16x16x32_bf16 v[64:67], a[92:95], a[172:175], v[64:67]
    v_sub_f32 v126, v198, v134
    v_sub_f32 v127, v199, v135
    v_sub_f32 v128, v200, v136
    v_mfma_f32_16x16x32_bf16 a[12:15], a[96:99], a[172:175], a[12:15]
    buffer_load_dwordx4 a[160:163], v2, s[36:39], s55 offen offset:0
    v_sub_f32 v129, v201, v137
    v_mfma_f32_16x16x32_bf16 a[12:15], a[112:115], a[176:179], a[12:15]
    v_sub_f32 v130, v202, v138
    v_sub_f32 v131, v203, v139
    v_mfma_f32_16x16x32_bf16 a[12:15], a[128:131], a[180:183], a[12:15]
    v_cvt_pk_bf16_f32 v140, v124, v125
    v_cvt_pk_bf16_f32 v141, v126, v127
    v_mfma_f32_16x16x32_bf16 a[32:35], a[132:135], a[180:183], a[32:35]
    v_cvt_pk_bf16_f32 v142, v128, v129
    v_cvt_pk_bf16_f32 v143, v130, v131
    v_mfma_f32_16x16x32_bf16 a[32:35], a[116:119], a[176:179], a[32:35]
    buffer_load_dwordx4 a[164:167], v2, s[36:39], s55 offen offset:1024
    v_lshlrev_b32 v132, 16, v120
    v_mfma_f32_16x16x32_bf16 a[32:35], a[100:103], a[172:175], a[32:35]
    ds_write_b128 v7, v[140:143] offset:16640
    v_and_b32 v133, 0xffff0000, v120
    v_mfma_f32_16x16x32_bf16 v[48:51], a[88:91], a[184:187], v[48:51]
    v_lshlrev_b32 v134, 16, v121
    v_and_b32 v135, 0xffff0000, v121
    v_mfma_f32_16x16x32_bf16 v[48:51], a[104:107], a[188:191], v[48:51]
    v_lshlrev_b32 v136, 16, v122
    v_and_b32 v137, 0xffff0000, v122
    v_mfma_f32_16x16x32_bf16 v[48:51], a[120:123], a[192:195], v[48:51]
    buffer_load_dwordx4 a[168:171], v2, s[36:39], s55 offen offset:2048
    v_lshlrev_b32 v138, 16, v123
    v_mfma_f32_16x16x32_bf16 v[68:71], a[124:127], a[192:195], v[68:71]
    v_and_b32 v139, 0xffff0000, v123
    v_sub_f32 v124, v188, v132
    v_sub_f32 v125, v189, v133
    v_mfma_f32_16x16x32_bf16 v[68:71], a[108:111], a[188:191], v[68:71]
    v_sub_f32 v126, v190, v134
    v_sub_f32 v127, v191, v135
    v_mfma_f32_16x16x32_bf16 v[68:71], a[92:95], a[184:187], v[68:71]
    buffer_load_dwordx4 a[172:175], v2, s[36:39], s55 offen offset:3072
    s_add_u32 s55, s24, 240640
    v_mfma_f32_16x16x32_bf16 a[16:19], a[96:99], a[184:187], a[16:19]
    v_sub_f32 v128, v192, v136
    v_sub_f32 v129, v193, v137
    v_mfma_f32_16x16x32_bf16 a[16:19], a[112:115], a[188:191], a[16:19]
    v_sub_f32 v130, v194, v138
    v_sub_f32 v131, v195, v139
    v_mfma_f32_16x16x32_bf16 a[16:19], a[128:131], a[192:195], a[16:19]
    v_cvt_pk_bf16_f32 v152, v124, v125
    v_cvt_pk_bf16_f32 v153, v126, v127
    v_mfma_f32_16x16x32_bf16 a[36:39], a[132:135], a[192:195], a[36:39]
    buffer_load_dwordx4 a[176:179], v2, s[36:39], s55 offen offset:0
    v_cvt_pk_bf16_f32 v154, v128, v129
    v_mfma_f32_16x16x32_bf16 a[36:39], a[116:119], a[188:191], a[36:39]
    v_cvt_pk_bf16_f32 v155, v130, v131
    v_mfma_f32_16x16x32_bf16 a[36:39], a[100:103], a[184:187], a[36:39]
    ds_write_b128 v7, v[152:155] offset:29120
    s_waitcnt lgkmcnt(4)
    v_mfma_f32_16x16x32_bf16 v[32:35], a[40:43], a[196:199], v[32:35]
    s_waitcnt vmcnt(11)
    v_lshlrev_b32 v188, 16, v96
    v_mfma_f32_16x16x32_bf16 v[32:35], a[56:59], a[200:203], v[32:35]
    buffer_load_dwordx4 v[112:115], v2, s[20:23], s11 offen offset:2048
    v_and_b32 v189, 0xffff0000, v96
    v_lshlrev_b32 v190, 16, v97
    v_mfma_f32_16x16x32_bf16 v[32:35], a[72:75], a[204:207], v[32:35]
    v_and_b32 v191, 0xffff0000, v97
    v_lshlrev_b32 v192, 16, v98
    v_mfma_f32_16x16x32_bf16 v[52:55], a[76:79], a[204:207], v[52:55]
    v_and_b32 v193, 0xffff0000, v98
    v_lshlrev_b32 v194, 16, v99
    v_mfma_f32_16x16x32_bf16 v[52:55], a[60:63], a[200:203], v[52:55]
    s_waitcnt lgkmcnt(0)
    s_barrier
    v_mfma_f32_16x16x32_bf16 v[52:55], a[44:47], a[196:199], v[52:55]
    ds_read_b128 a[88:91], v5 offset:16640
    buffer_load_dwordx4 v[116:119], v244, s[20:23], s11 offen offset:0
    v_mfma_f32_16x16x32_bf16 a[0:3], a[48:51], a[196:199], a[0:3]
    ds_read_b128 a[104:107], v5 offset:16672
    v_and_b32 v195, 0xffff0000, v99
    v_mfma_f32_16x16x32_bf16 a[0:3], a[64:67], a[200:203], a[0:3]
    ds_read_b128 a[120:123], v5 offset:16704
    v_lshlrev_b32 v196, 16, v100
    v_mfma_f32_16x16x32_bf16 a[0:3], a[80:83], a[204:207], a[0:3]
    ds_read_b128 a[92:95], v5 offset:17152
    buffer_load_dwordx4 v[108:111], v2, s[40:43], s11 offen offset:0
    v_mfma_f32_16x16x32_bf16 a[20:23], a[84:87], a[204:207], a[20:23]
    ds_read_b128 a[108:111], v5 offset:17184
    v_and_b32 v197, 0xffff0000, v100
    v_mfma_f32_16x16x32_bf16 a[20:23], a[68:71], a[200:203], a[20:23]
    ds_read_b128 a[124:127], v5 offset:17216
    v_lshlrev_b32 v198, 16, v101
    v_mfma_f32_16x16x32_bf16 a[20:23], a[52:55], a[196:199], a[20:23]
    ds_read_b128 a[96:99], v6 offset:16640
    v_and_b32 v199, 0xffff0000, v101
    v_lshlrev_b32 v200, 16, v102
    v_mfma_f32_16x16x32_bf16 v[36:39], a[40:43], a[208:211], v[36:39]
    ds_read_b128 a[112:115], v6 offset:16672
    buffer_load_dwordx4 v[120:123], v244, s[44:47], s11 offen offset:2048
    v_mfma_f32_16x16x32_bf16 v[36:39], a[56:59], a[212:215], v[36:39]
    ds_read_b128 a[128:131], v6 offset:16704
    v_and_b32 v201, 0xffff0000, v102
    v_mfma_f32_16x16x32_bf16 v[36:39], a[72:75], a[216:219], v[36:39]
    ds_read_b128 a[100:103], v6 offset:17152
    v_lshlrev_b32 v202, 16, v103
    v_mfma_f32_16x16x32_bf16 v[56:59], a[76:79], a[216:219], v[56:59]
    ds_read_b128 a[116:119], v6 offset:17184
    v_and_b32 v203, 0xffff0000, v103
    v_mfma_f32_16x16x32_bf16 v[56:59], a[60:63], a[212:215], v[56:59]
    ds_read_b128 a[132:135], v6 offset:17216
    buffer_load_dwordx4 a[180:183], v2, s[36:39], s55 offen offset:1024
    v_mfma_f32_16x16x32_bf16 v[56:59], a[44:47], a[208:211], v[56:59]
    v_add_f32 v124, v188, v196
    v_add_f32 v125, v189, v197
    v_mfma_f32_16x16x32_bf16 a[4:7], a[48:51], a[208:211], a[4:7]
    v_add_f32 v126, v190, v198
    v_add_f32 v127, v191, v199
    v_mfma_f32_16x16x32_bf16 a[4:7], a[64:67], a[212:215], a[4:7]
    v_add_f32 v128, v192, v200
    v_add_f32 v129, v193, v201
    v_mfma_f32_16x16x32_bf16 a[4:7], a[80:83], a[216:219], a[4:7]
    buffer_load_dwordx4 a[184:187], v2, s[36:39], s55 offen offset:2048
    v_add_f32 v130, v194, v202
    v_mfma_f32_16x16x32_bf16 a[24:27], a[84:87], a[216:219], a[24:27]
    v_add_f32 v131, v195, v203
    v_cvt_pk_bf16_f32 v144, v124, v125
    v_cvt_pk_bf16_f32 v145, v126, v127
    v_mfma_f32_16x16x32_bf16 a[24:27], a[68:71], a[212:215], a[24:27]
    v_cvt_pk_bf16_f32 v146, v128, v129
    v_cvt_pk_bf16_f32 v147, v130, v131
    v_mfma_f32_16x16x32_bf16 a[24:27], a[52:55], a[208:211], a[24:27]
    buffer_load_dwordx4 a[188:191], v2, s[36:39], s55 offen offset:3072
    s_add_u32 s55, s24, 244736
    v_mfma_f32_16x16x32_bf16 v[40:43], a[40:43], a[220:223], v[40:43]
    v_sub_f32 v124, v196, v188
    v_sub_f32 v125, v197, v189
    v_mfma_f32_16x16x32_bf16 v[40:43], a[56:59], a[224:227], v[40:43]
    ds_write_b128 v7, v[144:147] offset:4160
    v_sub_f32 v126, v198, v190
    v_mfma_f32_16x16x32_bf16 v[40:43], a[72:75], a[228:231], v[40:43]
    v_sub_f32 v127, v199, v191
    v_sub_f32 v128, v200, v192
    v_mfma_f32_16x16x32_bf16 v[60:63], a[76:79], a[228:231], v[60:63]
    buffer_load_dwordx4 a[192:195], v2, s[36:39], s55 offen offset:0
    v_sub_f32 v129, v201, v193
    v_mfma_f32_16x16x32_bf16 v[60:63], a[60:63], a[224:227], v[60:63]
    v_sub_f32 v130, v202, v194
    v_sub_f32 v131, v203, v195
    v_mfma_f32_16x16x32_bf16 v[60:63], a[44:47], a[220:223], v[60:63]
    v_cvt_pk_bf16_f32 v148, v124, v125
    v_cvt_pk_bf16_f32 v149, v126, v127
    v_mfma_f32_16x16x32_bf16 a[8:11], a[48:51], a[220:223], a[8:11]
    v_cvt_pk_bf16_f32 v150, v128, v129
    v_cvt_pk_bf16_f32 v151, v130, v131
    v_mfma_f32_16x16x32_bf16 a[8:11], a[64:67], a[224:227], a[8:11]
    buffer_load_dwordx4 a[196:199], v2, s[36:39], s55 offen offset:1024
    v_lshlrev_b32 v132, 16, v92
    v_and_b32 v133, 0xffff0000, v92
    v_mfma_f32_16x16x32_bf16 a[8:11], a[80:83], a[228:231], a[8:11]
    ds_write_b128 v7, v[148:151] offset:8320
    v_lshlrev_b32 v134, 16, v93
    v_mfma_f32_16x16x32_bf16 a[28:31], a[84:87], a[228:231], a[28:31]
    v_and_b32 v135, 0xffff0000, v93
    v_lshlrev_b32 v136, 16, v94
    v_mfma_f32_16x16x32_bf16 a[28:31], a[68:71], a[224:227], a[28:31]
    v_and_b32 v137, 0xffff0000, v94
    v_lshlrev_b32 v138, 16, v95
    v_mfma_f32_16x16x32_bf16 a[28:31], a[52:55], a[220:223], a[28:31]
    buffer_load_dwordx4 a[200:203], v2, s[36:39], s55 offen offset:2048
    v_and_b32 v139, 0xffff0000, v95
    v_mfma_f32_16x16x32_bf16 v[44:47], a[40:43], a[232:235], v[44:47]
    v_sub_f32 v124, v196, v132
    v_sub_f32 v125, v197, v133
    v_mfma_f32_16x16x32_bf16 v[44:47], a[56:59], a[236:239], v[44:47]
    v_sub_f32 v126, v198, v134
    v_sub_f32 v127, v199, v135
    v_mfma_f32_16x16x32_bf16 v[44:47], a[72:75], a[240:243], v[44:47]
    buffer_load_dwordx4 a[204:207], v2, s[36:39], s55 offen offset:3072
    s_add_u32 s55, s24, 248832
    v_mfma_f32_16x16x32_bf16 v[64:67], a[76:79], a[240:243], v[64:67]
    v_sub_f32 v128, v200, v136
    v_sub_f32 v129, v201, v137
    v_mfma_f32_16x16x32_bf16 v[64:67], a[60:63], a[236:239], v[64:67]
    v_sub_f32 v130, v202, v138
    v_sub_f32 v131, v203, v139
    v_mfma_f32_16x16x32_bf16 v[64:67], a[44:47], a[232:235], v[64:67]
    v_cvt_pk_bf16_f32 v140, v124, v125
    v_cvt_pk_bf16_f32 v141, v126, v127
    v_cvt_pk_bf16_f32 v142, v128, v129
    v_mfma_f32_16x16x32_bf16 a[12:15], a[48:51], a[232:235], a[12:15]
    buffer_load_dwordx4 a[208:211], v2, s[36:39], s55 offen offset:0
    v_cvt_pk_bf16_f32 v143, v130, v131
    v_mfma_f32_16x16x32_bf16 a[12:15], a[64:67], a[236:239], a[12:15]
    v_lshlrev_b32 v132, 16, v104
    v_and_b32 v133, 0xffff0000, v104
    v_mfma_f32_16x16x32_bf16 a[12:15], a[80:83], a[240:243], a[12:15]
    ds_write_b128 v7, v[140:143] offset:0
    v_lshlrev_b32 v134, 16, v105
    v_mfma_f32_16x16x32_bf16 a[32:35], a[84:87], a[240:243], a[32:35]
    v_and_b32 v135, 0xffff0000, v105
    v_lshlrev_b32 v136, 16, v106
    v_mfma_f32_16x16x32_bf16 a[32:35], a[68:71], a[236:239], a[32:35]
    buffer_load_dwordx4 a[212:215], v2, s[36:39], s55 offen offset:1024
    v_and_b32 v137, 0xffff0000, v106
    v_mfma_f32_16x16x32_bf16 a[32:35], a[52:55], a[232:235], a[32:35]
    v_lshlrev_b32 v138, 16, v107
    v_and_b32 v139, 0xffff0000, v107
    v_mfma_f32_16x16x32_bf16 v[48:51], a[40:43], a[244:247], v[48:51]
    v_sub_f32 v124, v188, v132
    v_sub_f32 v125, v189, v133
    v_mfma_f32_16x16x32_bf16 v[48:51], a[56:59], a[248:251], v[48:51]
    v_sub_f32 v126, v190, v134
    v_sub_f32 v127, v191, v135
    v_mfma_f32_16x16x32_bf16 v[48:51], a[72:75], a[252:255], v[48:51]
    buffer_load_dwordx4 a[216:219], v2, s[36:39], s55 offen offset:2048
    v_sub_f32 v128, v192, v136
    v_mfma_f32_16x16x32_bf16 v[68:71], a[76:79], a[252:255], v[68:71]
    v_sub_f32 v129, v193, v137
    v_sub_f32 v130, v194, v138
    v_sub_f32 v131, v195, v139
    v_mfma_f32_16x16x32_bf16 v[68:71], a[60:63], a[248:251], v[68:71]
    v_cvt_pk_bf16_f32 v152, v124, v125
    v_cvt_pk_bf16_f32 v153, v126, v127
    v_mfma_f32_16x16x32_bf16 v[68:71], a[44:47], a[244:247], v[68:71]
    buffer_load_dwordx4 a[220:223], v2, s[36:39], s55 offen offset:3072
    s_add_u32 s55, s24, 252928
    v_mfma_f32_16x16x32_bf16 a[16:19], a[48:51], a[244:247], a[16:19]
    v_cvt_pk_bf16_f32 v154, v128, v129
    v_cvt_pk_bf16_f32 v155, v130, v131
    v_mfma_f32_16x16x32_bf16 a[16:19], a[64:67], a[248:251], a[16:19]
    v_mfma_f32_16x16x32_bf16 a[16:19], a[80:83], a[252:255], a[16:19]
    ds_write_b128 v7, v[152:155] offset:12480
    v_mfma_f32_16x16x32_bf16 a[36:39], a[84:87], a[252:255], a[36:39]
    buffer_load_dwordx4 a[224:227], v2, s[36:39], s55 offen offset:0
    v_mfma_f32_16x16x32_bf16 a[36:39], a[68:71], a[248:251], a[36:39]
    v_mfma_f32_16x16x32_bf16 a[36:39], a[52:55], a[244:247], a[36:39]
    s_waitcnt vmcnt(24) lgkmcnt(4)
    v_mfma_f32_16x16x32_bf16 v[32:35], a[88:91], a[136:139], v[32:35]
    s_waitcnt vmcnt(12)
    v_lshlrev_b32 v188, 16, v112
    v_mfma_f32_16x16x32_bf16 v[32:35], a[104:107], a[140:143], v[32:35]
    buffer_load_dwordx4 v[96:99], v2, s[20:23], s12 offen offset:2048
    v_and_b32 v189, 0xffff0000, v112
    v_lshlrev_b32 v190, 16, v113
    v_mfma_f32_16x16x32_bf16 v[32:35], a[120:123], a[144:147], v[32:35]
    v_and_b32 v191, 0xffff0000, v113
    v_lshlrev_b32 v192, 16, v114
    v_mfma_f32_16x16x32_bf16 v[52:55], a[124:127], a[144:147], v[52:55]
    v_and_b32 v193, 0xffff0000, v114
    v_lshlrev_b32 v194, 16, v115
    v_mfma_f32_16x16x32_bf16 v[52:55], a[108:111], a[140:143], v[52:55]
    s_waitcnt lgkmcnt(0)
    s_barrier
    v_mfma_f32_16x16x32_bf16 v[52:55], a[92:95], a[136:139], v[52:55]
    ds_read_b128 a[40:43], v5 offset:0
    buffer_load_dwordx4 v[100:103], v244, s[20:23], s12 offen offset:0
    v_mfma_f32_16x16x32_bf16 a[0:3], a[96:99], a[136:139], a[0:3]
    ds_read_b128 a[56:59], v5 offset:32
    v_and_b32 v195, 0xffff0000, v115
    v_mfma_f32_16x16x32_bf16 a[0:3], a[112:115], a[140:143], a[0:3]
    ds_read_b128 a[72:75], v5 offset:64
    v_lshlrev_b32 v196, 16, v116
    v_mfma_f32_16x16x32_bf16 a[0:3], a[128:131], a[144:147], a[0:3]
    ds_read_b128 a[44:47], v5 offset:512
    buffer_load_dwordx4 v[92:95], v2, s[40:43], s12 offen offset:0
    v_mfma_f32_16x16x32_bf16 a[20:23], a[132:135], a[144:147], a[20:23]
    ds_read_b128 a[60:63], v5 offset:544
    v_and_b32 v197, 0xffff0000, v116
    v_mfma_f32_16x16x32_bf16 a[20:23], a[116:119], a[140:143], a[20:23]
    ds_read_b128 a[76:79], v5 offset:576
    v_lshlrev_b32 v198, 16, v117
    v_mfma_f32_16x16x32_bf16 a[20:23], a[100:103], a[136:139], a[20:23]
    ds_read_b128 a[48:51], v6 offset:0
    v_and_b32 v199, 0xffff0000, v117
    v_lshlrev_b32 v200, 16, v118
    v_mfma_f32_16x16x32_bf16 v[36:39], a[88:91], a[148:151], v[36:39]
    ds_read_b128 a[64:67], v6 offset:32
    buffer_load_dwordx4 v[104:107], v244, s[44:47], s12 offen offset:2048
    v_mfma_f32_16x16x32_bf16 v[36:39], a[104:107], a[152:155], v[36:39]
    ds_read_b128 a[80:83], v6 offset:64
    v_and_b32 v201, 0xffff0000, v118
    v_mfma_f32_16x16x32_bf16 v[36:39], a[120:123], a[156:159], v[36:39]
    ds_read_b128 a[52:55], v6 offset:512
    v_lshlrev_b32 v202, 16, v119
    v_mfma_f32_16x16x32_bf16 v[56:59], a[124:127], a[156:159], v[56:59]
    ds_read_b128 a[68:71], v6 offset:544
    v_and_b32 v203, 0xffff0000, v119
    v_mfma_f32_16x16x32_bf16 v[56:59], a[108:111], a[152:155], v[56:59]
    ds_read_b128 a[84:87], v6 offset:576
    global_load_dword v0, v253, s[0:1] sc1
    v_mfma_f32_16x16x32_bf16 v[56:59], a[92:95], a[148:151], v[56:59]
    v_add_f32 v124, v188, v196
    v_add_f32 v125, v189, v197
    v_mfma_f32_16x16x32_bf16 a[4:7], a[96:99], a[148:151], a[4:7]
    v_add_f32 v126, v190, v198
    v_add_f32 v127, v191, v199
    v_mfma_f32_16x16x32_bf16 a[4:7], a[112:115], a[152:155], a[4:7]
    buffer_load_dwordx4 a[228:231], v2, s[36:39], s55 offen offset:1024
    v_add_f32 v128, v192, v200
    v_mfma_f32_16x16x32_bf16 a[4:7], a[128:131], a[156:159], a[4:7]
    v_add_f32 v129, v193, v201
    v_add_f32 v130, v194, v202
    v_mfma_f32_16x16x32_bf16 a[24:27], a[132:135], a[156:159], a[24:27]
    v_add_f32 v131, v195, v203
    v_cvt_pk_bf16_f32 v144, v124, v125
    v_cvt_pk_bf16_f32 v145, v126, v127
    v_mfma_f32_16x16x32_bf16 a[24:27], a[116:119], a[152:155], a[24:27]
    v_cvt_pk_bf16_f32 v146, v128, v129
    v_cvt_pk_bf16_f32 v147, v130, v131
    v_mfma_f32_16x16x32_bf16 a[24:27], a[100:103], a[148:151], a[24:27]
    buffer_load_dwordx4 a[232:235], v2, s[36:39], s55 offen offset:2048
    v_sub_f32 v124, v196, v188
    v_mfma_f32_16x16x32_bf16 v[40:43], a[88:91], a[160:163], v[40:43]
    ds_write_b128 v7, v[144:147] offset:20800
    v_sub_f32 v125, v197, v189
    v_mfma_f32_16x16x32_bf16 v[40:43], a[104:107], a[164:167], v[40:43]
    v_sub_f32 v126, v198, v190
    v_sub_f32 v127, v199, v191
    v_mfma_f32_16x16x32_bf16 v[40:43], a[120:123], a[168:171], v[40:43]
    v_sub_f32 v128, v200, v192
    v_sub_f32 v129, v201, v193
    v_mfma_f32_16x16x32_bf16 v[60:63], a[124:127], a[168:171], v[60:63]
    buffer_load_dwordx4 a[236:239], v2, s[36:39], s55 offen offset:3072
    s_add_u32 s55, s24, 257024
    v_mfma_f32_16x16x32_bf16 v[60:63], a[108:111], a[164:167], v[60:63]
    v_sub_f32 v130, v202, v194
    v_sub_f32 v131, v203, v195
    v_mfma_f32_16x16x32_bf16 v[60:63], a[92:95], a[160:163], v[60:63]
    v_cvt_pk_bf16_f32 v148, v124, v125
    v_cvt_pk_bf16_f32 v149, v126, v127
    v_mfma_f32_16x16x32_bf16 a[8:11], a[96:99], a[160:163], a[8:11]
    v_cvt_pk_bf16_f32 v150, v128, v129
    v_cvt_pk_bf16_f32 v151, v130, v131
    v_mfma_f32_16x16x32_bf16 a[8:11], a[112:115], a[164:167], a[8:11]
    buffer_load_dwordx4 a[240:243], v2, s[36:39], s55 offen offset:0
    v_lshlrev_b32 v132, 16, v108
    v_and_b32 v133, 0xffff0000, v108
    v_mfma_f32_16x16x32_bf16 a[8:11], a[128:131], a[168:171], a[8:11]
    ds_write_b128 v7, v[148:151] offset:24960
    v_lshlrev_b32 v134, 16, v109
    v_mfma_f32_16x16x32_bf16 a[28:31], a[132:135], a[168:171], a[28:31]
    v_and_b32 v135, 0xffff0000, v109
    v_lshlrev_b32 v136, 16, v110
    v_mfma_f32_16x16x32_bf16 a[28:31], a[116:119], a[164:167], a[28:31]
    buffer_load_dwordx4 a[244:247], v2, s[36:39], s55 offen offset:1024
    v_and_b32 v137, 0xffff0000, v110
    v_mfma_f32_16x16x32_bf16 a[28:31], a[100:103], a[160:163], a[28:31]
    v_lshlrev_b32 v138, 16, v111
    s_waitcnt vmcnt(21)
    v_mfma_f32_16x16x32_bf16 v[44:47], a[88:91], a[172:175], v[44:47]
    v_and_b32 v139, 0xffff0000, v111
    v_sub_f32 v124, v196, v132
    v_mfma_f32_16x16x32_bf16 v[44:47], a[104:107], a[176:179], v[44:47]
    v_sub_f32 v125, v197, v133
    v_sub_f32 v126, v198, v134
    v_mfma_f32_16x16x32_bf16 v[44:47], a[120:123], a[180:183], v[44:47]
    buffer_load_dwordx4 a[248:251], v2, s[36:39], s55 offen offset:2048
    v_sub_f32 v127, v199, v135
    v_mfma_f32_16x16x32_bf16 v[64:67], a[124:127], a[180:183], v[64:67]
    v_sub_f32 v128, v200, v136
    v_sub_f32 v129, v201, v137
    v_mfma_f32_16x16x32_bf16 v[64:67], a[108:111], a[176:179], v[64:67]
    v_sub_f32 v130, v202, v138
    v_sub_f32 v131, v203, v139
    v_mfma_f32_16x16x32_bf16 v[64:67], a[92:95], a[172:175], v[64:67]
    v_cvt_pk_bf16_f32 v140, v124, v125
    v_cvt_pk_bf16_f32 v141, v126, v127
    v_cvt_pk_bf16_f32 v142, v128, v129
    v_mfma_f32_16x16x32_bf16 a[12:15], a[96:99], a[172:175], a[12:15]
    buffer_load_dwordx4 a[252:255], v2, s[36:39], s55 offen offset:3072
    s_add_u32 s55, s24, 261120
    v_mfma_f32_16x16x32_bf16 a[12:15], a[112:115], a[176:179], a[12:15]
    v_cvt_pk_bf16_f32 v143, v130, v131
    v_lshlrev_b32 v132, 16, v120
    v_mfma_f32_16x16x32_bf16 a[12:15], a[128:131], a[180:183], a[12:15]
    ds_write_b128 v7, v[140:143] offset:16640
    v_and_b32 v133, 0xffff0000, v120
    v_mfma_f32_16x16x32_bf16 a[32:35], a[132:135], a[180:183], a[32:35]
    v_lshlrev_b32 v134, 16, v121
L_page8:
    s_cbranch_execz L_back2
    v_and_b32 v135, 0xffff0000, v121
    v_mfma_f32_16x16x32_bf16 a[32:35], a[116:119], a[176:179], a[32:35]
    buffer_load_dwordx4 a[136:139], v2, s[36:39], s55 offen offset:0
    v_lshlrev_b32 v136, 16, v122
    v_mfma_f32_16x16x32_bf16 a[32:35], a[100:103], a[172:175], a[32:35]
    v_and_b32 v137, 0xffff0000, v122
    s_waitcnt vmcnt(21)
    v_mfma_f32_16x16x32_bf16 v[48:51], a[88:91], a[184:187], v[48:51]
    v_lshlrev_b32 v138, 16, v123
    v_and_b32 v139, 0xffff0000, v123
    v_mfma_f32_16x16x32_bf16 v[48:51], a[104:107], a[188:191], v[48:51]
    buffer_load_dwordx4 a[140:143], v2, s[36:39], s55 offen offset:1024
    v_sub_f32 v124, v188, v132
    v_mfma_f32_16x16x32_bf16 v[48:51], a[120:123], a[192:195], v[48:51]
    v_sub_f32 v125, v189, v133
    v_sub_f32 v126, v190, v134
    v_mfma_f32_16x16x32_bf16 v[68:71], a[124:127], a[192:195], v[68:71]
    v_sub_f32 v127, v191, v135
    v_sub_f32 v128, v192, v136
    v_sub_f32 v129, v193, v137
    v_mfma_f32_16x16x32_bf16 v[68:71], a[108:111], a[188:191], v[68:71]
    v_sub_f32 v130, v194, v138
    v_sub_f32 v131, v195, v139
    v_mfma_f32_16x16x32_bf16 v[68:71], a[92:95], a[184:187], v[68:71]
    buffer_load_dwordx4 a[144:147], v2, s[36:39], s55 offen offset:2048
    v_cvt_pk_bf16_f32 v152, v124, v125
    v_mfma_f32_16x16x32_bf16 a[16:19], a[96:99], a[184:187], a[16:19]
    v_cvt_pk_bf16_f32 v153, v126, v127
    v_cvt_pk_bf16_f32 v154, v128, v129
    v_mfma_f32_16x16x32_bf16 a[16:19], a[112:115], a[188:191], a[16:19]
    v_cvt_pk_bf16_f32 v155, v130, v131
    v_mfma_f32_16x16x32_bf16 a[16:19], a[128:131], a[192:195], a[16:19]
    ds_write_b128 v7, v[152:155] offset:29120
    v_mfma_f32_16x16x32_bf16 a[36:39], a[132:135], a[192:195], a[36:39]
    buffer_load_dwordx4 a[148:151], v2, s[36:39], s55 offen offset:3072
    s_add_u32 s55, s24, 265216
    v_mfma_f32_16x16x32_bf16 a[36:39], a[116:119], a[188:191], a[36:39]
    v_mfma_f32_16x16x32_bf16 a[36:39], a[100:103], a[184:187], a[36:39]
    s_waitcnt vmcnt(21) lgkmcnt(4)
    v_mfma_f32_16x16x32_bf16 v[32:35], a[40:43], a[196:199], v[32:35]
    s_waitcnt vmcnt(12)
    v_lshlrev_b32 v188, 16, v96
    v_mfma_f32_16x16x32_bf16 v[32:35], a[56:59], a[200:203], v[32:35]
    buffer_load_dwordx4 v[112:115], v2, s[20:23], s13 offen offset:2048
    v_and_b32 v189, 0xffff0000, v96
    v_lshlrev_b32 v190, 16, v97
    v_mfma_f32_16x16x32_bf16 v[32:35], a[72:75], a[204:207], v[32:35]
    v_and_b32 v191, 0xffff0000, v97
    v_lshlrev_b32 v192, 16, v98
    v_mfma_f32_16x16x32_bf16 v[52:55], a[76:79], a[204:207], v[52:55]
    v_and_b32 v193, 0xffff0000, v98
    v_lshlrev_b32 v194, 16, v99
    v_mfma_f32_16x16x32_bf16 v[52:55], a[60:63], a[200:203], v[52:55]
    s_waitcnt lgkmcnt(0)
    s_barrier
    v_mfma_f32_16x16x32_bf16 v[52:55], a[44:47], a[196:199], v[52:55]
    ds_read_b128 a[88:91], v5 offset:16640
    buffer_load_dwordx4 v[116:119], v244, s[20:23], s13 offen offset:0
    v_mfma_f32_16x16x32_bf16 a[0:3], a[48:51], a[196:199], a[0:3]
    ds_read_b128 a[104:107], v5 offset:16672
    v_and_b32 v195, 0xffff0000, v99
    v_mfma_f32_16x16x32_bf16 a[0:3], a[64:67], a[200:203], a[0:3]
    ds_read_b128 a[120:123], v5 offset:16704
    v_lshlrev_b32 v196, 16, v100
    v_mfma_f32_16x16x32_bf16 a[0:3], a[80:83], a[204:207], a[0:3]
    ds_read_b128 a[92:95], v5 offset:17152
    buffer_load_dwordx4 v[108:111], v2, s[40:43], s13 offen offset:0
    v_mfma_f32_16x16x32_bf16 a[20:23], a[84:87], a[204:207], a[20:23]
    ds_read_b128 a[108:111], v5 offset:17184
    v_and_b32 v197, 0xffff0000, v100
    v_mfma_f32_16x16x32_bf16 a[20:23], a[68:71], a[200:203], a[20:23]
    ds_read_b128 a[124:127], v5 offset:17216
    v_lshlrev_b32 v198, 16, v101
    v_mfma_f32_16x16x32_bf16 a[20:23], a[52:55], a[196:199], a[20:23]
    ds_read_b128 a[96:99], v6 offset:16640
    v_and_b32 v199, 0xffff0000, v101
    v_lshlrev_b32 v200, 16, v102
    v_mfma_f32_16x16x32_bf16 v[36:39], a[40:43], a[208:211], v[36:39]
    ds_read_b128 a[112:115], v6 offset:16672
    buffer_load_dwordx4 v[120:123], v244, s[44:47], s13 offen offset:2048
    v_mfma_f32_16x16x32_bf16 v[36:39], a[56:59], a[212:215], v[36:39]
    ds_read_b128 a[128:131], v6 offset:16704
    v_and_b32 v201, 0xffff0000, v102
    v_mfma_f32_16x16x32_bf16 v[36:39], a[72:75], a[216:219], v[36:39]
    ds_read_b128 a[100:103], v6 offset:17152
    v_lshlrev_b32 v202, 16, v103
    v_mfma_f32_16x16x32_bf16 v[56:59], a[76:79], a[216:219], v[56:59]
    ds_read_b128 a[116:119], v6 offset:17184
    v_and_b32 v203, 0xffff0000, v103
    v_mfma_f32_16x16x32_bf16 v[56:59], a[60:63], a[212:215], v[56:59]
    ds_read_b128 a[132:135], v6 offset:17216
    buffer_load_dwordx4 a[152:155], v2, s[36:39], s55 offen offset:0
    v_mfma_f32_16x16x32_bf16 v[56:59], a[44:47], a[208:211], v[56:59]
    v_add_f32 v124, v188, v196
    v_add_f32 v125, v189, v197
    v_mfma_f32_16x16x32_bf16 a[4:7], a[48:51], a[208:211], a[4:7]
    v_add_f32 v126, v190, v198
    v_add_f32 v127, v191, v199
    v_mfma_f32_16x16x32_bf16 a[4:7], a[64:67], a[212:215], a[4:7]
    buffer_load_dwordx4 a[156:159], v2, s[36:39], s55 offen offset:1024
    v_add_f32 v128, v192, v200
    v_mfma_f32_16x16x32_bf16 a[4:7], a[80:83], a[216:219], a[4:7]
    v_add_f32 v129, v193, v201
    v_add_f32 v130, v194, v202
    v_mfma_f32_16x16x32_bf16 a[24:27], a[84:87], a[216:219], a[24:27]
    v_add_f32 v131, v195, v203
    v_cvt_pk_bf16_f32 v144, v124, v125
    v_cvt_pk_bf16_f32 v145, v126, v127
    v_mfma_f32_16x16x32_bf16 a[24:27], a[68:71], a[212:215], a[24:27]
    v_cvt_pk_bf16_f32 v146, v128, v129
    v_cvt_pk_bf16_f32 v147, v130, v131
    v_mfma_f32_16x16x32_bf16 a[24:27], a[52:55], a[208:211], a[24:27]
    buffer_load_dwordx4 a[160:163], v2, s[36:39], s55 offen offset:2048
    s_waitcnt vmcnt(17)
    v_mfma_f32_16x16x32_bf16 v[40:43], a[40:43], a[220:223], v[40:43]
    v_sub_f32 v124, v196, v188
    v_sub_f32 v125, v197, v189
    v_mfma_f32_16x16x32_bf16 v[40:43], a[56:59], a[224:227], v[40:43]
    ds_write_b128 v7, v[144:147] offset:4160
    v_sub_f32 v126, v198, v190
    v_mfma_f32_16x16x32_bf16 v[40:43], a[72:75], a[228:231], v[40:43]
    v_sub_f32 v127, v199, v191
    v_sub_f32 v128, v200, v192
    v_mfma_f32_16x16x32_bf16 v[60:63], a[76:79], a[228:231], v[60:63]
    buffer_load_dwordx4 a[164:167], v2, s[36:39], s55 offen offset:3072
    s_add_u32 s55, s24, 269312
    v_mfma_f32_16x16x32_bf16 v[60:63], a[60:63], a[224:227], v[60:63]
    v_sub_f32 v129, v201, v193
    v_sub_f32 v130, v202, v194
    v_mfma_f32_16x16x32_bf16 v[60:63], a[44:47], a[220:223], v[60:63]
    v_sub_f32 v131, v203, v195
    v_cvt_pk_bf16_f32 v148, v124, v125
    v_mfma_f32_16x16x32_bf16 a[8:11], a[48:51], a[220:223], a[8:11]
    v_cvt_pk_bf16_f32 v149, v126, v127
    v_cvt_pk_bf16_f32 v150, v128, v129
    v_mfma_f32_16x16x32_bf16 a[8:11], a[64:67], a[224:227], a[8:11]
    buffer_load_dwordx4 a[168:171], v2, s[36:39], s55 offen offset:0
    v_cvt_pk_bf16_f32 v151, v130, v131
    v_lshlrev_b32 v132, 16, v92
    v_mfma_f32_16x16x32_bf16 a[8:11], a[80:83], a[228:231], a[8:11]
    ds_write_b128 v7, v[148:151] offset:8320
    v_and_b32 v133, 0xffff0000, v92
    v_mfma_f32_16x16x32_bf16 a[28:31], a[84:87], a[228:231], a[28:31]
    v_lshlrev_b32 v134, 16, v93
    v_and_b32 v135, 0xffff0000, v93
    v_mfma_f32_16x16x32_bf16 a[28:31], a[68:71], a[224:227], a[28:31]
    buffer_load_dwordx4 a[172:175], v2, s[36:39], s55 offen offset:1024
    v_lshlrev_b32 v136, 16, v94
    v_mfma_f32_16x16x32_bf16 a[28:31], a[52:55], a[220:223], a[28:31]
    v_and_b32 v137, 0xffff0000, v94
    s_waitcnt vmcnt(17)
    v_mfma_f32_16x16x32_bf16 v[44:47], a[40:43], a[232:235], v[44:47]
    v_lshlrev_b32 v138, 16, v95
    v_and_b32 v139, 0xffff0000, v95
    v_mfma_f32_16x16x32_bf16 v[44:47], a[56:59], a[236:239], v[44:47]
    v_sub_f32 v124, v196, v132
    v_sub_f32 v125, v197, v133
    v_mfma_f32_16x16x32_bf16 v[44:47], a[72:75], a[240:243], v[44:47]
    buffer_load_dwordx4 a[176:179], v2, s[36:39], s55 offen offset:2048
    v_sub_f32 v126, v198, v134
    v_mfma_f32_16x16x32_bf16 v[64:67], a[76:79], a[240:243], v[64:67]
    v_sub_f32 v127, v199, v135
    v_sub_f32 v128, v200, v136
    v_mfma_f32_16x16x32_bf16 v[64:67], a[60:63], a[236:239], v[64:67]
    v_sub_f32 v129, v201, v137
    v_sub_f32 v130, v202, v138
    v_mfma_f32_16x16x32_bf16 v[64:67], a[44:47], a[232:235], v[64:67]
    v_sub_f32 v131, v203, v139
    v_cvt_pk_bf16_f32 v140, v124, v125
    v_cvt_pk_bf16_f32 v141, v126, v127
    v_mfma_f32_16x16x32_bf16 a[12:15], a[48:51], a[232:235], a[12:15]
    buffer_load_dwordx4 a[180:183], v2, s[36:39], s55 offen offset:3072
    s_add_u32 s55, s24, 273408
    v_mfma_f32_16x16x32_bf16 a[12:15], a[64:67], a[236:239], a[12:15]
    v_cvt_pk_bf16_f32 v142, v128, v129
    v_cvt_pk_bf16_f32 v143, v130, v131
    v_mfma_f32_16x16x32_bf16 a[12:15], a[80:83], a[240:243], a[12:15]
    v_lshlrev_b32 v132, 16, v104
    v_and_b32 v133, 0xffff0000, v104
    v_mfma_f32_16x16x32_bf16 a[32:35], a[84:87], a[240:243], a[32:35]
    ds_write_b128 v7, v[140:143] offset:0
    v_lshlrev_b32 v134, 16, v105
    v_mfma_f32_16x16x32_bf16 a[32:35], a[68:71], a[236:239], a[32:35]
    buffer_load_dwordx4 a[184:187], v2, s[36:39], s55 offen offset:0
    v_and_b32 v135, 0xffff0000, v105
    v_mfma_f32_16x16x32_bf16 a[32:35], a[52:55], a[232:235], a[32:35]
    v_lshlrev_b32 v136, 16, v106
    s_waitcnt vmcnt(17)
    v_mfma_f32_16x16x32_bf16 v[48:51], a[40:43], a[244:247], v[48:51]
    v_and_b32 v137, 0xffff0000, v106
    v_lshlrev_b32 v138, 16, v107
    v_mfma_f32_16x16x32_bf16 v[48:51], a[56:59], a[248:251], v[48:51]
    v_and_b32 v139, 0xffff0000, v107
    v_sub_f32 v124, v188, v132
    v_mfma_f32_16x16x32_bf16 v[48:51], a[72:75], a[252:255], v[48:51]
    buffer_load_dwordx4 a[188:191], v2, s[36:39], s55 offen offset:1024
    v_sub_f32 v125, v189, v133
    v_mfma_f32_16x16x32_bf16 v[68:71], a[76:79], a[252:255], v[68:71]
    v_sub_f32 v126, v190, v134
    v_sub_f32 v127, v191, v135
    v_sub_f32 v128, v192, v136
    v_mfma_f32_16x16x32_bf16 v[68:71], a[60:63], a[248:251], v[68:71]
    v_sub_f32 v129, v193, v137
    v_sub_f32 v130, v194, v138
    v_mfma_f32_16x16x32_bf16 v[68:71], a[44:47], a[244:247], v[68:71]
    buffer_load_dwordx4 a[192:195], v2, s[36:39], s55 offen offset:2048
    v_sub_f32 v131, v195, v139
    v_mfma_f32_16x16x32_bf16 a[16:19], a[48:51], a[244:247], a[16:19]
    v_cvt_pk_bf16_f32 v152, v124, v125
    v_cvt_pk_bf16_f32 v153, v126, v127
    v_mfma_f32_16x16x32_bf16 a[16:19], a[64:67], a[248:251], a[16:19]
    v_cvt_pk_bf16_f32 v154, v128, v129
    v_cvt_pk_bf16_f32 v155, v130, v131
    v_mfma_f32_16x16x32_bf16 a[16:19], a[80:83], a[252:255], a[16:19]
    v_mfma_f32_16x16x32_bf16 a[36:39], a[84:87], a[252:255], a[36:39]
    ds_write_b128 v7, v[152:155] offset:12480
    buffer_load_dwordx4 a[196:199], v2, s[36:39], s55 offen offset:3072
    v_mfma_f32_16x16x32_bf16 a[36:39], a[68:71], a[248:251], a[36:39]
    s_add_u32 s55, s24, 277504
    v_mfma_f32_16x16x32_bf16 a[36:39], a[52:55], a[244:247], a[36:39]
    s_waitcnt vmcnt(17) lgkmcnt(4)
    v_mfma_f32_16x16x32_bf16 v[32:35], a[88:91], a[136:139], v[32:35]
    s_waitcnt vmcnt(12)
    v_lshlrev_b32 v188, 16, v112
    v_mfma_f32_16x16x32_bf16 v[32:35], a[104:107], a[140:143], v[32:35]
    buffer_load_dwordx4 a[200:203], v2, s[36:39], s55 offen offset:0
    v_and_b32 v189, 0xffff0000, v112
    v_lshlrev_b32 v190, 16, v113
    v_mfma_f32_16x16x32_bf16 v[32:35], a[120:123], a[144:147], v[32:35]
    v_and_b32 v191, 0xffff0000, v113
    v_lshlrev_b32 v192, 16, v114
    v_mfma_f32_16x16x32_bf16 v[52:55], a[124:127], a[144:147], v[52:55]
    v_and_b32 v193, 0xffff0000, v114
    v_lshlrev_b32 v194, 16, v115
    v_mfma_f32_16x16x32_bf16 v[52:55], a[108:111], a[140:143], v[52:55]
    s_waitcnt lgkmcnt(0)
    s_barrier
    v_mfma_f32_16x16x32_bf16 v[52:55], a[92:95], a[136:139], v[52:55]
    ds_read_b128 a[40:43], v5 offset:0
    buffer_load_dwordx4 a[204:207], v2, s[36:39], s55 offen offset:1024
    v_mfma_f32_16x16x32_bf16 a[0:3], a[96:99], a[136:139], a[0:3]
    ds_read_b128 a[56:59], v5 offset:32
    v_and_b32 v195, 0xffff0000, v115
    v_mfma_f32_16x16x32_bf16 a[0:3], a[112:115], a[140:143], a[0:3]
    ds_read_b128 a[72:75], v5 offset:64
    v_lshlrev_b32 v196, 16, v116
    v_mfma_f32_16x16x32_bf16 a[0:3], a[128:131], a[144:147], a[0:3]
    ds_read_b128 a[44:47], v5 offset:512
    v_and_b32 v197, 0xffff0000, v116
    v_mfma_f32_16x16x32_bf16 a[20:23], a[132:135], a[144:147], a[20:23]
    ds_read_b128 a[60:63], v5 offset:544
    buffer_load_dwordx4 a[208:211], v2, s[36:39], s55 offen offset:2048
    v_mfma_f32_16x16x32_bf16 a[20:23], a[116:119], a[140:143], a[20:23]
    ds_read_b128 a[76:79], v5 offset:576
    v_lshlrev_b32 v198, 16, v117
    v_mfma_f32_16x16x32_bf16 a[20:23], a[100:103], a[136:139], a[20:23]
    ds_read_b128 a[48:51], v6 offset:0
    v_and_b32 v199, 0xffff0000, v117
    s_waitcnt vmcnt(13)
    v_mfma_f32_16x16x32_bf16 v[36:39], a[88:91], a[148:151], v[36:39]
    ds_read_b128 a[64:67], v6 offset:32
    buffer_load_dwordx4 a[212:215], v2, s[36:39], s55 offen offset:3072
    v_mfma_f32_16x16x32_bf16 v[36:39], a[104:107], a[152:155], v[36:39]
    ds_read_b128 a[80:83], v6 offset:64
    s_add_u32 s55, s24, 281600
    v_mfma_f32_16x16x32_bf16 v[36:39], a[120:123], a[156:159], v[36:39]
    ds_read_b128 a[52:55], v6 offset:512
    v_lshlrev_b32 v200, 16, v118
    v_mfma_f32_16x16x32_bf16 v[56:59], a[124:127], a[156:159], v[56:59]
    ds_read_b128 a[68:71], v6 offset:544
    v_and_b32 v201, 0xffff0000, v118
    v_mfma_f32_16x16x32_bf16 v[56:59], a[108:111], a[152:155], v[56:59]
    ds_read_b128 a[84:87], v6 offset:576
    buffer_load_dwordx4 a[216:219], v2, s[36:39], s55 offen offset:0
    v_mfma_f32_16x16x32_bf16 v[56:59], a[92:95], a[148:151], v[56:59]
    v_lshlrev_b32 v202, 16, v119
    v_and_b32 v203, 0xffff0000, v119
    v_mfma_f32_16x16x32_bf16 a[4:7], a[96:99], a[148:151], a[4:7]
    v_add_f32 v124, v188, v196
    v_add_f32 v125, v189, v197
    v_mfma_f32_16x16x32_bf16 a[4:7], a[112:115], a[152:155], a[4:7]
    v_add_f32 v126, v190, v198
    v_add_f32 v127, v191, v199
    v_mfma_f32_16x16x32_bf16 a[4:7], a[128:131], a[156:159], a[4:7]
    buffer_load_dwordx4 a[220:223], v2, s[36:39], s55 offen offset:1024
    v_add_f32 v128, v192, v200
    v_mfma_f32_16x16x32_bf16 a[24:27], a[132:135], a[156:159], a[24:27]
    v_add_f32 v129, v193, v201
    v_add_f32 v130, v194, v202
    v_add_f32 v131, v195, v203
    v_mfma_f32_16x16x32_bf16 a[24:27], a[116:119], a[152:155], a[24:27]
    v_cvt_pk_bf16_f32 v144, v124, v125
    v_cvt_pk_bf16_f32 v145, v126, v127
    v_mfma_f32_16x16x32_bf16 a[24:27], a[100:103], a[148:151], a[24:27]
    v_cvt_pk_bf16_f32 v146, v128, v129
    s_waitcnt vmcnt(13)
    v_mfma_f32_16x16x32_bf16 v[40:43], a[88:91], a[160:163], v[40:43]
    buffer_load_dwordx4 a[224:227], v2, s[36:39], s55 offen offset:2048
    v_cvt_pk_bf16_f32 v147, v130, v131
    v_mfma_f32_16x16x32_bf16 v[40:43], a[104:107], a[164:167], v[40:43]
    v_sub_f32 v124, v196, v188
    v_sub_f32 v125, v197, v189
    v_mfma_f32_16x16x32_bf16 v[40:43], a[120:123], a[168:171], v[40:43]
    ds_write_b128 v7, v[144:147] offset:20800
    v_sub_f32 v126, v198, v190
    v_mfma_f32_16x16x32_bf16 v[60:63], a[124:127], a[168:171], v[60:63]
    v_sub_f32 v127, v199, v191
    v_sub_f32 v128, v200, v192
    v_mfma_f32_16x16x32_bf16 v[60:63], a[108:111], a[164:167], v[60:63]
    buffer_load_dwordx4 a[228:231], v2, s[36:39], s55 offen offset:3072
    s_add_u32 s55, s24, 285696
    v_mfma_f32_16x16x32_bf16 v[60:63], a[92:95], a[160:163], v[60:63]
    v_sub_f32 v129, v201, v193
    v_sub_f32 v130, v202, v194
    v_mfma_f32_16x16x32_bf16 a[8:11], a[96:99], a[160:163], a[8:11]
    v_sub_f32 v131, v203, v195
    v_cvt_pk_bf16_f32 v148, v124, v125
    v_mfma_f32_16x16x32_bf16 a[8:11], a[112:115], a[164:167], a[8:11]
    buffer_load_dwordx4 a[232:235], v2, s[36:39], s55 offen offset:0
    v_cvt_pk_bf16_f32 v149, v126, v127
    v_cvt_pk_bf16_f32 v150, v128, v129
    v_mfma_f32_16x16x32_bf16 a[8:11], a[128:131], a[168:171], a[8:11]
    v_cvt_pk_bf16_f32 v151, v130, v131
    v_lshlrev_b32 v132, 16, v108
    v_mfma_f32_16x16x32_bf16 a[28:31], a[132:135], a[168:171], a[28:31]
    ds_write_b128 v7, v[148:151] offset:24960
    v_and_b32 v133, 0xffff0000, v108
    v_mfma_f32_16x16x32_bf16 a[28:31], a[116:119], a[164:167], a[28:31]
    v_lshlrev_b32 v134, 16, v109
    v_and_b32 v135, 0xffff0000, v109
    v_mfma_f32_16x16x32_bf16 a[28:31], a[100:103], a[160:163], a[28:31]
    buffer_load_dwordx4 a[236:239], v2, s[36:39], s55 offen offset:1024
    s_waitcnt vmcnt(14)
    v_mfma_f32_16x16x32_bf16 v[44:47], a[88:91], a[172:175], v[44:47]
    v_lshlrev_b32 v136, 16, v110
    v_and_b32 v137, 0xffff0000, v110
    v_mfma_f32_16x16x32_bf16 v[44:47], a[104:107], a[176:179], v[44:47]
    v_lshlrev_b32 v138, 16, v111
    v_and_b32 v139, 0xffff0000, v111
    v_mfma_f32_16x16x32_bf16 v[44:47], a[120:123], a[180:183], v[44:47]
    v_sub_f32 v124, v196, v132
    v_sub_f32 v125, v197, v133
    v_mfma_f32_16x16x32_bf16 v[64:67], a[124:127], a[180:183], v[64:67]
    buffer_load_dwordx4 a[240:243], v2, s[36:39], s55 offen offset:2048
    v_sub_f32 v126, v198, v134
    v_mfma_f32_16x16x32_bf16 v[64:67], a[108:111], a[176:179], v[64:67]
    v_sub_f32 v127, v199, v135
    v_sub_f32 v128, v200, v136
    v_mfma_f32_16x16x32_bf16 v[64:67], a[92:95], a[172:175], v[64:67]
    v_sub_f32 v129, v201, v137
    v_sub_f32 v130, v202, v138
    v_sub_f32 v131, v203, v139
    v_mfma_f32_16x16x32_bf16 a[12:15], a[96:99], a[172:175], a[12:15]
    v_cvt_pk_bf16_f32 v140, v124, v125
    v_cvt_pk_bf16_f32 v141, v126, v127
    v_mfma_f32_16x16x32_bf16 a[12:15], a[112:115], a[176:179], a[12:15]
    buffer_load_dwordx4 a[244:247], v2, s[36:39], s55 offen offset:3072
    s_add_u32 s55, s24, 289792
    v_mfma_f32_16x16x32_bf16 a[12:15], a[128:131], a[180:183], a[12:15]
    v_cvt_pk_bf16_f32 v142, v128, v129
    v_cvt_pk_bf16_f32 v143, v130, v131
    v_mfma_f32_16x16x32_bf16 a[32:35], a[132:135], a[180:183], a[32:35]
    v_lshlrev_b32 v132, 16, v120
    v_and_b32 v133, 0xffff0000, v120
    v_mfma_f32_16x16x32_bf16 a[32:35], a[116:119], a[176:179], a[32:35]
    ds_write_b128 v7, v[140:143] offset:16640
    v_lshlrev_b32 v134, 16, v121
    v_mfma_f32_16x16x32_bf16 a[32:35], a[100:103], a[172:175], a[32:35]
    buffer_load_dwordx4 a[248:251], v2, s[36:39], s55 offen offset:0
    s_waitcnt vmcnt(14)
    v_mfma_f32_16x16x32_bf16 v[48:51], a[88:91], a[184:187], v[48:51]
    v_and_b32 v135, 0xffff0000, v121
    v_lshlrev_b32 v136, 16, v122
    v_mfma_f32_16x16x32_bf16 v[48:51], a[104:107], a[188:191], v[48:51]
    v_and_b32 v137, 0xffff0000, v122
    v_lshlrev_b32 v138, 16, v123
    v_mfma_f32_16x16x32_bf16 v[48:51], a[120:123], a[192:195], v[48:51]
    buffer_load_dwordx4 a[252:255], v2, s[36:39], s55 offen offset:1024
    v_and_b32 v139, 0xffff0000, v123
    v_mfma_f32_16x16x32_bf16 v[68:71], a[124:127], a[192:195], v[68:71]
    v_sub_f32 v124, v188, v132
    v_sub_f32 v125, v189, v133
    v_sub_f32 v126, v190, v134
    v_mfma_f32_16x16x32_bf16 v[68:71], a[108:111], a[188:191], v[68:71]
    v_sub_f32 v127, v191, v135
    v_sub_f32 v128, v192, v136
    v_mfma_f32_16x16x32_bf16 v[68:71], a[92:95], a[184:187], v[68:71]
    v_sub_f32 v129, v193, v137
    v_sub_f32 v130, v194, v138
    v_mfma_f32_16x16x32_bf16 a[16:19], a[96:99], a[184:187], a[16:19]
    buffer_load_dwordx4 a[136:139], v2, s[36:39], s55 offen offset:2048
    v_sub_f32 v131, v195, v139
    v_mfma_f32_16x16x32_bf16 a[16:19], a[112:115], a[188:191], a[16:19]
    v_cvt_pk_bf16_f32 v152, v124, v125
    v_cvt_pk_bf16_f32 v153, v126, v127
    v_mfma_f32_16x16x32_bf16 a[16:19], a[128:131], a[192:195], a[16:19]
    v_cvt_pk_bf16_f32 v154, v128, v129
    v_cvt_pk_bf16_f32 v155, v130, v131
    v_mfma_f32_16x16x32_bf16 a[36:39], a[132:135], a[192:195], a[36:39]
    v_mfma_f32_16x16x32_bf16 a[36:39], a[116:119], a[188:191], a[36:39]
    ds_write_b128 v7, v[152:155] offset:29120
    buffer_load_dwordx4 a[140:143], v2, s[36:39], s55 offen offset:3072
    v_mfma_f32_16x16x32_bf16 a[36:39], a[100:103], a[184:187], a[36:39]
    s_add_u32 s55, s24, 293888
    s_waitcnt vmcnt(14) lgkmcnt(4)
    v_mfma_f32_16x16x32_bf16 v[32:35], a[40:43], a[196:199], v[32:35]
    v_mfma_f32_16x16x32_bf16 v[32:35], a[56:59], a[200:203], v[32:35]
    s_waitcnt lgkmcnt(0)
    s_barrier
    v_mfma_f32_16x16x32_bf16 v[32:35], a[72:75], a[204:207], v[32:35]
    ds_read_b128 a[88:91], v5 offset:16640
    buffer_load_dwordx4 a[144:147], v2, s[36:39], s55 offen offset:0
    v_mfma_f32_16x16x32_bf16 v[52:55], a[76:79], a[204:207], v[52:55]
    ds_read_b128 a[104:107], v5 offset:16672
    v_mfma_f32_16x16x32_bf16 v[52:55], a[60:63], a[200:203], v[52:55]
    ds_read_b128 a[120:123], v5 offset:16704
    v_mfma_f32_16x16x32_bf16 v[52:55], a[44:47], a[196:199], v[52:55]
    ds_read_b128 a[92:95], v5 offset:17152
    v_mfma_f32_16x16x32_bf16 a[0:3], a[48:51], a[196:199], a[0:3]
    ds_read_b128 a[108:111], v5 offset:17184
    buffer_load_dwordx4 a[148:151], v2, s[36:39], s55 offen offset:1024
    v_mfma_f32_16x16x32_bf16 a[0:3], a[64:67], a[200:203], a[0:3]
    ds_read_b128 a[124:127], v5 offset:17216
    v_mfma_f32_16x16x32_bf16 a[0:3], a[80:83], a[204:207], a[0:3]
    ds_read_b128 a[96:99], v6 offset:16640
    v_mfma_f32_16x16x32_bf16 a[20:23], a[84:87], a[204:207], a[20:23]
    ds_read_b128 a[112:115], v6 offset:16672
    buffer_load_dwordx4 a[152:155], v2, s[36:39], s55 offen offset:2048
    v_mfma_f32_16x16x32_bf16 a[20:23], a[68:71], a[200:203], a[20:23]
    ds_read_b128 a[128:131], v6 offset:16704
    v_mfma_f32_16x16x32_bf16 a[20:23], a[52:55], a[196:199], a[20:23]
    ds_read_b128 a[100:103], v6 offset:17152
    s_waitcnt vmcnt(14) lgkmcnt(7)
    v_mfma_f32_16x16x32_bf16 v[32:35], a[88:91], a[208:211], v[32:35]
    ds_read_b128 a[116:119], v6 offset:17184
    v_mfma_f32_16x16x32_bf16 v[32:35], a[104:107], a[212:215], v[32:35]
    ds_read_b128 a[132:135], v6 offset:17216
    buffer_load_dwordx4 a[156:159], v2, s[36:39], s55 offen offset:3072
    v_mfma_f32_16x16x32_bf16 v[32:35], a[120:123], a[216:219], v[32:35]
    s_add_u32 s55, s24, 297984
    s_waitcnt lgkmcnt(6)
    v_mfma_f32_16x16x32_bf16 v[52:55], a[124:127], a[216:219], v[52:55]
    v_mfma_f32_16x16x32_bf16 v[52:55], a[108:111], a[212:215], v[52:55]
    v_mfma_f32_16x16x32_bf16 v[52:55], a[92:95], a[208:211], v[52:55]
    buffer_load_dwordx4 a[160:163], v2, s[36:39], s55 offen offset:0
    s_waitcnt lgkmcnt(3)
    v_mfma_f32_16x16x32_bf16 a[0:3], a[96:99], a[208:211], a[0:3]
    v_mfma_f32_16x16x32_bf16 a[0:3], a[112:115], a[212:215], a[0:3]
    v_mfma_f32_16x16x32_bf16 a[0:3], a[128:131], a[216:219], a[0:3]
    s_waitcnt lgkmcnt(0)
    v_mfma_f32_16x16x32_bf16 a[20:23], a[132:135], a[216:219], a[20:23]
    buffer_load_dwordx4 a[164:167], v2, s[36:39], s55 offen offset:1024
    v_mfma_f32_16x16x32_bf16 a[20:23], a[116:119], a[212:215], a[20:23]
    ds_write_b128 v9, v[32:35] offset:0
    v_mfma_f32_16x16x32_bf16 a[20:23], a[100:103], a[208:211], a[20:23]
    s_waitcnt vmcnt(14)
    v_mfma_f32_16x16x32_bf16 v[36:39], a[40:43], a[220:223], v[36:39]
    v_mfma_f32_16x16x32_bf16 v[36:39], a[56:59], a[224:227], v[36:39]
    ds_write_b128 v9, v[52:55] offset:5120
    buffer_load_dwordx4 a[168:171], v2, s[36:39], s55 offen offset:2048
    v_mfma_f32_16x16x32_bf16 v[36:39], a[72:75], a[228:231], v[36:39]
    s_waitcnt vmcnt(12)
    v_mfma_f32_16x16x32_bf16 v[36:39], a[88:91], a[232:235], v[36:39]
    v_mfma_f32_16x16x32_bf16 v[36:39], a[104:107], a[236:239], v[36:39]
    ds_write_b128 v9, a[0:3] offset:10240
    buffer_load_dwordx4 a[172:175], v2, s[36:39], s55 offen offset:3072
    v_mfma_f32_16x16x32_bf16 v[36:39], a[120:123], a[240:243], v[36:39]
    s_add_u32 s55, s24, 302080
    v_mfma_f32_16x16x32_bf16 v[56:59], a[124:127], a[240:243], v[56:59]
    v_mfma_f32_16x16x32_bf16 v[56:59], a[108:111], a[236:239], v[56:59]
    ds_write_b128 v9, a[20:23] offset:15360
    v_mfma_f32_16x16x32_bf16 v[56:59], a[92:95], a[232:235], v[56:59]
    buffer_load_dwordx4 a[176:179], v2, s[36:39], s55 offen offset:0
    v_mfma_f32_16x16x32_bf16 v[56:59], a[76:79], a[228:231], v[56:59]
    v_mfma_f32_16x16x32_bf16 v[56:59], a[60:63], a[224:227], v[56:59]
    v_mfma_f32_16x16x32_bf16 v[56:59], a[44:47], a[220:223], v[56:59]
    v_mfma_f32_16x16x32_bf16 a[4:7], a[48:51], a[220:223], a[4:7]
    buffer_load_dwordx4 a[180:183], v2, s[36:39], s55 offen offset:1024
    v_mfma_f32_16x16x32_bf16 a[4:7], a[64:67], a[224:227], a[4:7]
    ds_write_b128 v9, v[36:39] offset:1024
    s_waitcnt lgkmcnt(1)
    v_mfma_f32_16x16x32_bf16 a[4:7], a[80:83], a[228:231], a[4:7]
    s_barrier
    ds_read_b128 v[92:95], v10 offset:0
    v_mfma_f32_16x16x32_bf16 a[4:7], a[96:99], a[232:235], a[4:7]
    ds_read_b128 v[96:99], v10 offset:5120
    v_mfma_f32_16x16x32_bf16 a[4:7], a[112:115], a[236:239], a[4:7]
    ds_read_b128 v[100:103], v11 offset:0
    buffer_load_dwordx4 a[184:187], v2, s[36:39], s55 offen offset:2048
    v_mfma_f32_16x16x32_bf16 a[4:7], a[128:131], a[240:243], a[4:7]
    ds_read_b128 v[104:107], v11 offset:5120
    v_mfma_f32_16x16x32_bf16 a[24:27], a[132:135], a[240:243], a[24:27]
    v_mfma_f32_16x16x32_bf16 a[24:27], a[116:119], a[236:239], a[24:27]
    ds_write_b128 v9, v[56:59] offset:6144
    v_mfma_f32_16x16x32_bf16 a[24:27], a[100:103], a[232:235], a[24:27]
    buffer_load_dwordx4 a[188:191], v2, s[36:39], s55 offen offset:3072
    s_add_u32 s55, s24, 306176
    v_mfma_f32_16x16x32_bf16 a[24:27], a[84:87], a[228:231], a[24:27]
    v_mfma_f32_16x16x32_bf16 a[24:27], a[68:71], a[224:227], a[24:27]
    v_mfma_f32_16x16x32_bf16 a[24:27], a[52:55], a[220:223], a[24:27]
    buffer_load_dwordx4 a[192:195], v2, s[36:39], s55 offen offset:0
    s_waitcnt vmcnt(15)
    v_mfma_f32_16x16x32_bf16 v[40:43], a[40:43], a[244:247], v[40:43]
    s_waitcnt lgkmcnt(1)
    v_fma_f32 v32, v32, s14, v204
    v_mfma_f32_16x16x32_bf16 v[40:43], a[56:59], a[248:251], v[40:43]
    ds_write_b128 v9, a[4:7] offset:11264
    v_fma_f32 v33, v33, s14, v205
    v_mfma_f32_16x16x32_bf16 v[40:43], a[72:75], a[252:255], v[40:43]
    v_fma_f32 v34, v34, s14, v206
    s_waitcnt vmcnt(12)
    v_mfma_f32_16x16x32_bf16 v[40:43], a[88:91], a[136:139], v[40:43]
    v_fma_f32 v35, v35, s14, v207
    v_fma_f32 v52, v52, s14, v224
    v_mfma_f32_16x16x32_bf16 v[40:43], a[104:107], a[140:143], v[40:43]
    v_fma_f32 v53, v53, s14, v225
    v_fma_f32 v54, v54, s14, v226
    v_mfma_f32_16x16x32_bf16 v[40:43], a[120:123], a[144:147], v[40:43]
    v_fma_f32 v55, v55, s14, v227
    v_fma_f32 v32, v92, s16, v32
    v_mfma_f32_16x16x32_bf16 v[60:63], a[124:127], a[144:147], v[60:63]
    v_fma_f32 v33, v93, s16, v33
    v_fma_f32 v34, v94, s16, v34
    v_mfma_f32_16x16x32_bf16 v[60:63], a[108:111], a[140:143], v[60:63]
    ds_write_b128 v9, a[24:27] offset:16384
    v_fma_f32 v35, v95, s16, v35
    v_mfma_f32_16x16x32_bf16 v[60:63], a[92:95], a[136:139], v[60:63]
    v_fma_f32 v52, v96, s16, v52
    v_fma_f32 v53, v97, s16, v53
    v_mfma_f32_16x16x32_bf16 v[60:63], a[76:79], a[252:255], v[60:63]
    v_fma_f32 v54, v98, s16, v54
    v_fma_f32 v55, v99, s16, v55
    v_mfma_f32_16x16x32_bf16 v[60:63], a[60:63], a[248:251], v[60:63]
    v_fma_f32 v32, v100, s18, v32
    v_fma_f32 v33, v101, s18, v33
    v_mfma_f32_16x16x32_bf16 v[60:63], a[44:47], a[244:247], v[60:63]
    v_fma_f32 v34, v102, s18, v34
    v_fma_f32 v35, v103, s18, v35
    v_mfma_f32_16x16x32_bf16 a[8:11], a[48:51], a[244:247], a[8:11]
    v_fma_f32 v52, v104, s18, v52
    v_fma_f32 v53, v105, s18, v53
    v_mfma_f32_16x16x32_bf16 a[8:11], a[64:67], a[248:251], a[8:11]
    ds_write_b128 v9, v[40:43] offset:2048
    s_waitcnt lgkmcnt(1)
    v_mfma_f32_16x16x32_bf16 a[8:11], a[80:83], a[252:255], a[8:11]
    s_barrier
    ds_read_b128 v[108:111], v10 offset:1024
    v_mfma_f32_16x16x32_bf16 a[8:11], a[96:99], a[136:139], a[8:11]
    ds_read_b128 v[112:115], v10 offset:6144
    v_fma_f32 v54, v106, s18, v54
    v_mfma_f32_16x16x32_bf16 a[8:11], a[112:115], a[140:143], a[8:11]
    ds_read_b128 v[116:119], v11 offset:1024
    v_fma_f32 v55, v107, s18, v55
    v_mfma_f32_16x16x32_bf16 a[8:11], a[128:131], a[144:147], a[8:11]
    ds_read_b128 v[120:123], v11 offset:6144
    v_cvt_pk_bf16_f32 v140, v32, v33
    v_mfma_f32_16x16x32_bf16 a[28:31], a[132:135], a[144:147], a[28:31]
    v_cvt_pk_bf16_f32 v142, v52, v53
    v_cvt_pk_bf16_f32 v141, v34, v35
    v_mfma_f32_16x16x32_bf16 a[28:31], a[116:119], a[140:143], a[28:31]
    ds_write_b128 v9, v[60:63] offset:7168
    v_cvt_pk_bf16_f32 v143, v54, v55
    v_mfma_f32_16x16x32_bf16 a[28:31], a[100:103], a[136:139], a[28:31]
    v_permlane16_swap_b32 v140, v142
    v_mfma_f32_16x16x32_bf16 a[28:31], a[84:87], a[252:255], a[28:31]
    s_add_u32 s70, s54, 0
    v_mfma_f32_16x16x32_bf16 a[28:31], a[68:71], a[248:251], a[28:31]
    v_permlane16_swap_b32 v141, v143
    v_mfma_f32_16x16x32_bf16 a[28:31], a[52:55], a[244:247], a[28:31]
    s_waitcnt lgkmcnt(1)
    s_waitcnt vmcnt(9)
    v_mfma_f32_16x16x32_bf16 v[44:47], a[40:43], a[148:151], v[44:47]
    buffer_store_dwordx4 v[140:143], v3, s[32:35], s70 offen sc1
    v_fma_f32 v36, v36, s14, v208
    v_mfma_f32_16x16x32_bf16 v[44:47], a[56:59], a[152:155], v[44:47]
    ds_write_b128 v9, a[8:11] offset:12288
    v_fma_f32 v37, v37, s14, v209
    v_mfma_f32_16x16x32_bf16 v[44:47], a[72:75], a[156:159], v[44:47]
    v_fma_f32 v38, v38, s14, v210
    s_waitcnt vmcnt(7)
    v_mfma_f32_16x16x32_bf16 v[44:47], a[88:91], a[160:163], v[44:47]
    v_fma_f32 v39, v39, s14, v211
    v_fma_f32 v56, v56, s14, v228
    v_mfma_f32_16x16x32_bf16 v[44:47], a[104:107], a[164:167], v[44:47]
L_chain3:
L_page9:
    s_cbranch_execz L_back3
    v_fma_f32 v57, v57, s14, v229
    v_fma_f32 v58, v58, s14, v230
    v_mfma_f32_16x16x32_bf16 v[44:47], a[120:123], a[168:171], v[44:47]
    v_fma_f32 v59, v59, s14, v231
    v_fma_f32 v36, v108, s16, v36
    v_mfma_f32_16x16x32_bf16 v[64:67], a[124:127], a[168:171], v[64:67]
    v_fma_f32 v37, v109, s16, v37
    v_fma_f32 v38, v110, s16, v38
    v_mfma_f32_16x16x32_bf16 v[64:67], a[108:111], a[164:167], v[64:67]
    ds_write_b128 v9, a[28:31] offset:17408
    v_fma_f32 v39, v111, s16, v39
    v_mfma_f32_16x16x32_bf16 v[64:67], a[92:95], a[160:163], v[64:67]
    v_fma_f32 v56, v112, s16, v56
    v_fma_f32 v57, v113, s16, v57
    v_mfma_f32_16x16x32_bf16 v[64:67], a[76:79], a[156:159], v[64:67]
    v_fma_f32 v58, v114, s16, v58
    v_fma_f32 v59, v115, s16, v59
    v_mfma_f32_16x16x32_bf16 v[64:67], a[60:63], a[152:155], v[64:67]
    v_fma_f32 v36, v116, s18, v36
    v_fma_f32 v37, v117, s18, v37
    v_mfma_f32_16x16x32_bf16 v[64:67], a[44:47], a[148:151], v[64:67]
    v_fma_f32 v38, v118, s18, v38
    v_fma_f32 v39, v119, s18, v39
    v_mfma_f32_16x16x32_bf16 a[12:15], a[48:51], a[148:151], a[12:15]
    v_fma_f32 v56, v120, s18, v56
    v_fma_f32 v57, v121, s18, v57
    v_mfma_f32_16x16x32_bf16 a[12:15], a[64:67], a[152:155], a[12:15]
    ds_write_b128 v9, v[44:47] offset:3072
    s_waitcnt lgkmcnt(1)
    v_mfma_f32_16x16x32_bf16 a[12:15], a[80:83], a[156:159], a[12:15]
    s_barrier
    ds_read_b128 v[124:127], v10 offset:2048
    v_mfma_f32_16x16x32_bf16 a[12:15], a[96:99], a[160:163], a[12:15]
    ds_read_b128 v[128:131], v10 offset:7168
    v_fma_f32 v58, v122, s18, v58
    v_mfma_f32_16x16x32_bf16 a[12:15], a[112:115], a[164:167], a[12:15]
    ds_read_b128 v[132:135], v11 offset:2048
    v_fma_f32 v59, v123, s18, v59
    v_mfma_f32_16x16x32_bf16 a[12:15], a[128:131], a[168:171], a[12:15]
    ds_read_b128 v[136:139], v11 offset:7168
    v_cvt_pk_bf16_f32 v144, v36, v37
    v_mfma_f32_16x16x32_bf16 a[32:35], a[132:135], a[168:171], a[32:35]
    v_cvt_pk_bf16_f32 v146, v56, v57
    v_cvt_pk_bf16_f32 v145, v38, v39
    v_mfma_f32_16x16x32_bf16 a[32:35], a[116:119], a[164:167], a[32:35]
    ds_write_b128 v9, v[64:67] offset:8192
    v_cvt_pk_bf16_f32 v147, v58, v59
    v_mfma_f32_16x16x32_bf16 a[32:35], a[100:103], a[160:163], a[32:35]
    v_permlane16_swap_b32 v144, v146
    v_mfma_f32_16x16x32_bf16 a[32:35], a[84:87], a[156:159], a[32:35]
    s_add_u32 s70, s54, 131072
    v_mfma_f32_16x16x32_bf16 a[32:35], a[68:71], a[152:155], a[32:35]
    v_permlane16_swap_b32 v145, v147
    v_mfma_f32_16x16x32_bf16 a[32:35], a[52:55], a[148:151], a[32:35]
    s_waitcnt lgkmcnt(1)
    s_waitcnt vmcnt(4)
    v_mfma_f32_16x16x32_bf16 v[48:51], a[40:43], a[172:175], v[48:51]
    buffer_store_dwordx4 v[144:147], v3, s[32:35], s70 offen sc1
    v_fma_f32 v40, v40, s14, v212
    v_mfma_f32_16x16x32_bf16 v[48:51], a[56:59], a[176:179], v[48:51]
    ds_write_b128 v9, a[12:15] offset:13312
    v_fma_f32 v41, v41, s14, v213
    v_mfma_f32_16x16x32_bf16 v[48:51], a[72:75], a[180:183], v[48:51]
    v_fma_f32 v42, v42, s14, v214
    s_waitcnt vmcnt(2)
    v_mfma_f32_16x16x32_bf16 v[48:51], a[88:91], a[184:187], v[48:51]
    v_fma_f32 v43, v43, s14, v215
    v_fma_f32 v60, v60, s14, v232
    v_mfma_f32_16x16x32_bf16 v[48:51], a[104:107], a[188:191], v[48:51]
    v_fma_f32 v61, v61, s14, v233
    v_fma_f32 v62, v62, s14, v234
    v_mfma_f32_16x16x32_bf16 v[48:51], a[120:123], a[192:195], v[48:51]
    v_fma_f32 v63, v63, s14, v235
    v_fma_f32 v40, v124, s16, v40
    v_mfma_f32_16x16x32_bf16 v[68:71], a[124:127], a[192:195], v[68:71]
    v_fma_f32 v41, v125, s16, v41
    v_fma_f32 v42, v126, s16, v42
    v_mfma_f32_16x16x32_bf16 v[68:71], a[108:111], a[188:191], v[68:71]
    ds_write_b128 v9, a[32:35] offset:18432
    v_fma_f32 v43, v127, s16, v43
    v_mfma_f32_16x16x32_bf16 v[68:71], a[92:95], a[184:187], v[68:71]
    v_fma_f32 v60, v128, s16, v60
    v_fma_f32 v61, v129, s16, v61
    v_mfma_f32_16x16x32_bf16 v[68:71], a[76:79], a[180:183], v[68:71]
    v_fma_f32 v62, v130, s16, v62
    v_fma_f32 v63, v131, s16, v63
    v_mfma_f32_16x16x32_bf16 v[68:71], a[60:63], a[176:179], v[68:71]
    v_fma_f32 v40, v132, s18, v40
    v_fma_f32 v41, v133, s18, v41
    v_mfma_f32_16x16x32_bf16 v[68:71], a[44:47], a[172:175], v[68:71]
    v_fma_f32 v42, v134, s18, v42
    v_fma_f32 v43, v135, s18, v43
    v_mfma_f32_16x16x32_bf16 a[16:19], a[48:51], a[172:175], a[16:19]
    v_fma_f32 v60, v136, s18, v60
    v_fma_f32 v61, v137, s18, v61
    v_mfma_f32_16x16x32_bf16 a[16:19], a[64:67], a[176:179], a[16:19]
    ds_write_b128 v9, v[48:51] offset:4096
    s_waitcnt lgkmcnt(1)
    v_mfma_f32_16x16x32_bf16 a[16:19], a[80:83], a[180:183], a[16:19]
    s_barrier
    ds_read_b128 v[92:95], v10 offset:3072
    v_mfma_f32_16x16x32_bf16 a[16:19], a[96:99], a[184:187], a[16:19]
    ds_read_b128 v[96:99], v10 offset:8192
    v_fma_f32 v62, v138, s18, v62
    v_mfma_f32_16x16x32_bf16 a[16:19], a[112:115], a[188:191], a[16:19]
    ds_read_b128 v[100:103], v11 offset:3072
    v_fma_f32 v63, v139, s18, v63
    v_mfma_f32_16x16x32_bf16 a[16:19], a[128:131], a[192:195], a[16:19]
    ds_read_b128 v[104:107], v11 offset:8192
    v_cvt_pk_bf16_f32 v140, v40, v41
    v_mfma_f32_16x16x32_bf16 a[36:39], a[132:135], a[192:195], a[36:39]
    v_cvt_pk_bf16_f32 v142, v60, v61
    v_cvt_pk_bf16_f32 v141, v42, v43
    v_mfma_f32_16x16x32_bf16 a[36:39], a[116:119], a[188:191], a[36:39]
    ds_write_b128 v9, v[68:71] offset:9216
    v_cvt_pk_bf16_f32 v143, v62, v63
    v_mfma_f32_16x16x32_bf16 a[36:39], a[100:103], a[184:187], a[36:39]
    v_permlane16_swap_b32 v140, v142
    v_mfma_f32_16x16x32_bf16 a[36:39], a[84:87], a[180:183], a[36:39]
    s_add_u32 s70, s54, 262144
    v_mfma_f32_16x16x32_bf16 a[36:39], a[68:71], a[176:179], a[36:39]
    v_permlane16_swap_b32 v141, v143
    v_mfma_f32_16x16x32_bf16 a[36:39], a[52:55], a[172:175], a[36:39]
    s_waitcnt lgkmcnt(1)
    v_fma_f32 v44, v44, s14, v216
    buffer_store_dwordx4 v[140:143], v3, s[32:35], s70 offen sc1
L_chain4:
L_page10:
    s_cbranch_execz L_back4
    v_fma_f32 v45, v45, s14, v217
    v_pk_fma_f32 v[46:47], v[46:47], s[14:15], v[218:219] op_sel_hi:[1,0,1]
    v_pk_fma_f32 v[64:65], v[64:65], s[14:15], v[236:237] op_sel_hi:[1,0,1]
    ds_write_b128 v9, a[16:19] offset:14336
    v_pk_fma_f32 v[66:67], v[66:67], s[14:15], v[238:239] op_sel_hi:[1,0,1]
    v_pk_fma_f32 v[44:45], v[92:93], s[16:17], v[44:45] op_sel_hi:[1,0,1]
    v_pk_fma_f32 v[46:47], v[94:95], s[16:17], v[46:47] op_sel_hi:[1,0,1]
    v_pk_fma_f32 v[64:65], v[96:97], s[16:17], v[64:65] op_sel_hi:[1,0,1]
    ds_write_b128 v9, a[36:39] offset:19456
    v_pk_fma_f32 v[66:67], v[98:99], s[16:17], v[66:67] op_sel_hi:[1,0,1]
    v_pk_fma_f32 v[44:45], v[100:101], s[18:19], v[44:45] op_sel_hi:[1,0,1]
    v_pk_fma_f32 v[46:47], v[102:103], s[18:19], v[46:47] op_sel_hi:[1,0,1]
    v_pk_fma_f32 v[64:65], v[104:105], s[18:19], v[64:65] op_sel_hi:[1,0,1]
    v_pk_fma_f32 v[66:67], v[106:107], s[18:19], v[66:67] op_sel_hi:[1,0,1]
    v_cvt_pk_bf16_f32 v144, v44, v45
    v_cvt_pk_bf16_f32 v146, v64, v65
    v_cvt_pk_bf16_f32 v145, v46, v47
    v_cvt_pk_bf16_f32 v147, v66, v67
    v_permlane16_swap_b32 v144, v146
    s_add_u32 s70, s54, 393216
    v_permlane16_swap_b32 v145, v147
    buffer_store_dwordx4 v[144:147], v3, s[32:35], s70 offen sc1
    s_waitcnt lgkmcnt(0)
    s_barrier
    ds_read_b128 v[108:111], v10 offset:4096
    ds_read_b128 v[112:115], v10 offset:9216
    ds_read_b128 v[116:119], v11 offset:4096
    ds_read_b128 v[120:123], v11 offset:9216
    s_waitcnt lgkmcnt(0)
    v_pk_fma_f32 v[48:49], v[48:49], s[14:15], v[220:221] op_sel_hi:[1,0,1]
    v_pk_fma_f32 v[50:51], v[50:51], s[14:15], v[222:223] op_sel_hi:[1,0,1]
    v_pk_fma_f32 v[68:69], v[68:69], s[14:15], v[240:241] op_sel_hi:[1,0,1]
    v_pk_fma_f32 v[70:71], v[70:71], s[14:15], v[242:243] op_sel_hi:[1,0,1]
    v_pk_fma_f32 v[48:49], v[108:109], s[16:17], v[48:49] op_sel_hi:[1,0,1]
    v_pk_fma_f32 v[50:51], v[110:111], s[16:17], v[50:51] op_sel_hi:[1,0,1]
    v_pk_fma_f32 v[68:69], v[112:113], s[16:17], v[68:69] op_sel_hi:[1,0,1]
    v_pk_fma_f32 v[70:71], v[114:115], s[16:17], v[70:71] op_sel_hi:[1,0,1]
    v_pk_fma_f32 v[48:49], v[116:117], s[18:19], v[48:49] op_sel_hi:[1,0,1]
    v_pk_fma_f32 v[50:51], v[118:119], s[18:19], v[50:51] op_sel_hi:[1,0,1]
    v_pk_fma_f32 v[68:69], v[120:121], s[18:19], v[68:69] op_sel_hi:[1,0,1]
    v_pk_fma_f32 v[70:71], v[122:123], s[18:19], v[70:71] op_sel_hi:[1,0,1]
    v_cvt_pk_bf16_f32 v140, v48, v49
    v_cvt_pk_bf16_f32 v142, v68, v69
    v_cvt_pk_bf16_f32 v141, v50, v51
    v_cvt_pk_bf16_f32 v143, v70, v71
    v_permlane16_swap_b32 v140, v142
    s_add_u32 s70, s54, 524288
    v_permlane16_swap_b32 v141, v143
    buffer_store_dwordx4 v[140:143], v3, s[32:35], s70 offen sc1
    s_endpgm
L_actb0_slow:
    s_mov_b32 s76, 0
L_actb0_spin:
    s_add_u32 s76, s76, 1
    s_cmp_gt_u32 s76, 0x20000
    s_cbranch_scc1 L_actb0_ok
    buffer_load_dwordx2 v[248:249], v255, s[36:39], s62 offen sc1
    s_waitcnt vmcnt(0)
    v_cmp_ne_u64 vcc, s[52:53], v[248:249]
    s_and_b64 vcc, vcc, s[58:59]
    s_cbranch_scc0 L_actb0_ok
    s_branch L_actb0_spin
L_late_slow:
    s_mov_b32 s76, 0
L_late_spin:
    s_add_u32 s76, s76, 1
    s_cmp_gt_u32 s76, 0x20000
    s_cbranch_scc1 L_late_ok
    buffer_load_dwordx2 v[248:249], v254, s[36:39], s65 offen sc1
    s_waitcnt vmcnt(0)
    v_cmp_ne_u64 vcc, s[52:53], v[248:249]
    s_and_b64 vcc, vcc, -1
    s_cbranch_scc0 L_late_ok
    s_branch L_late_spin
L_actb1_slow:
    s_mov_b32 s76, 0
L_actb1_spin:
    s_add_u32 s76, s76, 1
    s_cmp_gt_u32 s76, 0x20000
    s_cbranch_scc1 L_actb1_ok
    buffer_load_dwordx2 v[248:249], v255, s[36:39], s62 offen sc1
    s_waitcnt vmcnt(0)
    v_cmp_ne_u64 vcc, s[52:53], v[248:249]
    s_and_b64 vcc, vcc, s[58:59]
    s_cbranch_scc0 L_actb1_ok
    s_branch L_actb1_spin
L_done:
    s_endpgm
.section .rodata,"a"
.p2align 6
.amdhsa_kernel standalone__adm_resblock__diffusion_kernel
  .amdhsa_next_free_vgpr 512
  .amdhsa_next_free_sgpr 102
  .amdhsa_accum_offset 256
  .amdhsa_group_segment_fixed_size 0
  .amdhsa_kernarg_size 96
  .amdhsa_user_sgpr_count 2
  .amdhsa_user_sgpr_kernarg_segment_ptr 1
  .amdhsa_system_sgpr_workgroup_id_x 1
  .amdhsa_float_denorm_mode_32 3
.end_amdhsa_kernel
```
